```python
import torch

def _softmax(x, axis=-1):
    return torch.softmax(x, dim=axis)
def _gelu(x):
    return torch.nn.functional.gelu(x, approximate="tanh")
def _silu(x):
    return torch.nn.functional.silu(x)
def _sigmoid(x):
    return torch.sigmoid(x)
def _layernorm(x, axis=-1, eps=1e-5):
    m = x.mean(dim=axis, keepdim=True)
    v = x.var(dim=axis, keepdim=True, unbiased=False)
    return (x - m) / torch.sqrt(v + eps)
def _scatter_add(tgt, idx, src, axis=0):
    return tgt.clone().index_add_(axis, idx, src)
def _segment_sum(src, seg, n):
    out = torch.zeros((n,) + src.shape[1:], dtype=src.dtype)
    return out.index_add_(0, seg, src)
def _pad(x, pw):
    flat = tuple(v for pair in reversed(pw) for v in pair)
    return torch.nn.functional.pad(x, flat)

kernel_name = 'concat_heads__gqa_block_cached__gqa_block_cached__near_ridge'

def setup_inputs():

    _w = (lambda a: (lambda t: t.to(torch.bfloat16) if t.is_floating_point() else t)(torch.as_tensor(a)))
    def _A_setup():
        B, Sq, D = 8, 64, 576
        Hq, Hkv, Sk, Dh = 32, 16, 512, 128
        assert Hq % Hkv == 0, (Hq, Hkv)
        return {
            "x": _w((lambda *s: torch.randn(*s, dtype=torch.bfloat16) * 0.8)(B, Sq, D)),
            "k_cache": _w((lambda *s: torch.randn(*s, dtype=torch.bfloat16) * 0.8)(B, Hkv, Sk, Dh)),
            "v_cache": _w((lambda *s: torch.randn(*s, dtype=torch.bfloat16) * 0.05)(B, Hkv, Sk, Dh)),
            "wq": _w((lambda *s: torch.randn(*s, dtype=torch.bfloat16) * 0.8)(D, Hq * Dh) * (D ** -0.5)),
            "wo": _w((lambda *s: torch.randn(*s, dtype=torch.bfloat16) * 0.05)(Hq * Dh, D) * ((Hq * Dh) ** -0.5)),
        }
    _A_in = _A_setup()

    def _B_setup():
        B, Sq, D = 8, 64, 576
        Hq, Hkv, Sk, Dh = 32, 16, 512, 128
        assert Hq % Hkv == 0, (Hq, Hkv)
        return {
            "x": _w((lambda *s: torch.randn(*s, dtype=torch.bfloat16) * 0.8)(B, Sq, D)),
            "k_cache": _w((lambda *s: torch.randn(*s, dtype=torch.bfloat16) * 0.8)(B, Hkv, Sk, Dh)),
            "v_cache": _w((lambda *s: torch.randn(*s, dtype=torch.bfloat16) * 0.05)(B, Hkv, Sk, Dh)),
            "wq": _w((lambda *s: torch.randn(*s, dtype=torch.bfloat16) * 0.8)(D, Hq * Dh) * (D ** -0.5)),
            "wo": _w((lambda *s: torch.randn(*s, dtype=torch.bfloat16) * 0.05)(Hq * Dh, D) * ((Hq * Dh) ** -0.5)),
        }
    _B_in = _B_setup()

    return {
        "A_x": _A_in["x"],
        "A_k_cache": _A_in["k_cache"],
        "A_v_cache": _A_in["v_cache"],
        "A_wq": _A_in["wq"],
        "A_wo": _A_in["wo"],
        "B_x": _B_in["x"],
        "B_k_cache": _B_in["k_cache"],
        "B_v_cache": _B_in["v_cache"],
        "B_wq": _B_in["wq"],
        "B_wo": _B_in["wo"],
    }

def reference(A_x, A_k_cache, A_v_cache, A_wq, A_wo, B_x, B_k_cache, B_v_cache, B_wq, B_wo):
    def _A_ref(x, k_cache, v_cache, wq, wo):
        B, Sq, D = x.shape
        Hq, Dh = 32, 128
        Hkv = k_cache.shape[1]
        rep = Hq // Hkv
        q = (lambda x, *d: x.permute(*d))((x @ wq).reshape(B, Sq, Hq, Dh), 0, 2, 1, 3)
        k = (lambda x, n, axis: torch.repeat_interleave(x, n, dim=axis))(k_cache, rep, axis=1)
        v = (lambda x, n, axis: torch.repeat_interleave(x, n, dim=axis))(v_cache, rep, axis=1)
        scores = torch.einsum("bhqd,bhkd->bhqk", q, k) * (Dh ** -0.5)
        p = _softmax(scores, axis=-1)
        o = torch.einsum("bhqk,bhkd->bhqd", p, v)
        return (lambda x, *d: x.permute(*d))(o, 0, 2, 1, 3).reshape(B, Sq, Hq * Dh) @ wo

    def _B_ref(x, k_cache, v_cache, wq, wo):
        B, Sq, D = x.shape
        Hq, Dh = 32, 128
        Hkv = k_cache.shape[1]
        rep = Hq // Hkv
        q = (lambda x, *d: x.permute(*d))((x @ wq).reshape(B, Sq, Hq, Dh), 0, 2, 1, 3)
        k = (lambda x, n, axis: torch.repeat_interleave(x, n, dim=axis))(k_cache, rep, axis=1)
        v = (lambda x, n, axis: torch.repeat_interleave(x, n, dim=axis))(v_cache, rep, axis=1)
        scores = torch.einsum("bhqd,bhkd->bhqk", q, k) * (Dh ** -0.5)
        p = _softmax(scores, axis=-1)
        o = torch.einsum("bhqk,bhkd->bhqd", p, v)
        return (lambda x, *d: x.permute(*d))(o, 0, 2, 1, 3).reshape(B, Sq, Hq * Dh) @ wo

    a = _A_ref(A_x, A_k_cache, A_v_cache, A_wq, A_wo)
    b = _B_ref(B_x, B_k_cache, B_v_cache, B_wq, B_wo)
    return torch.concatenate([a, b], axis=-1)
```

```asm
; @launch grid=(256,1,1) block=(512,1,1) lds=163840
.amdgcn_target "amdgcn-amd-amdhsa--gfx950"
.text
.globl concat_heads__gqa_block_cached__gqa_block_cached__near_ridge_kernel
.p2align 8
.type concat_heads__gqa_block_cached__gqa_block_cached__near_ridge_kernel,@function
concat_heads__gqa_block_cached__gqa_block_cached__near_ridge_kernel:
s_cmp_ge_u32 s2, 256
s_cbranch_scc1 L_end
s_and_b32 s4, s2, 7
s_lshr_b32 s6, s4, 2
s_mul_i32 s9, s6, 40
s_add_u32 s10, s0, s9
s_addc_u32 s11, s1, 0
s_load_dwordx4 s[12:15], s[10:11], 0
s_load_dwordx4 s[16:19], s[10:11], 16
s_load_dwordx2 s[20:21], s[10:11], 32
s_load_dwordx2 s[22:23], s[0:1], 96
s_load_dwordx4 s[96:99], s[0:1], 80
s_lshr_b32 s5, s2, 3
s_and_b32 s7, s4, 3
s_lshl_b32 s7, s7, 2
s_and_b32 s3, s5, 3
s_or_b32 s7, s7, s3
s_lshr_b32 s8, s5, 2
v_lshrrev_b32 v1, 6, v0
v_and_b32 v0, 63, v0
v_readfirstlane_b32 s24, v1
v_lshrrev_b32 v1, 2, v0
v_mul_u32_u24 v10, 1152, v1
v_lshrrev_b32 v2, 4, v0
v_and_b32 v4, 3, v0
v_xor_b32 v5, v4, v2
v_lshl_add_u32 v10, v5, 4, v10
v_lshrrev_b32 v5, 5, v0
v_lshlrev_b32 v6, 13, v5
v_and_b32 v7, 16, v0
v_lshl_add_u32 v6, v7, 4, v6
v_lshl_add_u32 v6, v4, 4, v6
v_and_b32 v7, 3, v1
v_xor_b32 v7, v7, v5
v_xor_b32 v8, 0, v7
v_lshl_add_u32 v8, v8, 6, v6
v_add_u32 v12, 0, v8
v_xor_b32 v8, 2, v7
v_lshl_add_u32 v8, v8, 6, v6
v_add_u32 v13, 15360, v8
v_xor_b32 v8, 0, v7
v_lshl_add_u32 v8, v8, 6, v6
v_add_u32 v14, 30720, v8
v_xor_b32 v8, 2, v7
v_lshl_add_u32 v8, v8, 6, v6
v_add_u32 v15, 46080, v8
s_and_b32 s27, s24, 3
s_mul_i32 s4, s8, 73728
s_mul_i32 s9, s3, 18432
s_mul_i32 s26, s27, 4608
s_add_u32 s9, s9, s26
s_add_u32 s9, s9, s4
s_mul_i32 s26, s27, 18432
s_add_u32 s4, s4, s26
s_lshl_b32 s25, s7, 9
s_lshl_b32 s26, s27, 16
s_add_u32 s25, s25, s26
s_lshl_b32 s58, s27, 12
s_lshl_b32 s59, s27, 10
s_mov_b32 s57, s8
v_lshlrev_b32 v9, 6, v0
s_waitcnt lgkmcnt(0)
s_mov_b32 s28, s12
s_and_b32 s29, s13, 0xffff
s_mov_b32 s30, 0x90000
s_mov_b32 s31, 0x20000
s_cmp_ge_u32 s24, 4
s_cbranch_scc1 L_loader
buffer_load_dword v11, v9, s[28:31], s9 offen
buffer_load_dword v11, v9, s[28:31], s9 offen offset:512
s_cmp_lg_u32 s24, 2
s_cbranch_scc1 L_now8
s_mov_b32 s40, s18
s_and_b32 s41, s19, 0xffff
s_mov_b32 s42, 0x480000
s_mov_b32 s43, 0x20000
v_lshrrev_b32 v2, 3, v0
v_lshlrev_b32 v2, 13, v2
v_and_b32 v3, 7, v0
v_lshl_add_u32 v2, v3, 6, v2
s_lshl_b32 s26, s8, 16
s_lshl_b32 s27, s7, 9
s_add_u32 s26, s26, s27
s_add_u32 s26, s26, 4194304
buffer_load_dword v11, v2, s[40:43], s26 offen
L_now8:
s_getpc_b64 s[26:27]
L_pc:
s_and_b32 s9, s5, 7
s_lshl_b32 s9, s9, 13
v_lshlrev_b32 v2, 7, v0
v_add_u32 v2, s9, v2
s_mov_b32 s9, L_hotend-L_pc-4
v_min_u32 v2, s9, v2
s_cmp_lg_u32 s24, 3
s_cbranch_scc1 L_compute
global_load_dword v47, v2, s[26:27]
s_branch L_compute
L_loader:
s_mov_b32 s40, s18
s_and_b32 s41, s19, 0xffff
s_mov_b32 s42, 0x480000
s_mov_b32 s43, 0x20000
s_lshl_b32 s55, s57, 7
s_add_u32 s55, s55, s4
s_lshl_b32 s54, s57, 19
s_add_u32 s54, s54, s25
s_add_u32 m0, s59, 81920
s_nop 0
buffer_load_dwordx4 v10, s[28:31], s55 offen  lds
s_add_u32 m0, s58, 49152
s_nop 0
buffer_load_dwordx4 v12, s[40:43], s54 offen  lds
buffer_load_dwordx4 v13, s[40:43], s54 offen offset:1024  lds
buffer_load_dwordx4 v14, s[40:43], s54 offen offset:2048  lds
buffer_load_dwordx4 v15, s[40:43], s54 offen offset:3072  lds
s_add_u32 s57, s57, 1
s_cmp_eq_u32 s57, 9
s_cselect_b32 s57, 0, s57
s_add_u32 s55, s55, 64
s_add_u32 s54, s54, 262144
s_add_u32 m0, s59, 86016
s_nop 0
buffer_load_dwordx4 v10, s[28:31], s55 offen  lds
s_add_u32 m0, s58, 65536
s_nop 0
buffer_load_dwordx4 v12, s[40:43], s54 offen  lds
buffer_load_dwordx4 v13, s[40:43], s54 offen offset:1024  lds
buffer_load_dwordx4 v14, s[40:43], s54 offen offset:2048  lds
buffer_load_dwordx4 v15, s[40:43], s54 offen offset:3072  lds
v_and_b32 v5, 15, v0
v_lshlrev_b32 v6, 8, v2
v_xor_b32 v7, v5, v2
v_xor_b32 v8, 0, v7
v_lshl_add_u32 v16, v8, 4, v6
v_xor_b32 v8, 4, v7
v_lshl_add_u32 v17, v8, 4, v6
v_xor_b32 v8, 8, v7
v_lshl_add_u32 v18, v8, 4, v6
v_xor_b32 v8, 12, v7
v_lshl_add_u32 v19, v8, 4, v6
v_lshlrev_b32 v7, 1, v2
v_xor_b32 v7, v7, v5
v_lshl_add_u32 v20, v7, 4, v6
v_xor_b32 v23, 128, v20
s_mov_b32 s32, s14
s_and_b32 s33, s15, 0xffff
s_mov_b32 s34, 0x1000000
s_mov_b32 s35, 0x20000
s_mov_b32 s36, s16
s_and_b32 s37, s17, 0xffff
s_mov_b32 s38, 0x1000000
s_mov_b32 s39, 0x20000
s_lshl_b32 s26, s8, 4
s_add_u32 s26, s26, s7
s_lshl_b32 s26, s26, 17
s_add_u32 s26, s26, s58
s_and_b32 s24, s24, 3
s_cmp_eq_u32 s3, 1
s_cbranch_scc1 L_var1
s_cmp_eq_u32 s3, 2
s_cbranch_scc1 L_var2
s_cmp_eq_u32 s3, 3
s_cbranch_scc1 L_var3
s_add_u32 m0, s58, 98304
s_add_u32 s52, s26, 0
buffer_load_dwordx4 v16, s[32:35], s52 offen nt lds
buffer_load_dwordx4 v17, s[32:35], s52 offen offset:1024 nt lds
buffer_load_dwordx4 v18, s[32:35], s52 offen offset:2048 nt lds
buffer_load_dwordx4 v19, s[32:35], s52 offen offset:3072 nt lds
s_add_u32 m0, s58, 114688
s_add_u32 s52, s26, 0
buffer_load_dwordx4 v20, s[36:39], s52 offen nt lds
buffer_load_dwordx4 v23, s[36:39], s52 offen offset:1024 nt lds
buffer_load_dwordx4 v20, s[36:39], s52 offen offset:2048 nt lds
buffer_load_dwordx4 v23, s[36:39], s52 offen offset:3072 nt lds
s_lshl_b32 s55, s57, 7
s_add_u32 s55, s55, s4
s_lshl_b32 s54, s57, 19
s_add_u32 s54, s54, s25
s_add_u32 m0, s59, 90112
s_nop 0
buffer_load_dwordx4 v10, s[28:31], s55 offen  lds
s_add_u32 m0, s58, 16384
s_nop 0
buffer_load_dwordx4 v12, s[40:43], s54 offen  lds
buffer_load_dwordx4 v13, s[40:43], s54 offen offset:1024  lds
buffer_load_dwordx4 v14, s[40:43], s54 offen offset:2048  lds
buffer_load_dwordx4 v15, s[40:43], s54 offen offset:3072  lds
s_add_u32 s57, s57, 1
s_cmp_eq_u32 s57, 9
s_cselect_b32 s57, 0, s57
s_add_u32 s55, s55, 64
s_add_u32 s54, s54, 262144
s_add_u32 m0, s59, 94208
s_nop 0
buffer_load_dwordx4 v10, s[28:31], s55 offen  lds
s_add_u32 m0, s58, 32768
s_nop 0
buffer_load_dwordx4 v12, s[40:43], s54 offen  lds
buffer_load_dwordx4 v13, s[40:43], s54 offen offset:1024  lds
buffer_load_dwordx4 v14, s[40:43], s54 offen offset:2048  lds
buffer_load_dwordx4 v15, s[40:43], s54 offen offset:3072  lds
s_waitcnt vmcnt(23)
s_barrier
s_waitcnt vmcnt(18)
s_barrier
s_lshl_b32 s55, s57, 7
s_add_u32 s55, s55, s4
s_lshl_b32 s54, s57, 19
s_add_u32 s54, s54, s25
s_add_u32 m0, s59, 81920
s_nop 0
buffer_load_dwordx4 v10, s[28:31], s55 offen  lds
s_add_u32 m0, s58, 49152
s_nop 0
buffer_load_dwordx4 v12, s[40:43], s54 offen  lds
buffer_load_dwordx4 v13, s[40:43], s54 offen offset:1024  lds
buffer_load_dwordx4 v14, s[40:43], s54 offen offset:2048  lds
buffer_load_dwordx4 v15, s[40:43], s54 offen offset:3072  lds
s_add_u32 s57, s57, 1
s_cmp_eq_u32 s57, 9
s_cselect_b32 s57, 0, s57
s_waitcnt vmcnt(10)
s_barrier
s_add_u32 s55, s55, 64
s_add_u32 s54, s54, 262144
s_add_u32 m0, s59, 86016
s_nop 0
buffer_load_dwordx4 v10, s[28:31], s55 offen  lds
s_add_u32 m0, s58, 65536
s_nop 0
buffer_load_dwordx4 v12, s[40:43], s54 offen  lds
buffer_load_dwordx4 v13, s[40:43], s54 offen offset:1024  lds
buffer_load_dwordx4 v14, s[40:43], s54 offen offset:2048  lds
buffer_load_dwordx4 v15, s[40:43], s54 offen offset:3072  lds
s_waitcnt vmcnt(10)
s_barrier
s_lshl_b32 s55, s57, 7
s_add_u32 s55, s55, s4
s_lshl_b32 s54, s57, 19
s_add_u32 s54, s54, s25
s_add_u32 m0, s59, 90112
s_nop 0
buffer_load_dwordx4 v10, s[28:31], s55 offen  lds
s_add_u32 m0, s58, 16384
s_nop 0
buffer_load_dwordx4 v12, s[40:43], s54 offen  lds
buffer_load_dwordx4 v13, s[40:43], s54 offen offset:1024  lds
buffer_load_dwordx4 v14, s[40:43], s54 offen offset:2048  lds
buffer_load_dwordx4 v15, s[40:43], s54 offen offset:3072  lds
s_add_u32 s57, s57, 1
s_cmp_eq_u32 s57, 9
s_cselect_b32 s57, 0, s57
s_waitcnt vmcnt(10)
s_barrier
s_add_u32 s55, s55, 64
s_add_u32 s54, s54, 262144
s_add_u32 m0, s59, 94208
s_nop 0
buffer_load_dwordx4 v10, s[28:31], s55 offen  lds
s_add_u32 m0, s58, 32768
s_nop 0
buffer_load_dwordx4 v12, s[40:43], s54 offen  lds
buffer_load_dwordx4 v13, s[40:43], s54 offen offset:1024  lds
buffer_load_dwordx4 v14, s[40:43], s54 offen offset:2048  lds
buffer_load_dwordx4 v15, s[40:43], s54 offen offset:3072  lds
s_add_u32 m0, s58, 131072
s_add_u32 s52, s26, 16384
buffer_load_dwordx4 v16, s[32:35], s52 offen nt lds
buffer_load_dwordx4 v17, s[32:35], s52 offen offset:1024 nt lds
buffer_load_dwordx4 v18, s[32:35], s52 offen offset:2048 nt lds
buffer_load_dwordx4 v19, s[32:35], s52 offen offset:3072 nt lds
s_add_u32 m0, s58, 147456
s_add_u32 s52, s26, 16384
buffer_load_dwordx4 v20, s[36:39], s52 offen nt lds
buffer_load_dwordx4 v23, s[36:39], s52 offen offset:1024 nt lds
buffer_load_dwordx4 v20, s[36:39], s52 offen offset:2048 nt lds
buffer_load_dwordx4 v23, s[36:39], s52 offen offset:3072 nt lds
s_waitcnt vmcnt(18)
s_barrier
s_lshl_b32 s55, s57, 7
s_add_u32 s55, s55, s4
s_lshl_b32 s54, s57, 19
s_add_u32 s54, s54, s25
s_add_u32 m0, s59, 81920
s_nop 0
buffer_load_dwordx4 v10, s[28:31], s55 offen  lds
s_add_u32 m0, s58, 49152
s_nop 0
buffer_load_dwordx4 v12, s[40:43], s54 offen  lds
buffer_load_dwordx4 v13, s[40:43], s54 offen offset:1024  lds
buffer_load_dwordx4 v14, s[40:43], s54 offen offset:2048  lds
buffer_load_dwordx4 v15, s[40:43], s54 offen offset:3072  lds
s_add_u32 s57, s57, 1
s_cmp_eq_u32 s57, 9
s_cselect_b32 s57, 0, s57
s_waitcnt vmcnt(18)
s_barrier
s_add_u32 s55, s55, 64
s_add_u32 s54, s54, 262144
s_add_u32 m0, s59, 86016
s_nop 0
buffer_load_dwordx4 v10, s[28:31], s55 offen  lds
s_add_u32 m0, s58, 65536
s_nop 0
buffer_load_dwordx4 v12, s[40:43], s54 offen  lds
buffer_load_dwordx4 v13, s[40:43], s54 offen offset:1024  lds
buffer_load_dwordx4 v14, s[40:43], s54 offen offset:2048  lds
buffer_load_dwordx4 v15, s[40:43], s54 offen offset:3072  lds
s_waitcnt vmcnt(18)
s_barrier
s_lshl_b32 s55, s57, 7
s_add_u32 s55, s55, s4
s_lshl_b32 s54, s57, 19
s_add_u32 s54, s54, s25
s_add_u32 m0, s59, 90112
s_nop 0
buffer_load_dwordx4 v10, s[28:31], s55 offen  lds
s_add_u32 m0, s58, 16384
s_nop 0
buffer_load_dwordx4 v12, s[40:43], s54 offen  lds
buffer_load_dwordx4 v13, s[40:43], s54 offen offset:1024  lds
buffer_load_dwordx4 v14, s[40:43], s54 offen offset:2048  lds
buffer_load_dwordx4 v15, s[40:43], s54 offen offset:3072  lds
s_add_u32 s57, s57, 1
s_cmp_eq_u32 s57, 9
s_cselect_b32 s57, 0, s57
s_waitcnt vmcnt(10)
s_barrier
s_add_u32 s55, s55, 64
s_add_u32 s54, s54, 262144
s_add_u32 m0, s59, 94208
s_nop 0
buffer_load_dwordx4 v10, s[28:31], s55 offen  lds
s_add_u32 m0, s58, 32768
s_nop 0
buffer_load_dwordx4 v12, s[40:43], s54 offen  lds
buffer_load_dwordx4 v13, s[40:43], s54 offen offset:1024  lds
buffer_load_dwordx4 v14, s[40:43], s54 offen offset:2048  lds
buffer_load_dwordx4 v15, s[40:43], s54 offen offset:3072  lds
s_waitcnt vmcnt(10)
s_barrier
s_lshl_b32 s55, s57, 7
s_add_u32 s55, s55, s4
s_lshl_b32 s54, s57, 19
s_add_u32 s54, s54, s25
s_add_u32 m0, s59, 81920
s_nop 0
buffer_load_dwordx4 v10, s[28:31], s55 offen  lds
s_add_u32 m0, s58, 49152
s_nop 0
buffer_load_dwordx4 v12, s[40:43], s54 offen  lds
buffer_load_dwordx4 v13, s[40:43], s54 offen offset:1024  lds
buffer_load_dwordx4 v14, s[40:43], s54 offen offset:2048  lds
buffer_load_dwordx4 v15, s[40:43], s54 offen offset:3072  lds
s_add_u32 s57, s57, 1
s_cmp_eq_u32 s57, 9
s_cselect_b32 s57, 0, s57
s_waitcnt vmcnt(10)
s_barrier
s_add_u32 s55, s55, 64
s_add_u32 s54, s54, 262144
s_add_u32 m0, s59, 86016
s_nop 0
buffer_load_dwordx4 v10, s[28:31], s55 offen  lds
s_add_u32 m0, s58, 65536
s_nop 0
buffer_load_dwordx4 v12, s[40:43], s54 offen  lds
buffer_load_dwordx4 v13, s[40:43], s54 offen offset:1024  lds
buffer_load_dwordx4 v14, s[40:43], s54 offen offset:2048  lds
buffer_load_dwordx4 v15, s[40:43], s54 offen offset:3072  lds
s_add_u32 m0, s58, 0
s_add_u32 s52, s26, 32768
buffer_load_dwordx4 v16, s[32:35], s52 offen nt lds
buffer_load_dwordx4 v17, s[32:35], s52 offen offset:1024 nt lds
buffer_load_dwordx4 v18, s[32:35], s52 offen offset:2048 nt lds
buffer_load_dwordx4 v19, s[32:35], s52 offen offset:3072 nt lds
s_waitcnt vmcnt(14)
s_barrier
s_lshl_b32 s55, s57, 7
s_add_u32 s55, s55, s4
s_lshl_b32 s54, s57, 19
s_add_u32 s54, s54, s25
s_add_u32 m0, s59, 90112
s_nop 0
buffer_load_dwordx4 v10, s[28:31], s55 offen  lds
s_add_u32 m0, s58, 16384
s_nop 0
buffer_load_dwordx4 v12, s[40:43], s54 offen  lds
buffer_load_dwordx4 v13, s[40:43], s54 offen offset:1024  lds
buffer_load_dwordx4 v14, s[40:43], s54 offen offset:2048  lds
buffer_load_dwordx4 v15, s[40:43], s54 offen offset:3072  lds
s_add_u32 s57, s57, 1
s_cmp_eq_u32 s57, 9
s_cselect_b32 s57, 0, s57
s_waitcnt vmcnt(14)
s_barrier
s_add_u32 s55, s55, 64
s_add_u32 s54, s54, 262144
s_add_u32 m0, s59, 94208
s_nop 0
buffer_load_dwordx4 v10, s[28:31], s55 offen  lds
s_add_u32 m0, s58, 32768
s_nop 0
buffer_load_dwordx4 v12, s[40:43], s54 offen  lds
buffer_load_dwordx4 v13, s[40:43], s54 offen offset:1024  lds
buffer_load_dwordx4 v14, s[40:43], s54 offen offset:2048  lds
buffer_load_dwordx4 v15, s[40:43], s54 offen offset:3072  lds
s_waitcnt vmcnt(14)
s_barrier
s_lshl_b32 s55, s57, 7
s_add_u32 s55, s55, s4
s_lshl_b32 s54, s57, 19
s_add_u32 s54, s54, s25
s_add_u32 m0, s59, 81920
s_nop 0
buffer_load_dwordx4 v10, s[28:31], s55 offen  lds
s_add_u32 m0, s58, 49152
s_nop 0
buffer_load_dwordx4 v12, s[40:43], s54 offen  lds
buffer_load_dwordx4 v13, s[40:43], s54 offen offset:1024  lds
buffer_load_dwordx4 v14, s[40:43], s54 offen offset:2048  lds
buffer_load_dwordx4 v15, s[40:43], s54 offen offset:3072  lds
s_add_u32 s57, s57, 1
s_cmp_eq_u32 s57, 9
s_cselect_b32 s57, 0, s57
s_waitcnt vmcnt(10)
s_barrier
s_add_u32 s55, s55, 64
s_add_u32 s54, s54, 262144
s_add_u32 m0, s59, 86016
s_nop 0
buffer_load_dwordx4 v10, s[28:31], s55 offen  lds
s_add_u32 m0, s58, 65536
s_nop 0
buffer_load_dwordx4 v12, s[40:43], s54 offen  lds
buffer_load_dwordx4 v13, s[40:43], s54 offen offset:1024  lds
buffer_load_dwordx4 v14, s[40:43], s54 offen offset:2048  lds
buffer_load_dwordx4 v15, s[40:43], s54 offen offset:3072  lds
s_mov_b32 s57, s8
s_waitcnt vmcnt(10)
s_barrier
s_add_u32 m0, s58, 16384
s_add_u32 s52, s26, 32768
buffer_load_dwordx4 v20, s[36:39], s52 offen nt lds
buffer_load_dwordx4 v23, s[36:39], s52 offen offset:1024 nt lds
buffer_load_dwordx4 v20, s[36:39], s52 offen offset:2048 nt lds
buffer_load_dwordx4 v23, s[36:39], s52 offen offset:3072 nt lds
s_waitcnt vmcnt(9)
s_barrier
s_waitcnt vmcnt(4)
s_barrier
s_barrier
s_add_u32 m0, s58, 32768
s_add_u32 s52, s26, 49152
buffer_load_dwordx4 v16, s[32:35], s52 offen nt lds
buffer_load_dwordx4 v17, s[32:35], s52 offen offset:1024 nt lds
buffer_load_dwordx4 v18, s[32:35], s52 offen offset:2048 nt lds
buffer_load_dwordx4 v19, s[32:35], s52 offen offset:3072 nt lds
s_barrier
s_add_u32 m0, s58, 49152
s_add_u32 s52, s26, 49152
buffer_load_dwordx4 v20, s[36:39], s52 offen nt lds
buffer_load_dwordx4 v23, s[36:39], s52 offen offset:1024 nt lds
buffer_load_dwordx4 v20, s[36:39], s52 offen offset:2048 nt lds
buffer_load_dwordx4 v23, s[36:39], s52 offen offset:3072 nt lds
s_barrier
s_add_u32 m0, s58, 65536
s_add_u32 s52, s26, 65536
buffer_load_dwordx4 v16, s[32:35], s52 offen nt lds
buffer_load_dwordx4 v17, s[32:35], s52 offen offset:1024 nt lds
buffer_load_dwordx4 v18, s[32:35], s52 offen offset:2048 nt lds
buffer_load_dwordx4 v19, s[32:35], s52 offen offset:3072 nt lds
v_lshrrev_b32 v5, 3, v0
v_mul_u32_u24 v6, 1152, v5
v_xor_b32 v7, v1, v2
v_and_b32 v7, 1, v7
v_lshl_add_u32 v6, v7, 6, v6
v_lshl_add_u32 v6, v4, 4, v6
v_add_u32 v24, 0, v6
v_add_u32 v25, 8192, v6
v_add_u32 v26, 16384, v6
v_add_u32 v27, 24576, v6
s_lshl_b32 s27, s7, 8
s_lshl_b32 s9, s24, 5
s_add_u32 s27, s27, s9
s_xor_b32 s25, s27, 256
s_mul_i32 s25, s25, 1152
s_and_b32 s57, s7, 1
s_lshl_b32 s57, s57, 2
s_add_u32 s57, s57, s8
v_lshlrev_b32 v63, 4, v0
s_mul_i32 s27, s27, 1152
v_lshlrev_b32 v21, 7, v0
v_min_u32 v22, 7, v0
v_lshlrev_b32 v22, 7, v22
v_add_u32 v22, 8192, v22
s_mov_b32 s44, s20
s_and_b32 s45, s21, 0xffff
s_mov_b32 s46, 0x480000
s_mov_b32 s47, 0x20000
s_mov_b32 s48, s22
s_and_b32 s49, s23, 0xffff
s_mov_b32 s50, 0x10000000
s_mov_b32 s51, 0x20000
s_mov_b32 s92, s96
s_and_b32 s93, s97, 0xffff
s_mov_b32 s94, 0x120000
s_mov_b32 s95, 0x20000
s_lshl_b32 s9, s6, 3
s_add_u32 s9, s9, s8
s_mul_i32 s56, s9, 0x200000
s_lshl_b32 s11, s9, 4
s_add_u32 s100, s98, s11
s_addc_u32 s101, s99, 0
s_mov_b32 s96, s98
s_and_b32 s97, s99, 0xffff
s_mov_b32 s98, 0x100
s_mov_b32 s99, 0x20000
v_and_b32 v6, 15, v0
v_lshlrev_b32 v28, 4, v6
v_lshl_add_u32 v28, v2, 11, v28
s_lshr_b32 s9, s24, 1
s_and_b32 s5, s24, 1
s_lshl_b32 s10, s5, 8
v_add_u32 v28, s10, v28
s_lshl_b32 s53, s9, 30
v_add_u32 v31, s53, v28
s_barrier
s_barrier
s_add_u32 m0, s58, 81920
s_add_u32 s52, s26, 65536
buffer_load_dwordx4 v20, s[36:39], s52 offen nt lds
buffer_load_dwordx4 v23, s[36:39], s52 offen offset:1024 nt lds
buffer_load_dwordx4 v20, s[36:39], s52 offen offset:2048 nt lds
buffer_load_dwordx4 v23, s[36:39], s52 offen offset:3072 nt lds
v_lshlrev_b32 v29, 4, v2
v_and_b32 v7, 7, v0
v_mul_u32_u24 v30, 2304, v7
v_and_b32 v7, 8, v0
v_lshl_add_u32 v30, v7, 1, v30
v_and_b32 v7, 16, v0
v_lshrrev_b32 v7, 1, v7
v_add_u32 v30, v7, v30
s_lshl_b32 s5, s5, 5
v_add_u32 v30, s5, v30
s_add_u32 s12, s8, s9
s_cmp_ge_u32 s12, 9
s_cselect_b32 s10, 9, 0
s_sub_u32 s12, s12, s10
s_add_u32 s13, s12, 2
s_cmp_ge_u32 s13, 9
s_cselect_b32 s10, 9, 0
s_sub_u32 s13, s13, s10
s_add_u32 s14, s13, 2
s_cmp_ge_u32 s14, 9
s_cselect_b32 s10, 9, 0
s_sub_u32 s14, s14, s10
s_add_u32 s15, s14, 2
s_cmp_ge_u32 s15, 9
s_cselect_b32 s10, 9, 0
s_sub_u32 s15, s15, s10
s_add_u32 s16, s15, 2
s_cmp_ge_u32 s16, 9
s_cselect_b32 s10, 9, 0
s_sub_u32 s16, s16, s10
s_lshl_b32 s10, s7, 13
s_add_u32 s10, s10, s56
s_lshl_b32 s20, s12, 17
s_add_u32 s20, s20, s10
s_lshl_b32 s12, s12, 7
s_lshl_b32 s21, s13, 17
s_add_u32 s21, s21, s10
s_lshl_b32 s13, s13, 7
s_lshl_b32 s22, s14, 17
s_add_u32 s22, s22, s10
s_lshl_b32 s14, s14, 7
s_lshl_b32 s23, s15, 17
s_add_u32 s23, s23, s10
s_lshl_b32 s15, s15, 7
s_lshl_b32 s4, s16, 17
s_add_u32 s4, s4, s10
s_lshl_b32 s16, s16, 7
s_or_b32 s16, s16, s53
v_cmp_gt_u32 vcc, 32, v0
v_mov_b32 v7, s12
v_mov_b32 v8, s13
v_cndmask_b32 v7, v8, v7, vcc
v_add_u32 v41, v7, v30
v_mov_b32 v7, s14
v_mov_b32 v8, s15
v_cndmask_b32 v7, v8, v7, vcc
v_add_u32 v42, v7, v30
v_mov_b32 v7, s16
v_mov_b32 v8, 0x40000000
v_cndmask_b32 v7, v8, v7, vcc
v_add_u32 v43, v7, v30
s_waitcnt vmcnt(16)
s_barrier
s_waitcnt vmcnt(12)
s_barrier
s_add_u32 m0, s58, 98304
s_add_u32 s52, s26, 81920
buffer_load_dwordx4 v16, s[32:35], s52 offen nt lds
buffer_load_dwordx4 v17, s[32:35], s52 offen offset:1024 nt lds
buffer_load_dwordx4 v18, s[32:35], s52 offen offset:2048 nt lds
buffer_load_dwordx4 v19, s[32:35], s52 offen offset:3072 nt lds
v_and_b32 v7, 1, v0
v_lshlrev_b32 v7, 4, v7
v_mov_b32 v8, 0x3f80
v_lshlrev_b32 v8, v7, v8
v_lshrrev_b32 v6, 1, v6
v_cmp_eq_u32 vcc, 0, v6
s_nop 1
v_cndmask_b32 v32, 0, v8, vcc
v_cmp_eq_u32 vcc, 1, v6
s_nop 1
v_cndmask_b32 v33, 0, v8, vcc
v_cmp_eq_u32 vcc, 2, v6
s_nop 1
v_cndmask_b32 v34, 0, v8, vcc
v_cmp_eq_u32 vcc, 3, v6
s_nop 1
v_cndmask_b32 v35, 0, v8, vcc
v_cmp_eq_u32 vcc, 4, v6
s_nop 1
v_cndmask_b32 v44, 0, v8, vcc
v_cmp_eq_u32 vcc, 5, v6
s_nop 1
v_cndmask_b32 v45, 0, v8, vcc
v_cmp_eq_u32 vcc, 6, v6
s_nop 1
v_cndmask_b32 v46, 0, v8, vcc
v_cmp_eq_u32 vcc, 7, v6
s_nop 1
v_cndmask_b32 v47, 0, v8, vcc
s_lshr_b32 s5, s11, 4
s_mul_i32 s5, s5, 0x1000
s_lshl_b32 s9, s7, 7
s_add_u32 s5, s5, 0xc000000
s_add_u32 s5, s5, s9
s_lshl_b32 s9, s24, 2
s_add_u32 s55, s5, s9
s_add_u32 s55, s55, 0x800
s_xor_b32 s9, s7, 1
s_lshl_b32 s9, s9, 2
s_add_u32 s9, s9, s24
s_lshl_b32 s9, s9, 13
s_add_u32 s54, s56, s9
s_add_u32 s54, s54, 0x140000
s_lshl_b32 s9, s7, 9
s_add_u32 s3, s56, s9
s_lshr_b32 s9, s7, 1
s_lshl_b32 s10, s8, 3
s_add_u32 s9, s9, s10
s_mul_i32 s10, s9, 18432
s_mul_i32 s9, s6, 1152
s_add_u32 s10, s10, s9
s_and_b32 s9, s7, 1
s_lshl_b32 s9, s9, 6
s_add_u32 s10, s10, s9
v_bfe_u32 v7, v0, 3, 2
v_lshlrev_b32 v36, 14, v7
v_lshrrev_b32 v7, 5, v0
v_lshl_add_u32 v36, v7, 7, v36
v_and_b32 v7, 7, v0
v_lshl_add_u32 v36, v7, 4, v36
s_and_b32 s9, s24, 1
s_lshl_b32 s9, s9, 16
s_lshr_b32 s52, s24, 1
s_lshl_b32 s52, s52, 13
s_add_u32 s9, s9, s52
v_add_u32 v36, s9, v36
v_mov_b32 v37, 0
v_mov_b32 v56, 0
v_mov_b32 v57, 0
v_mov_b32 v58, 0
v_mov_b32 v59, 0
v_lshlrev_b32 v52, 1, v2
v_add_u32 v52, 131136, v52
v_mov_b32 v51, 131136
s_waitcnt vmcnt(12)
s_barrier
s_add_u32 m0, s58, 114688
s_add_u32 s52, s26, 81920
buffer_load_dwordx4 v20, s[36:39], s52 offen nt lds
buffer_load_dwordx4 v23, s[36:39], s52 offen offset:1024 nt lds
buffer_load_dwordx4 v20, s[36:39], s52 offen offset:2048 nt lds
buffer_load_dwordx4 v23, s[36:39], s52 offen offset:3072 nt lds
s_waitcnt vmcnt(12)
s_barrier
s_add_u32 m0, s58, 131072
s_add_u32 s52, s26, 98304
buffer_load_dwordx4 v16, s[32:35], s52 offen nt lds
buffer_load_dwordx4 v17, s[32:35], s52 offen offset:1024 nt lds
buffer_load_dwordx4 v18, s[32:35], s52 offen offset:2048 nt lds
buffer_load_dwordx4 v19, s[32:35], s52 offen offset:3072 nt lds
s_mov_b32 s6, 1
s_cmp_lg_u32 s24, 0
s_cbranch_scc1 L_nochk0
s_load_dword s6, s[100:101], 0
L_nochk0:
s_waitcnt vmcnt(12)
s_barrier
s_add_u32 m0, s58, 147456
s_add_u32 s52, s26, 98304
buffer_load_dwordx4 v20, s[36:39], s52 offen nt lds
buffer_load_dwordx4 v23, s[36:39], s52 offen offset:1024 nt lds
buffer_load_dwordx4 v20, s[36:39], s52 offen offset:2048 nt lds
buffer_load_dwordx4 v23, s[36:39], s52 offen offset:3072 nt lds
s_waitcnt vmcnt(12)
s_barrier
s_add_u32 m0, s58, 0
s_add_u32 s52, s26, 114688
buffer_load_dwordx4 v16, s[32:35], s52 offen nt lds
buffer_load_dwordx4 v17, s[32:35], s52 offen offset:1024 nt lds
buffer_load_dwordx4 v18, s[32:35], s52 offen offset:2048 nt lds
buffer_load_dwordx4 v19, s[32:35], s52 offen offset:3072 nt lds
s_waitcnt vmcnt(12)
s_barrier
s_add_u32 m0, s58, 16384
s_add_u32 s52, s26, 114688
buffer_load_dwordx4 v20, s[36:39], s52 offen nt lds
buffer_load_dwordx4 v23, s[36:39], s52 offen offset:1024 nt lds
buffer_load_dwordx4 v20, s[36:39], s52 offen offset:2048 nt lds
buffer_load_dwordx4 v23, s[36:39], s52 offen offset:3072 nt lds
s_waitcnt vmcnt(12)
s_barrier
s_add_u32 m0, s58, 32768
s_add_u32 s53, s8, 8
s_cmp_ge_u32 s53, 9
s_cselect_b32 s52, 9, 0
s_sub_u32 s53, s53, s52
s_lshl_b32 s53, s53, 7
s_add_u32 s53, s53, s27
buffer_load_dwordx4 v24, s[44:47], s53 offen  lds
buffer_load_dwordx4 v25, s[44:47], s53 offen offset:1024  lds
buffer_load_dwordx4 v26, s[44:47], s53 offen offset:2048  lds
buffer_load_dwordx4 v27, s[44:47], s53 offen offset:3072  lds
s_waitcnt lgkmcnt(0)
s_cmp_eq_u32 s6, 1
s_cbranch_scc0 L_hs0
L_hsback0:
s_waitcnt vmcnt(12)
s_barrier
s_add_u32 m0, s58, 49152
s_add_u32 s53, s53, 147456
buffer_load_dwordx4 v24, s[44:47], s53 offen  lds
buffer_load_dwordx4 v25, s[44:47], s53 offen offset:1024  lds
buffer_load_dwordx4 v26, s[44:47], s53 offen offset:2048  lds
buffer_load_dwordx4 v27, s[44:47], s53 offen offset:3072  lds
s_waitcnt vmcnt(12)
s_barrier
s_add_u32 m0, s58, 65536
s_add_u32 s53, s57, 0
s_cmp_ge_u32 s53, 9
s_cselect_b32 s52, 9, 0
s_sub_u32 s53, s53, s52
s_lshl_b32 s53, s53, 7
s_add_u32 s53, s53, s27
buffer_load_dwordx4 v24, s[44:47], s53 offen  lds
buffer_load_dwordx4 v25, s[44:47], s53 offen offset:1024  lds
buffer_load_dwordx4 v26, s[44:47], s53 offen offset:2048  lds
buffer_load_dwordx4 v27, s[44:47], s53 offen offset:3072  lds
s_waitcnt vmcnt(12)
s_barrier
s_add_u32 m0, s58, 81920
s_add_u32 s53, s53, 147456
buffer_load_dwordx4 v24, s[44:47], s53 offen  lds
buffer_load_dwordx4 v25, s[44:47], s53 offen offset:1024  lds
buffer_load_dwordx4 v26, s[44:47], s53 offen offset:2048  lds
buffer_load_dwordx4 v27, s[44:47], s53 offen offset:3072  lds
s_waitcnt vmcnt(8)
s_barrier
s_add_u32 m0, s58, 98304
s_add_u32 s53, s57, 1
s_cmp_ge_u32 s53, 9
s_cselect_b32 s52, 9, 0
s_sub_u32 s53, s53, s52
s_lshl_b32 s53, s53, 7
s_add_u32 s53, s53, s27
buffer_load_dwordx4 v24, s[44:47], s53 offen  lds
buffer_load_dwordx4 v25, s[44:47], s53 offen offset:1024  lds
buffer_load_dwordx4 v26, s[44:47], s53 offen offset:2048  lds
buffer_load_dwordx4 v27, s[44:47], s53 offen offset:3072  lds
s_add_u32 m0, s58, 114688
s_add_u32 s53, s53, 147456
buffer_load_dwordx4 v24, s[44:47], s53 offen  lds
buffer_load_dwordx4 v25, s[44:47], s53 offen offset:1024  lds
buffer_load_dwordx4 v26, s[44:47], s53 offen offset:2048  lds
buffer_load_dwordx4 v27, s[44:47], s53 offen offset:3072  lds
s_barrier
s_buffer_load_dword s1, s[48:51], s55 glc
s_add_u32 m0, s58, 0
s_add_u32 s53, s57, 2
s_cmp_ge_u32 s53, 9
s_cselect_b32 s52, 9, 0
s_sub_u32 s53, s53, s52
s_lshl_b32 s53, s53, 7
s_add_u32 s53, s53, s27
buffer_load_dwordx4 v24, s[44:47], s53 offen  lds
buffer_load_dwordx4 v25, s[44:47], s53 offen offset:1024  lds
buffer_load_dwordx4 v26, s[44:47], s53 offen offset:2048  lds
buffer_load_dwordx4 v27, s[44:47], s53 offen offset:3072  lds
s_add_u32 m0, s58, 16384
s_add_u32 s53, s53, 147456
buffer_load_dwordx4 v24, s[44:47], s53 offen  lds
buffer_load_dwordx4 v25, s[44:47], s53 offen offset:1024  lds
buffer_load_dwordx4 v26, s[44:47], s53 offen offset:2048  lds
buffer_load_dwordx4 v27, s[44:47], s53 offen offset:3072  lds
s_waitcnt vmcnt(16)
s_barrier
s_waitcnt lgkmcnt(0)
s_cmp_eq_u32 s1, 1
s_cbranch_scc1 L_ze0
s_buffer_load_dword s1, s[48:51], s55 glc
s_add_u32 m0, s58, 32768
s_add_u32 s53, s57, 3
s_cmp_ge_u32 s53, 9
s_cselect_b32 s52, 9, 0
s_sub_u32 s53, s53, s52
s_lshl_b32 s53, s53, 7
s_add_u32 s53, s53, s27
buffer_load_dwordx4 v24, s[44:47], s53 offen  lds
buffer_load_dwordx4 v25, s[44:47], s53 offen offset:1024  lds
buffer_load_dwordx4 v26, s[44:47], s53 offen offset:2048  lds
buffer_load_dwordx4 v27, s[44:47], s53 offen offset:3072  lds
s_add_u32 m0, s58, 49152
s_add_u32 s53, s53, 147456
buffer_load_dwordx4 v24, s[44:47], s53 offen  lds
buffer_load_dwordx4 v25, s[44:47], s53 offen offset:1024  lds
buffer_load_dwordx4 v26, s[44:47], s53 offen offset:2048  lds
buffer_load_dwordx4 v27, s[44:47], s53 offen offset:3072  lds
s_waitcnt vmcnt(16)
s_barrier
s_waitcnt lgkmcnt(0)
s_cmp_eq_u32 s1, 1
s_cbranch_scc1 L_ze1
s_add_u32 m0, s58, 65536
s_add_u32 s53, s57, 0
s_cmp_ge_u32 s53, 9
s_cselect_b32 s52, 9, 0
s_sub_u32 s53, s53, s52
s_lshl_b32 s53, s53, 7
s_add_u32 s53, s53, s25
buffer_load_dwordx4 v24, s[44:47], s53 offen  lds
buffer_load_dwordx4 v25, s[44:47], s53 offen offset:1024  lds
buffer_load_dwordx4 v26, s[44:47], s53 offen offset:2048  lds
buffer_load_dwordx4 v27, s[44:47], s53 offen offset:3072  lds
s_add_u32 m0, s58, 81920
s_add_u32 s53, s53, 147456
buffer_load_dwordx4 v24, s[44:47], s53 offen  lds
buffer_load_dwordx4 v25, s[44:47], s53 offen offset:1024  lds
buffer_load_dwordx4 v26, s[44:47], s53 offen offset:2048  lds
buffer_load_dwordx4 v27, s[44:47], s53 offen offset:3072  lds
s_waitcnt vmcnt(16)
s_barrier
s_add_u32 m0, s58, 98304
s_add_u32 s53, s57, 1
s_cmp_ge_u32 s53, 9
s_cselect_b32 s52, 9, 0
s_sub_u32 s53, s53, s52
s_lshl_b32 s53, s53, 7
s_add_u32 s53, s53, s25
buffer_load_dwordx4 v24, s[44:47], s53 offen  lds
buffer_load_dwordx4 v25, s[44:47], s53 offen offset:1024  lds
buffer_load_dwordx4 v26, s[44:47], s53 offen offset:2048  lds
buffer_load_dwordx4 v27, s[44:47], s53 offen offset:3072  lds
s_add_u32 m0, s58, 114688
s_add_u32 s53, s53, 147456
buffer_load_dwordx4 v24, s[44:47], s53 offen  lds
buffer_load_dwordx4 v25, s[44:47], s53 offen offset:1024  lds
buffer_load_dwordx4 v26, s[44:47], s53 offen offset:2048  lds
buffer_load_dwordx4 v27, s[44:47], s53 offen offset:3072  lds
s_mov_b32 s52, 0
L_zp13:
s_buffer_load_dword s9, s[48:51], s55 glc
s_add_u32 s52, s52, 1
s_waitcnt lgkmcnt(0)
s_cmp_eq_u32 s9, 1
s_cbranch_scc1 L_zok13
s_cmp_lt_u32 s52, 64
s_cbranch_scc1 L_zp13
s_branch L_zv13
L_zok13:
s_lshl_b32 s9, s58, 1
s_add_u32 m0, s9, 131072
s_nop 0
buffer_load_dwordx4 v63, s[48:51], s54 offen sc1 lds
buffer_load_dwordx4 v63, s[48:51], s54 offen offset:1024 sc1 lds
buffer_load_dwordx4 v63, s[48:51], s54 offen offset:2048 sc1 lds
buffer_load_dwordx4 v63, s[48:51], s54 offen offset:3072 sc1 lds
s_lshl_b32 s9, s58, 1
s_add_u32 m0, s9, 135168
s_add_u32 s54, s54, 4096
buffer_load_dwordx4 v63, s[48:51], s54 offen sc1 lds
buffer_load_dwordx4 v63, s[48:51], s54 offen offset:1024 sc1 lds
buffer_load_dwordx4 v63, s[48:51], s54 offen offset:2048 sc1 lds
buffer_load_dwordx4 v63, s[48:51], s54 offen offset:3072 sc1 lds
s_waitcnt vmcnt(24)
s_barrier
s_add_u32 m0, s58, 0
s_add_u32 s53, s57, 2
s_cmp_ge_u32 s53, 9
s_cselect_b32 s52, 9, 0
s_sub_u32 s53, s53, s52
s_lshl_b32 s53, s53, 7
s_add_u32 s53, s53, s25
buffer_load_dwordx4 v24, s[44:47], s53 offen  lds
buffer_load_dwordx4 v25, s[44:47], s53 offen offset:1024  lds
buffer_load_dwordx4 v26, s[44:47], s53 offen offset:2048  lds
buffer_load_dwordx4 v27, s[44:47], s53 offen offset:3072  lds
s_add_u32 m0, s58, 16384
s_add_u32 s53, s53, 147456
buffer_load_dwordx4 v24, s[44:47], s53 offen  lds
buffer_load_dwordx4 v25, s[44:47], s53 offen offset:1024  lds
buffer_load_dwordx4 v26, s[44:47], s53 offen offset:2048  lds
buffer_load_dwordx4 v27, s[44:47], s53 offen offset:3072  lds
s_waitcnt vmcnt(8)
s_barrier
s_add_u32 m0, s58, 32768
s_add_u32 s53, s57, 3
s_cmp_ge_u32 s53, 9
s_cselect_b32 s52, 9, 0
s_sub_u32 s53, s53, s52
s_lshl_b32 s53, s53, 7
s_add_u32 s53, s53, s25
buffer_load_dwordx4 v24, s[44:47], s53 offen  lds
buffer_load_dwordx4 v25, s[44:47], s53 offen offset:1024  lds
buffer_load_dwordx4 v26, s[44:47], s53 offen offset:2048  lds
buffer_load_dwordx4 v27, s[44:47], s53 offen offset:3072  lds
s_add_u32 m0, s58, 49152
s_add_u32 s53, s53, 147456
buffer_load_dwordx4 v24, s[44:47], s53 offen  lds
buffer_load_dwordx4 v25, s[44:47], s53 offen offset:1024  lds
buffer_load_dwordx4 v26, s[44:47], s53 offen offset:2048  lds
buffer_load_dwordx4 v27, s[44:47], s53 offen offset:3072  lds
s_barrier
s_waitcnt vmcnt(8)
s_barrier
ds_write_b128 v51, v[56:59]
ds_write_b128 v51, v[56:59] offset:16
s_waitcnt lgkmcnt(0)
s_waitcnt vmcnt(0)
s_barrier
s_branch L_ltail
L_var1:
s_lshl_b32 s55, s57, 7
s_add_u32 s55, s55, s4
s_lshl_b32 s54, s57, 19
s_add_u32 s54, s54, s25
s_add_u32 m0, s59, 90112
s_nop 0
buffer_load_dwordx4 v10, s[28:31], s55 offen  lds
s_add_u32 m0, s58, 16384
s_nop 0
buffer_load_dwordx4 v12, s[40:43], s54 offen  lds
buffer_load_dwordx4 v13, s[40:43], s54 offen offset:1024  lds
buffer_load_dwordx4 v14, s[40:43], s54 offen offset:2048  lds
buffer_load_dwordx4 v15, s[40:43], s54 offen offset:3072  lds
s_add_u32 s57, s57, 1
s_cmp_eq_u32 s57, 9
s_cselect_b32 s57, 0, s57
s_add_u32 s55, s55, 64
s_add_u32 s54, s54, 262144
s_add_u32 m0, s59, 94208
s_nop 0
buffer_load_dwordx4 v10, s[28:31], s55 offen  lds
s_add_u32 m0, s58, 32768
s_nop 0
buffer_load_dwordx4 v12, s[40:43], s54 offen  lds
buffer_load_dwordx4 v13, s[40:43], s54 offen offset:1024  lds
buffer_load_dwordx4 v14, s[40:43], s54 offen offset:2048  lds
buffer_load_dwordx4 v15, s[40:43], s54 offen offset:3072  lds
s_add_u32 m0, s58, 98304
s_add_u32 s52, s26, 0
buffer_load_dwordx4 v16, s[32:35], s52 offen nt lds
buffer_load_dwordx4 v17, s[32:35], s52 offen offset:1024 nt lds
buffer_load_dwordx4 v18, s[32:35], s52 offen offset:2048 nt lds
buffer_load_dwordx4 v19, s[32:35], s52 offen offset:3072 nt lds
s_add_u32 m0, s58, 114688
s_add_u32 s52, s26, 0
buffer_load_dwordx4 v20, s[36:39], s52 offen nt lds
buffer_load_dwordx4 v23, s[36:39], s52 offen offset:1024 nt lds
buffer_load_dwordx4 v20, s[36:39], s52 offen offset:2048 nt lds
buffer_load_dwordx4 v23, s[36:39], s52 offen offset:3072 nt lds
s_waitcnt vmcnt(23)
s_barrier
s_waitcnt vmcnt(18)
s_barrier
s_lshl_b32 s55, s57, 7
s_add_u32 s55, s55, s4
s_lshl_b32 s54, s57, 19
s_add_u32 s54, s54, s25
s_add_u32 m0, s59, 81920
s_nop 0
buffer_load_dwordx4 v10, s[28:31], s55 offen  lds
s_add_u32 m0, s58, 49152
s_nop 0
buffer_load_dwordx4 v12, s[40:43], s54 offen  lds
buffer_load_dwordx4 v13, s[40:43], s54 offen offset:1024  lds
buffer_load_dwordx4 v14, s[40:43], s54 offen offset:2048  lds
buffer_load_dwordx4 v15, s[40:43], s54 offen offset:3072  lds
s_add_u32 s57, s57, 1
s_cmp_eq_u32 s57, 9
s_cselect_b32 s57, 0, s57
s_waitcnt vmcnt(18)
s_barrier
s_add_u32 s55, s55, 64
s_add_u32 s54, s54, 262144
s_add_u32 m0, s59, 86016
s_nop 0
buffer_load_dwordx4 v10, s[28:31], s55 offen  lds
s_add_u32 m0, s58, 65536
s_nop 0
buffer_load_dwordx4 v12, s[40:43], s54 offen  lds
buffer_load_dwordx4 v13, s[40:43], s54 offen offset:1024  lds
buffer_load_dwordx4 v14, s[40:43], s54 offen offset:2048  lds
buffer_load_dwordx4 v15, s[40:43], s54 offen offset:3072  lds
s_waitcnt vmcnt(18)
s_barrier
s_lshl_b32 s55, s57, 7
s_add_u32 s55, s55, s4
s_lshl_b32 s54, s57, 19
s_add_u32 s54, s54, s25
s_add_u32 m0, s59, 90112
s_nop 0
buffer_load_dwordx4 v10, s[28:31], s55 offen  lds
s_add_u32 m0, s58, 16384
s_nop 0
buffer_load_dwordx4 v12, s[40:43], s54 offen  lds
buffer_load_dwordx4 v13, s[40:43], s54 offen offset:1024  lds
buffer_load_dwordx4 v14, s[40:43], s54 offen offset:2048  lds
buffer_load_dwordx4 v15, s[40:43], s54 offen offset:3072  lds
s_add_u32 s57, s57, 1
s_cmp_eq_u32 s57, 9
s_cselect_b32 s57, 0, s57
s_waitcnt vmcnt(10)
s_barrier
s_add_u32 s55, s55, 64
s_add_u32 s54, s54, 262144
s_add_u32 m0, s59, 94208
s_nop 0
buffer_load_dwordx4 v10, s[28:31], s55 offen  lds
s_add_u32 m0, s58, 32768
s_nop 0
buffer_load_dwordx4 v12, s[40:43], s54 offen  lds
buffer_load_dwordx4 v13, s[40:43], s54 offen offset:1024  lds
buffer_load_dwordx4 v14, s[40:43], s54 offen offset:2048  lds
buffer_load_dwordx4 v15, s[40:43], s54 offen offset:3072  lds
s_waitcnt vmcnt(10)
s_barrier
s_lshl_b32 s55, s57, 7
s_add_u32 s55, s55, s4
s_lshl_b32 s54, s57, 19
s_add_u32 s54, s54, s25
s_add_u32 m0, s59, 81920
s_nop 0
buffer_load_dwordx4 v10, s[28:31], s55 offen  lds
s_add_u32 m0, s58, 49152
s_nop 0
buffer_load_dwordx4 v12, s[40:43], s54 offen  lds
buffer_load_dwordx4 v13, s[40:43], s54 offen offset:1024  lds
buffer_load_dwordx4 v14, s[40:43], s54 offen offset:2048  lds
buffer_load_dwordx4 v15, s[40:43], s54 offen offset:3072  lds
s_add_u32 s57, s57, 1
s_cmp_eq_u32 s57, 9
s_cselect_b32 s57, 0, s57
s_waitcnt vmcnt(10)
s_barrier
s_add_u32 s55, s55, 64
s_add_u32 s54, s54, 262144
s_add_u32 m0, s59, 86016
s_nop 0
buffer_load_dwordx4 v10, s[28:31], s55 offen  lds
s_add_u32 m0, s58, 65536
s_nop 0
buffer_load_dwordx4 v12, s[40:43], s54 offen  lds
buffer_load_dwordx4 v13, s[40:43], s54 offen offset:1024  lds
buffer_load_dwordx4 v14, s[40:43], s54 offen offset:2048  lds
buffer_load_dwordx4 v15, s[40:43], s54 offen offset:3072  lds
s_add_u32 m0, s58, 131072
s_add_u32 s52, s26, 16384
buffer_load_dwordx4 v16, s[32:35], s52 offen nt lds
buffer_load_dwordx4 v17, s[32:35], s52 offen offset:1024 nt lds
buffer_load_dwordx4 v18, s[32:35], s52 offen offset:2048 nt lds
buffer_load_dwordx4 v19, s[32:35], s52 offen offset:3072 nt lds
s_add_u32 m0, s58, 147456
s_add_u32 s52, s26, 16384
buffer_load_dwordx4 v20, s[36:39], s52 offen nt lds
buffer_load_dwordx4 v23, s[36:39], s52 offen offset:1024 nt lds
buffer_load_dwordx4 v20, s[36:39], s52 offen offset:2048 nt lds
buffer_load_dwordx4 v23, s[36:39], s52 offen offset:3072 nt lds
s_waitcnt vmcnt(18)
s_barrier
s_lshl_b32 s55, s57, 7
s_add_u32 s55, s55, s4
s_lshl_b32 s54, s57, 19
s_add_u32 s54, s54, s25
s_add_u32 m0, s59, 90112
s_nop 0
buffer_load_dwordx4 v10, s[28:31], s55 offen  lds
s_add_u32 m0, s58, 16384
s_nop 0
buffer_load_dwordx4 v12, s[40:43], s54 offen  lds
buffer_load_dwordx4 v13, s[40:43], s54 offen offset:1024  lds
buffer_load_dwordx4 v14, s[40:43], s54 offen offset:2048  lds
buffer_load_dwordx4 v15, s[40:43], s54 offen offset:3072  lds
s_add_u32 s57, s57, 1
s_cmp_eq_u32 s57, 9
s_cselect_b32 s57, 0, s57
s_waitcnt vmcnt(18)
s_barrier
s_add_u32 s55, s55, 64
s_add_u32 s54, s54, 262144
s_add_u32 m0, s59, 94208
s_nop 0
buffer_load_dwordx4 v10, s[28:31], s55 offen  lds
s_add_u32 m0, s58, 32768
s_nop 0
buffer_load_dwordx4 v12, s[40:43], s54 offen  lds
buffer_load_dwordx4 v13, s[40:43], s54 offen offset:1024  lds
buffer_load_dwordx4 v14, s[40:43], s54 offen offset:2048  lds
buffer_load_dwordx4 v15, s[40:43], s54 offen offset:3072  lds
s_waitcnt vmcnt(18)
s_barrier
s_lshl_b32 s55, s57, 7
s_add_u32 s55, s55, s4
s_lshl_b32 s54, s57, 19
s_add_u32 s54, s54, s25
s_add_u32 m0, s59, 81920
s_nop 0
buffer_load_dwordx4 v10, s[28:31], s55 offen  lds
s_add_u32 m0, s58, 49152
s_nop 0
buffer_load_dwordx4 v12, s[40:43], s54 offen  lds
buffer_load_dwordx4 v13, s[40:43], s54 offen offset:1024  lds
buffer_load_dwordx4 v14, s[40:43], s54 offen offset:2048  lds
buffer_load_dwordx4 v15, s[40:43], s54 offen offset:3072  lds
s_add_u32 s57, s57, 1
s_cmp_eq_u32 s57, 9
s_cselect_b32 s57, 0, s57
s_waitcnt vmcnt(10)
s_barrier
s_add_u32 s55, s55, 64
s_add_u32 s54, s54, 262144
s_add_u32 m0, s59, 86016
s_nop 0
buffer_load_dwordx4 v10, s[28:31], s55 offen  lds
s_add_u32 m0, s58, 65536
s_nop 0
buffer_load_dwordx4 v12, s[40:43], s54 offen  lds
buffer_load_dwordx4 v13, s[40:43], s54 offen offset:1024  lds
buffer_load_dwordx4 v14, s[40:43], s54 offen offset:2048  lds
buffer_load_dwordx4 v15, s[40:43], s54 offen offset:3072  lds
s_waitcnt vmcnt(10)
s_barrier
s_lshl_b32 s55, s57, 7
s_add_u32 s55, s55, s4
s_lshl_b32 s54, s57, 19
s_add_u32 s54, s54, s25
s_add_u32 m0, s59, 90112
s_nop 0
buffer_load_dwordx4 v10, s[28:31], s55 offen  lds
s_add_u32 m0, s58, 16384
s_nop 0
buffer_load_dwordx4 v12, s[40:43], s54 offen  lds
buffer_load_dwordx4 v13, s[40:43], s54 offen offset:1024  lds
buffer_load_dwordx4 v14, s[40:43], s54 offen offset:2048  lds
buffer_load_dwordx4 v15, s[40:43], s54 offen offset:3072  lds
s_add_u32 s57, s57, 1
s_cmp_eq_u32 s57, 9
s_cselect_b32 s57, 0, s57
s_waitcnt vmcnt(10)
s_barrier
s_add_u32 s55, s55, 64
s_add_u32 s54, s54, 262144
s_add_u32 m0, s59, 94208
s_nop 0
buffer_load_dwordx4 v10, s[28:31], s55 offen  lds
s_add_u32 m0, s58, 32768
s_nop 0
buffer_load_dwordx4 v12, s[40:43], s54 offen  lds
buffer_load_dwordx4 v13, s[40:43], s54 offen offset:1024  lds
buffer_load_dwordx4 v14, s[40:43], s54 offen offset:2048  lds
buffer_load_dwordx4 v15, s[40:43], s54 offen offset:3072  lds
s_add_u32 m0, s58, 0
s_add_u32 s52, s26, 32768
buffer_load_dwordx4 v16, s[32:35], s52 offen nt lds
buffer_load_dwordx4 v17, s[32:35], s52 offen offset:1024 nt lds
buffer_load_dwordx4 v18, s[32:35], s52 offen offset:2048 nt lds
buffer_load_dwordx4 v19, s[32:35], s52 offen offset:3072 nt lds
s_waitcnt vmcnt(14)
s_barrier
s_lshl_b32 s55, s57, 7
s_add_u32 s55, s55, s4
s_lshl_b32 s54, s57, 19
s_add_u32 s54, s54, s25
s_add_u32 m0, s59, 81920
s_nop 0
buffer_load_dwordx4 v10, s[28:31], s55 offen  lds
s_add_u32 m0, s58, 49152
s_nop 0
buffer_load_dwordx4 v12, s[40:43], s54 offen  lds
buffer_load_dwordx4 v13, s[40:43], s54 offen offset:1024  lds
buffer_load_dwordx4 v14, s[40:43], s54 offen offset:2048  lds
buffer_load_dwordx4 v15, s[40:43], s54 offen offset:3072  lds
s_add_u32 s57, s57, 1
s_cmp_eq_u32 s57, 9
s_cselect_b32 s57, 0, s57
s_waitcnt vmcnt(14)
s_barrier
s_add_u32 s55, s55, 64
s_add_u32 s54, s54, 262144
s_add_u32 m0, s59, 86016
s_nop 0
buffer_load_dwordx4 v10, s[28:31], s55 offen  lds
s_add_u32 m0, s58, 65536
s_nop 0
buffer_load_dwordx4 v12, s[40:43], s54 offen  lds
buffer_load_dwordx4 v13, s[40:43], s54 offen offset:1024  lds
buffer_load_dwordx4 v14, s[40:43], s54 offen offset:2048  lds
buffer_load_dwordx4 v15, s[40:43], s54 offen offset:3072  lds
s_mov_b32 s57, s8
s_waitcnt vmcnt(14)
s_barrier
s_add_u32 m0, s58, 16384
s_add_u32 s52, s26, 32768
buffer_load_dwordx4 v20, s[36:39], s52 offen nt lds
buffer_load_dwordx4 v23, s[36:39], s52 offen offset:1024 nt lds
buffer_load_dwordx4 v20, s[36:39], s52 offen offset:2048 nt lds
buffer_load_dwordx4 v23, s[36:39], s52 offen offset:3072 nt lds
s_waitcnt vmcnt(9)
s_barrier
s_waitcnt vmcnt(4)
s_barrier
s_barrier
s_add_u32 m0, s58, 32768
s_add_u32 s52, s26, 49152
buffer_load_dwordx4 v16, s[32:35], s52 offen nt lds
buffer_load_dwordx4 v17, s[32:35], s52 offen offset:1024 nt lds
buffer_load_dwordx4 v18, s[32:35], s52 offen offset:2048 nt lds
buffer_load_dwordx4 v19, s[32:35], s52 offen offset:3072 nt lds
s_barrier
s_add_u32 m0, s58, 49152
s_add_u32 s52, s26, 49152
buffer_load_dwordx4 v20, s[36:39], s52 offen nt lds
buffer_load_dwordx4 v23, s[36:39], s52 offen offset:1024 nt lds
buffer_load_dwordx4 v20, s[36:39], s52 offen offset:2048 nt lds
buffer_load_dwordx4 v23, s[36:39], s52 offen offset:3072 nt lds
s_barrier
s_add_u32 m0, s58, 65536
s_add_u32 s52, s26, 65536
buffer_load_dwordx4 v16, s[32:35], s52 offen nt lds
buffer_load_dwordx4 v17, s[32:35], s52 offen offset:1024 nt lds
buffer_load_dwordx4 v18, s[32:35], s52 offen offset:2048 nt lds
buffer_load_dwordx4 v19, s[32:35], s52 offen offset:3072 nt lds
v_lshrrev_b32 v5, 3, v0
v_mul_u32_u24 v6, 1152, v5
v_xor_b32 v7, v1, v2
v_and_b32 v7, 1, v7
v_lshl_add_u32 v6, v7, 6, v6
v_lshl_add_u32 v6, v4, 4, v6
v_add_u32 v24, 0, v6
v_add_u32 v25, 8192, v6
v_add_u32 v26, 16384, v6
v_add_u32 v27, 24576, v6
s_lshl_b32 s27, s7, 8
s_lshl_b32 s9, s24, 5
s_add_u32 s27, s27, s9
s_xor_b32 s25, s27, 256
s_mul_i32 s25, s25, 1152
s_and_b32 s57, s7, 1
s_lshl_b32 s57, s57, 2
s_add_u32 s57, s57, s8
v_lshlrev_b32 v63, 4, v0
s_mul_i32 s27, s27, 1152
v_lshlrev_b32 v21, 7, v0
v_min_u32 v22, 7, v0
v_lshlrev_b32 v22, 7, v22
v_add_u32 v22, 8192, v22
s_mov_b32 s44, s20
s_and_b32 s45, s21, 0xffff
s_mov_b32 s46, 0x480000
s_mov_b32 s47, 0x20000
s_mov_b32 s48, s22
s_and_b32 s49, s23, 0xffff
s_mov_b32 s50, 0x10000000
s_mov_b32 s51, 0x20000
s_mov_b32 s92, s96
s_and_b32 s93, s97, 0xffff
s_mov_b32 s94, 0x120000
s_mov_b32 s95, 0x20000
s_lshl_b32 s9, s6, 3
s_add_u32 s9, s9, s8
s_mul_i32 s56, s9, 0x200000
s_lshl_b32 s11, s9, 4
s_add_u32 s100, s98, s11
s_addc_u32 s101, s99, 0
s_mov_b32 s96, s98
s_and_b32 s97, s99, 0xffff
s_mov_b32 s98, 0x100
s_mov_b32 s99, 0x20000
v_and_b32 v6, 15, v0
v_lshlrev_b32 v28, 4, v6
v_lshl_add_u32 v28, v2, 11, v28
s_lshr_b32 s9, s24, 1
s_and_b32 s5, s24, 1
s_lshl_b32 s10, s5, 8
v_add_u32 v28, s10, v28
s_lshl_b32 s53, s9, 30
v_add_u32 v31, s53, v28
s_barrier
s_barrier
s_add_u32 m0, s58, 81920
s_add_u32 s52, s26, 65536
buffer_load_dwordx4 v20, s[36:39], s52 offen nt lds
buffer_load_dwordx4 v23, s[36:39], s52 offen offset:1024 nt lds
buffer_load_dwordx4 v20, s[36:39], s52 offen offset:2048 nt lds
buffer_load_dwordx4 v23, s[36:39], s52 offen offset:3072 nt lds
v_lshlrev_b32 v29, 4, v2
v_and_b32 v7, 7, v0
v_mul_u32_u24 v30, 2304, v7
v_and_b32 v7, 8, v0
v_lshl_add_u32 v30, v7, 1, v30
v_and_b32 v7, 16, v0
v_lshrrev_b32 v7, 1, v7
v_add_u32 v30, v7, v30
s_lshl_b32 s5, s5, 5
v_add_u32 v30, s5, v30
s_add_u32 s12, s8, s9
s_cmp_ge_u32 s12, 9
s_cselect_b32 s10, 9, 0
s_sub_u32 s12, s12, s10
s_add_u32 s13, s12, 2
s_cmp_ge_u32 s13, 9
s_cselect_b32 s10, 9, 0
s_sub_u32 s13, s13, s10
s_add_u32 s14, s13, 2
s_cmp_ge_u32 s14, 9
s_cselect_b32 s10, 9, 0
s_sub_u32 s14, s14, s10
s_add_u32 s15, s14, 2
s_cmp_ge_u32 s15, 9
s_cselect_b32 s10, 9, 0
s_sub_u32 s15, s15, s10
s_add_u32 s16, s15, 2
s_cmp_ge_u32 s16, 9
s_cselect_b32 s10, 9, 0
s_sub_u32 s16, s16, s10
s_lshl_b32 s10, s7, 13
s_add_u32 s10, s10, s56
s_lshl_b32 s20, s12, 17
s_add_u32 s20, s20, s10
s_lshl_b32 s12, s12, 7
s_lshl_b32 s21, s13, 17
s_add_u32 s21, s21, s10
s_lshl_b32 s13, s13, 7
s_lshl_b32 s22, s14, 17
s_add_u32 s22, s22, s10
s_lshl_b32 s14, s14, 7
s_lshl_b32 s23, s15, 17
s_add_u32 s23, s23, s10
s_lshl_b32 s15, s15, 7
s_lshl_b32 s4, s16, 17
s_add_u32 s4, s4, s10
s_lshl_b32 s16, s16, 7
s_or_b32 s16, s16, s53
v_cmp_gt_u32 vcc, 32, v0
v_mov_b32 v7, s12
v_mov_b32 v8, s13
v_cndmask_b32 v7, v8, v7, vcc
v_add_u32 v41, v7, v30
v_mov_b32 v7, s14
v_mov_b32 v8, s15
v_cndmask_b32 v7, v8, v7, vcc
v_add_u32 v42, v7, v30
v_mov_b32 v7, s16
v_mov_b32 v8, 0x40000000
v_cndmask_b32 v7, v8, v7, vcc
v_add_u32 v43, v7, v30
s_waitcnt vmcnt(16)
s_barrier
s_waitcnt vmcnt(12)
s_barrier
s_add_u32 m0, s58, 98304
s_add_u32 s52, s26, 81920
buffer_load_dwordx4 v16, s[32:35], s52 offen nt lds
buffer_load_dwordx4 v17, s[32:35], s52 offen offset:1024 nt lds
buffer_load_dwordx4 v18, s[32:35], s52 offen offset:2048 nt lds
buffer_load_dwordx4 v19, s[32:35], s52 offen offset:3072 nt lds
v_and_b32 v7, 1, v0
v_lshlrev_b32 v7, 4, v7
v_mov_b32 v8, 0x3f80
v_lshlrev_b32 v8, v7, v8
v_lshrrev_b32 v6, 1, v6
v_cmp_eq_u32 vcc, 0, v6
s_nop 1
v_cndmask_b32 v32, 0, v8, vcc
v_cmp_eq_u32 vcc, 1, v6
s_nop 1
v_cndmask_b32 v33, 0, v8, vcc
v_cmp_eq_u32 vcc, 2, v6
s_nop 1
v_cndmask_b32 v34, 0, v8, vcc
v_cmp_eq_u32 vcc, 3, v6
s_nop 1
v_cndmask_b32 v35, 0, v8, vcc
v_cmp_eq_u32 vcc, 4, v6
s_nop 1
v_cndmask_b32 v44, 0, v8, vcc
v_cmp_eq_u32 vcc, 5, v6
s_nop 1
v_cndmask_b32 v45, 0, v8, vcc
v_cmp_eq_u32 vcc, 6, v6
s_nop 1
v_cndmask_b32 v46, 0, v8, vcc
v_cmp_eq_u32 vcc, 7, v6
s_nop 1
v_cndmask_b32 v47, 0, v8, vcc
s_lshr_b32 s5, s11, 4
s_mul_i32 s5, s5, 0x1000
s_lshl_b32 s9, s7, 7
s_add_u32 s5, s5, 0xc000000
s_add_u32 s5, s5, s9
s_lshl_b32 s9, s24, 2
s_add_u32 s55, s5, s9
s_add_u32 s55, s55, 0x800
s_xor_b32 s9, s7, 1
s_lshl_b32 s9, s9, 2
s_add_u32 s9, s9, s24
s_lshl_b32 s9, s9, 13
s_add_u32 s54, s56, s9
s_add_u32 s54, s54, 0x140000
s_lshl_b32 s9, s7, 9
s_add_u32 s3, s56, s9
s_lshr_b32 s9, s7, 1
s_lshl_b32 s10, s8, 3
s_add_u32 s9, s9, s10
s_mul_i32 s10, s9, 18432
s_mul_i32 s9, s6, 1152
s_add_u32 s10, s10, s9
s_and_b32 s9, s7, 1
s_lshl_b32 s9, s9, 6
s_add_u32 s10, s10, s9
v_bfe_u32 v7, v0, 3, 2
v_lshlrev_b32 v36, 14, v7
v_lshrrev_b32 v7, 5, v0
v_lshl_add_u32 v36, v7, 7, v36
v_and_b32 v7, 7, v0
v_lshl_add_u32 v36, v7, 4, v36
s_and_b32 s9, s24, 1
s_lshl_b32 s9, s9, 16
s_lshr_b32 s52, s24, 1
s_lshl_b32 s52, s52, 13
s_add_u32 s9, s9, s52
v_add_u32 v36, s9, v36
v_mov_b32 v37, 0
v_mov_b32 v56, 0
v_mov_b32 v57, 0
v_mov_b32 v58, 0
v_mov_b32 v59, 0
v_lshlrev_b32 v52, 1, v2
v_add_u32 v52, 131136, v52
v_mov_b32 v51, 131136
s_waitcnt vmcnt(12)
s_barrier
s_add_u32 m0, s58, 114688
s_add_u32 s52, s26, 81920
buffer_load_dwordx4 v20, s[36:39], s52 offen nt lds
buffer_load_dwordx4 v23, s[36:39], s52 offen offset:1024 nt lds
buffer_load_dwordx4 v20, s[36:39], s52 offen offset:2048 nt lds
buffer_load_dwordx4 v23, s[36:39], s52 offen offset:3072 nt lds
s_waitcnt vmcnt(12)
s_barrier
s_add_u32 m0, s58, 131072
s_add_u32 s52, s26, 98304
buffer_load_dwordx4 v16, s[32:35], s52 offen nt lds
buffer_load_dwordx4 v17, s[32:35], s52 offen offset:1024 nt lds
buffer_load_dwordx4 v18, s[32:35], s52 offen offset:2048 nt lds
buffer_load_dwordx4 v19, s[32:35], s52 offen offset:3072 nt lds
s_mov_b32 s6, 1
s_cmp_lg_u32 s24, 0
s_cbranch_scc1 L_nochk1
s_load_dword s6, s[100:101], 0
L_nochk1:
s_waitcnt vmcnt(12)
s_barrier
s_add_u32 m0, s58, 147456
s_add_u32 s52, s26, 98304
buffer_load_dwordx4 v20, s[36:39], s52 offen nt lds
buffer_load_dwordx4 v23, s[36:39], s52 offen offset:1024 nt lds
buffer_load_dwordx4 v20, s[36:39], s52 offen offset:2048 nt lds
buffer_load_dwordx4 v23, s[36:39], s52 offen offset:3072 nt lds
s_waitcnt vmcnt(12)
s_barrier
s_add_u32 m0, s58, 0
s_add_u32 s52, s26, 114688
buffer_load_dwordx4 v16, s[32:35], s52 offen nt lds
buffer_load_dwordx4 v17, s[32:35], s52 offen offset:1024 nt lds
buffer_load_dwordx4 v18, s[32:35], s52 offen offset:2048 nt lds
buffer_load_dwordx4 v19, s[32:35], s52 offen offset:3072 nt lds
s_waitcnt vmcnt(12)
s_barrier
s_add_u32 m0, s58, 16384
s_add_u32 s52, s26, 114688
buffer_load_dwordx4 v20, s[36:39], s52 offen nt lds
buffer_load_dwordx4 v23, s[36:39], s52 offen offset:1024 nt lds
buffer_load_dwordx4 v20, s[36:39], s52 offen offset:2048 nt lds
buffer_load_dwordx4 v23, s[36:39], s52 offen offset:3072 nt lds
s_waitcnt vmcnt(12)
s_barrier
s_add_u32 m0, s58, 32768
s_add_u32 s53, s8, 8
s_cmp_ge_u32 s53, 9
s_cselect_b32 s52, 9, 0
s_sub_u32 s53, s53, s52
s_lshl_b32 s53, s53, 7
s_add_u32 s53, s53, s27
buffer_load_dwordx4 v24, s[44:47], s53 offen  lds
buffer_load_dwordx4 v25, s[44:47], s53 offen offset:1024  lds
buffer_load_dwordx4 v26, s[44:47], s53 offen offset:2048  lds
buffer_load_dwordx4 v27, s[44:47], s53 offen offset:3072  lds
s_waitcnt lgkmcnt(0)
s_cmp_eq_u32 s6, 1
s_cbranch_scc0 L_hs24
L_hsback24:
s_waitcnt vmcnt(12)
s_barrier
s_add_u32 m0, s58, 49152
s_add_u32 s53, s53, 147456
buffer_load_dwordx4 v24, s[44:47], s53 offen  lds
buffer_load_dwordx4 v25, s[44:47], s53 offen offset:1024  lds
buffer_load_dwordx4 v26, s[44:47], s53 offen offset:2048  lds
buffer_load_dwordx4 v27, s[44:47], s53 offen offset:3072  lds
s_waitcnt vmcnt(12)
s_barrier
s_add_u32 m0, s58, 65536
s_add_u32 s53, s57, 0
s_cmp_ge_u32 s53, 9
s_cselect_b32 s52, 9, 0
s_sub_u32 s53, s53, s52
s_lshl_b32 s53, s53, 7
s_add_u32 s53, s53, s27
buffer_load_dwordx4 v24, s[44:47], s53 offen  lds
buffer_load_dwordx4 v25, s[44:47], s53 offen offset:1024  lds
buffer_load_dwordx4 v26, s[44:47], s53 offen offset:2048  lds
buffer_load_dwordx4 v27, s[44:47], s53 offen offset:3072  lds
s_waitcnt vmcnt(12)
s_barrier
s_add_u32 m0, s58, 81920
s_add_u32 s53, s53, 147456
buffer_load_dwordx4 v24, s[44:47], s53 offen  lds
buffer_load_dwordx4 v25, s[44:47], s53 offen offset:1024  lds
buffer_load_dwordx4 v26, s[44:47], s53 offen offset:2048  lds
buffer_load_dwordx4 v27, s[44:47], s53 offen offset:3072  lds
s_waitcnt vmcnt(8)
s_barrier
s_add_u32 m0, s58, 98304
s_add_u32 s53, s57, 1
s_cmp_ge_u32 s53, 9
s_cselect_b32 s52, 9, 0
s_sub_u32 s53, s53, s52
s_lshl_b32 s53, s53, 7
s_add_u32 s53, s53, s27
buffer_load_dwordx4 v24, s[44:47], s53 offen  lds
buffer_load_dwordx4 v25, s[44:47], s53 offen offset:1024  lds
buffer_load_dwordx4 v26, s[44:47], s53 offen offset:2048  lds
buffer_load_dwordx4 v27, s[44:47], s53 offen offset:3072  lds
s_add_u32 m0, s58, 114688
s_add_u32 s53, s53, 147456
buffer_load_dwordx4 v24, s[44:47], s53 offen  lds
buffer_load_dwordx4 v25, s[44:47], s53 offen offset:1024  lds
buffer_load_dwordx4 v26, s[44:47], s53 offen offset:2048  lds
buffer_load_dwordx4 v27, s[44:47], s53 offen offset:3072  lds
s_barrier
s_buffer_load_dword s1, s[48:51], s55 glc
s_add_u32 m0, s58, 0
s_add_u32 s53, s57, 2
s_cmp_ge_u32 s53, 9
s_cselect_b32 s52, 9, 0
s_sub_u32 s53, s53, s52
s_lshl_b32 s53, s53, 7
s_add_u32 s53, s53, s27
buffer_load_dwordx4 v24, s[44:47], s53 offen  lds
buffer_load_dwordx4 v25, s[44:47], s53 offen offset:1024  lds
buffer_load_dwordx4 v26, s[44:47], s53 offen offset:2048  lds
buffer_load_dwordx4 v27, s[44:47], s53 offen offset:3072  lds
s_add_u32 m0, s58, 16384
s_add_u32 s53, s53, 147456
buffer_load_dwordx4 v24, s[44:47], s53 offen  lds
buffer_load_dwordx4 v25, s[44:47], s53 offen offset:1024  lds
buffer_load_dwordx4 v26, s[44:47], s53 offen offset:2048  lds
buffer_load_dwordx4 v27, s[44:47], s53 offen offset:3072  lds
s_waitcnt vmcnt(16)
s_barrier
s_waitcnt lgkmcnt(0)
s_cmp_eq_u32 s1, 1
s_cbranch_scc1 L_ze0
s_buffer_load_dword s1, s[48:51], s55 glc
s_add_u32 m0, s58, 32768
s_add_u32 s53, s57, 3
s_cmp_ge_u32 s53, 9
s_cselect_b32 s52, 9, 0
s_sub_u32 s53, s53, s52
s_lshl_b32 s53, s53, 7
s_add_u32 s53, s53, s27
buffer_load_dwordx4 v24, s[44:47], s53 offen  lds
buffer_load_dwordx4 v25, s[44:47], s53 offen offset:1024  lds
buffer_load_dwordx4 v26, s[44:47], s53 offen offset:2048  lds
buffer_load_dwordx4 v27, s[44:47], s53 offen offset:3072  lds
s_add_u32 m0, s58, 49152
s_add_u32 s53, s53, 147456
buffer_load_dwordx4 v24, s[44:47], s53 offen  lds
buffer_load_dwordx4 v25, s[44:47], s53 offen offset:1024  lds
buffer_load_dwordx4 v26, s[44:47], s53 offen offset:2048  lds
buffer_load_dwordx4 v27, s[44:47], s53 offen offset:3072  lds
s_waitcnt vmcnt(16)
s_barrier
s_waitcnt lgkmcnt(0)
s_cmp_eq_u32 s1, 1
s_cbranch_scc1 L_ze1
s_add_u32 m0, s58, 65536
s_add_u32 s53, s57, 0
s_cmp_ge_u32 s53, 9
s_cselect_b32 s52, 9, 0
s_sub_u32 s53, s53, s52
s_lshl_b32 s53, s53, 7
s_add_u32 s53, s53, s25
buffer_load_dwordx4 v24, s[44:47], s53 offen  lds
buffer_load_dwordx4 v25, s[44:47], s53 offen offset:1024  lds
buffer_load_dwordx4 v26, s[44:47], s53 offen offset:2048  lds
buffer_load_dwordx4 v27, s[44:47], s53 offen offset:3072  lds
s_add_u32 m0, s58, 81920
s_add_u32 s53, s53, 147456
buffer_load_dwordx4 v24, s[44:47], s53 offen  lds
buffer_load_dwordx4 v25, s[44:47], s53 offen offset:1024  lds
buffer_load_dwordx4 v26, s[44:47], s53 offen offset:2048  lds
buffer_load_dwordx4 v27, s[44:47], s53 offen offset:3072  lds
s_waitcnt vmcnt(16)
s_barrier
s_add_u32 m0, s58, 98304
s_add_u32 s53, s57, 1
s_cmp_ge_u32 s53, 9
s_cselect_b32 s52, 9, 0
s_sub_u32 s53, s53, s52
s_lshl_b32 s53, s53, 7
s_add_u32 s53, s53, s25
buffer_load_dwordx4 v24, s[44:47], s53 offen  lds
buffer_load_dwordx4 v25, s[44:47], s53 offen offset:1024  lds
buffer_load_dwordx4 v26, s[44:47], s53 offen offset:2048  lds
buffer_load_dwordx4 v27, s[44:47], s53 offen offset:3072  lds
s_add_u32 m0, s58, 114688
s_add_u32 s53, s53, 147456
buffer_load_dwordx4 v24, s[44:47], s53 offen  lds
buffer_load_dwordx4 v25, s[44:47], s53 offen offset:1024  lds
buffer_load_dwordx4 v26, s[44:47], s53 offen offset:2048  lds
buffer_load_dwordx4 v27, s[44:47], s53 offen offset:3072  lds
s_mov_b32 s52, 0
L_zp37:
s_buffer_load_dword s9, s[48:51], s55 glc
s_add_u32 s52, s52, 1
s_waitcnt lgkmcnt(0)
s_cmp_eq_u32 s9, 1
s_cbranch_scc1 L_zok37
s_cmp_lt_u32 s52, 64
s_cbranch_scc1 L_zp37
s_branch L_zv37
L_zok37:
s_lshl_b32 s9, s58, 1
s_add_u32 m0, s9, 131072
s_nop 0
buffer_load_dwordx4 v63, s[48:51], s54 offen sc1 lds
buffer_load_dwordx4 v63, s[48:51], s54 offen offset:1024 sc1 lds
buffer_load_dwordx4 v63, s[48:51], s54 offen offset:2048 sc1 lds
buffer_load_dwordx4 v63, s[48:51], s54 offen offset:3072 sc1 lds
s_lshl_b32 s9, s58, 1
s_add_u32 m0, s9, 135168
s_add_u32 s54, s54, 4096
buffer_load_dwordx4 v63, s[48:51], s54 offen sc1 lds
buffer_load_dwordx4 v63, s[48:51], s54 offen offset:1024 sc1 lds
buffer_load_dwordx4 v63, s[48:51], s54 offen offset:2048 sc1 lds
buffer_load_dwordx4 v63, s[48:51], s54 offen offset:3072 sc1 lds
s_waitcnt vmcnt(24)
s_barrier
s_add_u32 m0, s58, 0
s_add_u32 s53, s57, 2
s_cmp_ge_u32 s53, 9
s_cselect_b32 s52, 9, 0
s_sub_u32 s53, s53, s52
s_lshl_b32 s53, s53, 7
s_add_u32 s53, s53, s25
buffer_load_dwordx4 v24, s[44:47], s53 offen  lds
buffer_load_dwordx4 v25, s[44:47], s53 offen offset:1024  lds
buffer_load_dwordx4 v26, s[44:47], s53 offen offset:2048  lds
buffer_load_dwordx4 v27, s[44:47], s53 offen offset:3072  lds
s_add_u32 m0, s58, 16384
s_add_u32 s53, s53, 147456
buffer_load_dwordx4 v24, s[44:47], s53 offen  lds
buffer_load_dwordx4 v25, s[44:47], s53 offen offset:1024  lds
buffer_load_dwordx4 v26, s[44:47], s53 offen offset:2048  lds
buffer_load_dwordx4 v27, s[44:47], s53 offen offset:3072  lds
s_waitcnt vmcnt(8)
s_barrier
s_add_u32 m0, s58, 32768
s_add_u32 s53, s57, 3
s_cmp_ge_u32 s53, 9
s_cselect_b32 s52, 9, 0
s_sub_u32 s53, s53, s52
s_lshl_b32 s53, s53, 7
s_add_u32 s53, s53, s25
buffer_load_dwordx4 v24, s[44:47], s53 offen  lds
buffer_load_dwordx4 v25, s[44:47], s53 offen offset:1024  lds
buffer_load_dwordx4 v26, s[44:47], s53 offen offset:2048  lds
buffer_load_dwordx4 v27, s[44:47], s53 offen offset:3072  lds
s_add_u32 m0, s58, 49152
s_add_u32 s53, s53, 147456
buffer_load_dwordx4 v24, s[44:47], s53 offen  lds
buffer_load_dwordx4 v25, s[44:47], s53 offen offset:1024  lds
buffer_load_dwordx4 v26, s[44:47], s53 offen offset:2048  lds
buffer_load_dwordx4 v27, s[44:47], s53 offen offset:3072  lds
s_barrier
s_waitcnt vmcnt(8)
s_barrier
ds_write_b128 v51, v[56:59]
ds_write_b128 v51, v[56:59] offset:16
s_waitcnt lgkmcnt(0)
s_waitcnt vmcnt(0)
s_barrier
s_branch L_ltail
L_var2:
s_lshl_b32 s55, s57, 7
s_add_u32 s55, s55, s4
s_lshl_b32 s54, s57, 19
s_add_u32 s54, s54, s25
s_add_u32 m0, s59, 90112
s_nop 0
buffer_load_dwordx4 v10, s[28:31], s55 offen  lds
s_add_u32 m0, s58, 16384
s_nop 0
buffer_load_dwordx4 v12, s[40:43], s54 offen  lds
buffer_load_dwordx4 v13, s[40:43], s54 offen offset:1024  lds
buffer_load_dwordx4 v14, s[40:43], s54 offen offset:2048  lds
buffer_load_dwordx4 v15, s[40:43], s54 offen offset:3072  lds
s_add_u32 s57, s57, 1
s_cmp_eq_u32 s57, 9
s_cselect_b32 s57, 0, s57
s_add_u32 s55, s55, 64
s_add_u32 s54, s54, 262144
s_add_u32 m0, s59, 94208
s_nop 0
buffer_load_dwordx4 v10, s[28:31], s55 offen  lds
s_add_u32 m0, s58, 32768
s_nop 0
buffer_load_dwordx4 v12, s[40:43], s54 offen  lds
buffer_load_dwordx4 v13, s[40:43], s54 offen offset:1024  lds
buffer_load_dwordx4 v14, s[40:43], s54 offen offset:2048  lds
buffer_load_dwordx4 v15, s[40:43], s54 offen offset:3072  lds
s_waitcnt vmcnt(15)
s_barrier
s_waitcnt vmcnt(10)
s_barrier
s_lshl_b32 s55, s57, 7
s_add_u32 s55, s55, s4
s_lshl_b32 s54, s57, 19
s_add_u32 s54, s54, s25
s_add_u32 m0, s59, 81920
s_nop 0
buffer_load_dwordx4 v10, s[28:31], s55 offen  lds
s_add_u32 m0, s58, 49152
s_nop 0
buffer_load_dwordx4 v12, s[40:43], s54 offen  lds
buffer_load_dwordx4 v13, s[40:43], s54 offen offset:1024  lds
buffer_load_dwordx4 v14, s[40:43], s54 offen offset:2048  lds
buffer_load_dwordx4 v15, s[40:43], s54 offen offset:3072  lds
s_add_u32 s57, s57, 1
s_cmp_eq_u32 s57, 9
s_cselect_b32 s57, 0, s57
s_add_u32 m0, s58, 98304
s_add_u32 s52, s26, 0
buffer_load_dwordx4 v16, s[32:35], s52 offen nt lds
buffer_load_dwordx4 v17, s[32:35], s52 offen offset:1024 nt lds
buffer_load_dwordx4 v18, s[32:35], s52 offen offset:2048 nt lds
buffer_load_dwordx4 v19, s[32:35], s52 offen offset:3072 nt lds
s_add_u32 m0, s58, 114688
s_add_u32 s52, s26, 0
buffer_load_dwordx4 v20, s[36:39], s52 offen nt lds
buffer_load_dwordx4 v23, s[36:39], s52 offen offset:1024 nt lds
buffer_load_dwordx4 v20, s[36:39], s52 offen offset:2048 nt lds
buffer_load_dwordx4 v23, s[36:39], s52 offen offset:3072 nt lds
s_waitcnt vmcnt(18)
s_barrier
s_add_u32 s55, s55, 64
s_add_u32 s54, s54, 262144
s_add_u32 m0, s59, 86016
s_nop 0
buffer_load_dwordx4 v10, s[28:31], s55 offen  lds
s_add_u32 m0, s58, 65536
s_nop 0
buffer_load_dwordx4 v12, s[40:43], s54 offen  lds
buffer_load_dwordx4 v13, s[40:43], s54 offen offset:1024  lds
buffer_load_dwordx4 v14, s[40:43], s54 offen offset:2048  lds
buffer_load_dwordx4 v15, s[40:43], s54 offen offset:3072  lds
s_waitcnt vmcnt(18)
s_barrier
s_lshl_b32 s55, s57, 7
s_add_u32 s55, s55, s4
s_lshl_b32 s54, s57, 19
s_add_u32 s54, s54, s25
s_add_u32 m0, s59, 90112
s_nop 0
buffer_load_dwordx4 v10, s[28:31], s55 offen  lds
s_add_u32 m0, s58, 16384
s_nop 0
buffer_load_dwordx4 v12, s[40:43], s54 offen  lds
buffer_load_dwordx4 v13, s[40:43], s54 offen offset:1024  lds
buffer_load_dwordx4 v14, s[40:43], s54 offen offset:2048  lds
buffer_load_dwordx4 v15, s[40:43], s54 offen offset:3072  lds
s_add_u32 s57, s57, 1
s_cmp_eq_u32 s57, 9
s_cselect_b32 s57, 0, s57
s_waitcnt vmcnt(18)
s_barrier
s_add_u32 s55, s55, 64
s_add_u32 s54, s54, 262144
s_add_u32 m0, s59, 94208
s_nop 0
buffer_load_dwordx4 v10, s[28:31], s55 offen  lds
s_add_u32 m0, s58, 32768
s_nop 0
buffer_load_dwordx4 v12, s[40:43], s54 offen  lds
buffer_load_dwordx4 v13, s[40:43], s54 offen offset:1024  lds
buffer_load_dwordx4 v14, s[40:43], s54 offen offset:2048  lds
buffer_load_dwordx4 v15, s[40:43], s54 offen offset:3072  lds
s_waitcnt vmcnt(10)
s_barrier
s_lshl_b32 s55, s57, 7
s_add_u32 s55, s55, s4
s_lshl_b32 s54, s57, 19
s_add_u32 s54, s54, s25
s_add_u32 m0, s59, 81920
s_nop 0
buffer_load_dwordx4 v10, s[28:31], s55 offen  lds
s_add_u32 m0, s58, 49152
s_nop 0
buffer_load_dwordx4 v12, s[40:43], s54 offen  lds
buffer_load_dwordx4 v13, s[40:43], s54 offen offset:1024  lds
buffer_load_dwordx4 v14, s[40:43], s54 offen offset:2048  lds
buffer_load_dwordx4 v15, s[40:43], s54 offen offset:3072  lds
s_add_u32 s57, s57, 1
s_cmp_eq_u32 s57, 9
s_cselect_b32 s57, 0, s57
s_waitcnt vmcnt(10)
s_barrier
s_add_u32 s55, s55, 64
s_add_u32 s54, s54, 262144
s_add_u32 m0, s59, 86016
s_nop 0
buffer_load_dwordx4 v10, s[28:31], s55 offen  lds
s_add_u32 m0, s58, 65536
s_nop 0
buffer_load_dwordx4 v12, s[40:43], s54 offen  lds
buffer_load_dwordx4 v13, s[40:43], s54 offen offset:1024  lds
buffer_load_dwordx4 v14, s[40:43], s54 offen offset:2048  lds
buffer_load_dwordx4 v15, s[40:43], s54 offen offset:3072  lds
s_waitcnt vmcnt(10)
s_barrier
s_lshl_b32 s55, s57, 7
s_add_u32 s55, s55, s4
s_lshl_b32 s54, s57, 19
s_add_u32 s54, s54, s25
s_add_u32 m0, s59, 90112
s_nop 0
buffer_load_dwordx4 v10, s[28:31], s55 offen  lds
s_add_u32 m0, s58, 16384
s_nop 0
buffer_load_dwordx4 v12, s[40:43], s54 offen  lds
buffer_load_dwordx4 v13, s[40:43], s54 offen offset:1024  lds
buffer_load_dwordx4 v14, s[40:43], s54 offen offset:2048  lds
buffer_load_dwordx4 v15, s[40:43], s54 offen offset:3072  lds
s_add_u32 s57, s57, 1
s_cmp_eq_u32 s57, 9
s_cselect_b32 s57, 0, s57
s_add_u32 m0, s58, 131072
s_add_u32 s52, s26, 16384
buffer_load_dwordx4 v16, s[32:35], s52 offen nt lds
buffer_load_dwordx4 v17, s[32:35], s52 offen offset:1024 nt lds
buffer_load_dwordx4 v18, s[32:35], s52 offen offset:2048 nt lds
buffer_load_dwordx4 v19, s[32:35], s52 offen offset:3072 nt lds
s_add_u32 m0, s58, 147456
s_add_u32 s52, s26, 16384
buffer_load_dwordx4 v20, s[36:39], s52 offen nt lds
buffer_load_dwordx4 v23, s[36:39], s52 offen offset:1024 nt lds
buffer_load_dwordx4 v20, s[36:39], s52 offen offset:2048 nt lds
buffer_load_dwordx4 v23, s[36:39], s52 offen offset:3072 nt lds
s_waitcnt vmcnt(18)
s_barrier
s_add_u32 s55, s55, 64
s_add_u32 s54, s54, 262144
s_add_u32 m0, s59, 94208
s_nop 0
buffer_load_dwordx4 v10, s[28:31], s55 offen  lds
s_add_u32 m0, s58, 32768
s_nop 0
buffer_load_dwordx4 v12, s[40:43], s54 offen  lds
buffer_load_dwordx4 v13, s[40:43], s54 offen offset:1024  lds
buffer_load_dwordx4 v14, s[40:43], s54 offen offset:2048  lds
buffer_load_dwordx4 v15, s[40:43], s54 offen offset:3072  lds
s_waitcnt vmcnt(18)
s_barrier
s_lshl_b32 s55, s57, 7
s_add_u32 s55, s55, s4
s_lshl_b32 s54, s57, 19
s_add_u32 s54, s54, s25
s_add_u32 m0, s59, 81920
s_nop 0
buffer_load_dwordx4 v10, s[28:31], s55 offen  lds
s_add_u32 m0, s58, 49152
s_nop 0
buffer_load_dwordx4 v12, s[40:43], s54 offen  lds
buffer_load_dwordx4 v13, s[40:43], s54 offen offset:1024  lds
buffer_load_dwordx4 v14, s[40:43], s54 offen offset:2048  lds
buffer_load_dwordx4 v15, s[40:43], s54 offen offset:3072  lds
s_add_u32 s57, s57, 1
s_cmp_eq_u32 s57, 9
s_cselect_b32 s57, 0, s57
s_waitcnt vmcnt(18)
s_barrier
s_add_u32 s55, s55, 64
s_add_u32 s54, s54, 262144
s_add_u32 m0, s59, 86016
s_nop 0
buffer_load_dwordx4 v10, s[28:31], s55 offen  lds
s_add_u32 m0, s58, 65536
s_nop 0
buffer_load_dwordx4 v12, s[40:43], s54 offen  lds
buffer_load_dwordx4 v13, s[40:43], s54 offen offset:1024  lds
buffer_load_dwordx4 v14, s[40:43], s54 offen offset:2048  lds
buffer_load_dwordx4 v15, s[40:43], s54 offen offset:3072  lds
s_waitcnt vmcnt(10)
s_barrier
s_lshl_b32 s55, s57, 7
s_add_u32 s55, s55, s4
s_lshl_b32 s54, s57, 19
s_add_u32 s54, s54, s25
s_add_u32 m0, s59, 90112
s_nop 0
buffer_load_dwordx4 v10, s[28:31], s55 offen  lds
s_add_u32 m0, s58, 16384
s_nop 0
buffer_load_dwordx4 v12, s[40:43], s54 offen  lds
buffer_load_dwordx4 v13, s[40:43], s54 offen offset:1024  lds
buffer_load_dwordx4 v14, s[40:43], s54 offen offset:2048  lds
buffer_load_dwordx4 v15, s[40:43], s54 offen offset:3072  lds
s_add_u32 s57, s57, 1
s_cmp_eq_u32 s57, 9
s_cselect_b32 s57, 0, s57
s_waitcnt vmcnt(10)
s_barrier
s_add_u32 s55, s55, 64
s_add_u32 s54, s54, 262144
s_add_u32 m0, s59, 94208
s_nop 0
buffer_load_dwordx4 v10, s[28:31], s55 offen  lds
s_add_u32 m0, s58, 32768
s_nop 0
buffer_load_dwordx4 v12, s[40:43], s54 offen  lds
buffer_load_dwordx4 v13, s[40:43], s54 offen offset:1024  lds
buffer_load_dwordx4 v14, s[40:43], s54 offen offset:2048  lds
buffer_load_dwordx4 v15, s[40:43], s54 offen offset:3072  lds
s_waitcnt vmcnt(10)
s_barrier
s_lshl_b32 s55, s57, 7
s_add_u32 s55, s55, s4
s_lshl_b32 s54, s57, 19
s_add_u32 s54, s54, s25
s_add_u32 m0, s59, 81920
s_nop 0
buffer_load_dwordx4 v10, s[28:31], s55 offen  lds
s_add_u32 m0, s58, 49152
s_nop 0
buffer_load_dwordx4 v12, s[40:43], s54 offen  lds
buffer_load_dwordx4 v13, s[40:43], s54 offen offset:1024  lds
buffer_load_dwordx4 v14, s[40:43], s54 offen offset:2048  lds
buffer_load_dwordx4 v15, s[40:43], s54 offen offset:3072  lds
s_add_u32 s57, s57, 1
s_cmp_eq_u32 s57, 9
s_cselect_b32 s57, 0, s57
s_add_u32 m0, s58, 0
s_add_u32 s52, s26, 32768
buffer_load_dwordx4 v16, s[32:35], s52 offen nt lds
buffer_load_dwordx4 v17, s[32:35], s52 offen offset:1024 nt lds
buffer_load_dwordx4 v18, s[32:35], s52 offen offset:2048 nt lds
buffer_load_dwordx4 v19, s[32:35], s52 offen offset:3072 nt lds
s_waitcnt vmcnt(14)
s_barrier
s_add_u32 s55, s55, 64
s_add_u32 s54, s54, 262144
s_add_u32 m0, s59, 86016
s_nop 0
buffer_load_dwordx4 v10, s[28:31], s55 offen  lds
s_add_u32 m0, s58, 65536
s_nop 0
buffer_load_dwordx4 v12, s[40:43], s54 offen  lds
buffer_load_dwordx4 v13, s[40:43], s54 offen offset:1024  lds
buffer_load_dwordx4 v14, s[40:43], s54 offen offset:2048  lds
buffer_load_dwordx4 v15, s[40:43], s54 offen offset:3072  lds
s_mov_b32 s57, s8
s_waitcnt vmcnt(14)
s_barrier
s_add_u32 m0, s58, 16384
s_add_u32 s52, s26, 32768
buffer_load_dwordx4 v20, s[36:39], s52 offen nt lds
buffer_load_dwordx4 v23, s[36:39], s52 offen offset:1024 nt lds
buffer_load_dwordx4 v20, s[36:39], s52 offen offset:2048 nt lds
buffer_load_dwordx4 v23, s[36:39], s52 offen offset:3072 nt lds
s_waitcnt vmcnt(13)
s_barrier
s_waitcnt vmcnt(4)
s_barrier
s_barrier
s_add_u32 m0, s58, 32768
s_add_u32 s52, s26, 49152
buffer_load_dwordx4 v16, s[32:35], s52 offen nt lds
buffer_load_dwordx4 v17, s[32:35], s52 offen offset:1024 nt lds
buffer_load_dwordx4 v18, s[32:35], s52 offen offset:2048 nt lds
buffer_load_dwordx4 v19, s[32:35], s52 offen offset:3072 nt lds
s_barrier
s_add_u32 m0, s58, 49152
s_add_u32 s52, s26, 49152
buffer_load_dwordx4 v20, s[36:39], s52 offen nt lds
buffer_load_dwordx4 v23, s[36:39], s52 offen offset:1024 nt lds
buffer_load_dwordx4 v20, s[36:39], s52 offen offset:2048 nt lds
buffer_load_dwordx4 v23, s[36:39], s52 offen offset:3072 nt lds
s_barrier
s_add_u32 m0, s58, 65536
s_add_u32 s52, s26, 65536
buffer_load_dwordx4 v16, s[32:35], s52 offen nt lds
buffer_load_dwordx4 v17, s[32:35], s52 offen offset:1024 nt lds
buffer_load_dwordx4 v18, s[32:35], s52 offen offset:2048 nt lds
buffer_load_dwordx4 v19, s[32:35], s52 offen offset:3072 nt lds
v_lshrrev_b32 v5, 3, v0
v_mul_u32_u24 v6, 1152, v5
v_xor_b32 v7, v1, v2
v_and_b32 v7, 1, v7
v_lshl_add_u32 v6, v7, 6, v6
v_lshl_add_u32 v6, v4, 4, v6
v_add_u32 v24, 0, v6
v_add_u32 v25, 8192, v6
v_add_u32 v26, 16384, v6
v_add_u32 v27, 24576, v6
s_lshl_b32 s27, s7, 8
s_lshl_b32 s9, s24, 5
s_add_u32 s27, s27, s9
s_xor_b32 s25, s27, 256
s_mul_i32 s25, s25, 1152
s_and_b32 s57, s7, 1
s_lshl_b32 s57, s57, 2
s_add_u32 s57, s57, s8
v_lshlrev_b32 v63, 4, v0
s_mul_i32 s27, s27, 1152
v_lshlrev_b32 v21, 7, v0
v_min_u32 v22, 7, v0
v_lshlrev_b32 v22, 7, v22
v_add_u32 v22, 8192, v22
s_mov_b32 s44, s20
s_and_b32 s45, s21, 0xffff
s_mov_b32 s46, 0x480000
s_mov_b32 s47, 0x20000
s_mov_b32 s48, s22
s_and_b32 s49, s23, 0xffff
s_mov_b32 s50, 0x10000000
s_mov_b32 s51, 0x20000
s_mov_b32 s92, s96
s_and_b32 s93, s97, 0xffff
s_mov_b32 s94, 0x120000
s_mov_b32 s95, 0x20000
s_lshl_b32 s9, s6, 3
s_add_u32 s9, s9, s8
s_mul_i32 s56, s9, 0x200000
s_lshl_b32 s11, s9, 4
s_add_u32 s100, s98, s11
s_addc_u32 s101, s99, 0
s_mov_b32 s96, s98
s_and_b32 s97, s99, 0xffff
s_mov_b32 s98, 0x100
s_mov_b32 s99, 0x20000
v_and_b32 v6, 15, v0
v_lshlrev_b32 v28, 4, v6
v_lshl_add_u32 v28, v2, 11, v28
s_lshr_b32 s9, s24, 1
s_and_b32 s5, s24, 1
s_lshl_b32 s10, s5, 8
v_add_u32 v28, s10, v28
s_lshl_b32 s53, s9, 30
v_add_u32 v31, s53, v28
s_barrier
s_barrier
s_add_u32 m0, s58, 81920
s_add_u32 s52, s26, 65536
buffer_load_dwordx4 v20, s[36:39], s52 offen nt lds
buffer_load_dwordx4 v23, s[36:39], s52 offen offset:1024 nt lds
buffer_load_dwordx4 v20, s[36:39], s52 offen offset:2048 nt lds
buffer_load_dwordx4 v23, s[36:39], s52 offen offset:3072 nt lds
v_lshlrev_b32 v29, 4, v2
v_and_b32 v7, 7, v0
v_mul_u32_u24 v30, 2304, v7
v_and_b32 v7, 8, v0
v_lshl_add_u32 v30, v7, 1, v30
v_and_b32 v7, 16, v0
v_lshrrev_b32 v7, 1, v7
v_add_u32 v30, v7, v30
s_lshl_b32 s5, s5, 5
v_add_u32 v30, s5, v30
s_add_u32 s12, s8, s9
s_cmp_ge_u32 s12, 9
s_cselect_b32 s10, 9, 0
s_sub_u32 s12, s12, s10
s_add_u32 s13, s12, 2
s_cmp_ge_u32 s13, 9
s_cselect_b32 s10, 9, 0
s_sub_u32 s13, s13, s10
s_add_u32 s14, s13, 2
s_cmp_ge_u32 s14, 9
s_cselect_b32 s10, 9, 0
s_sub_u32 s14, s14, s10
s_add_u32 s15, s14, 2
s_cmp_ge_u32 s15, 9
s_cselect_b32 s10, 9, 0
s_sub_u32 s15, s15, s10
s_add_u32 s16, s15, 2
s_cmp_ge_u32 s16, 9
s_cselect_b32 s10, 9, 0
s_sub_u32 s16, s16, s10
s_lshl_b32 s10, s7, 13
s_add_u32 s10, s10, s56
s_lshl_b32 s20, s12, 17
s_add_u32 s20, s20, s10
s_lshl_b32 s12, s12, 7
s_lshl_b32 s21, s13, 17
s_add_u32 s21, s21, s10
s_lshl_b32 s13, s13, 7
s_lshl_b32 s22, s14, 17
s_add_u32 s22, s22, s10
s_lshl_b32 s14, s14, 7
s_lshl_b32 s23, s15, 17
s_add_u32 s23, s23, s10
s_lshl_b32 s15, s15, 7
s_lshl_b32 s4, s16, 17
s_add_u32 s4, s4, s10
s_lshl_b32 s16, s16, 7
s_or_b32 s16, s16, s53
v_cmp_gt_u32 vcc, 32, v0
v_mov_b32 v7, s12
v_mov_b32 v8, s13
v_cndmask_b32 v7, v8, v7, vcc
v_add_u32 v41, v7, v30
v_mov_b32 v7, s14
v_mov_b32 v8, s15
v_cndmask_b32 v7, v8, v7, vcc
v_add_u32 v42, v7, v30
v_mov_b32 v7, s16
v_mov_b32 v8, 0x40000000
v_cndmask_b32 v7, v8, v7, vcc
v_add_u32 v43, v7, v30
s_waitcnt vmcnt(16)
s_barrier
s_waitcnt vmcnt(12)
s_barrier
s_add_u32 m0, s58, 98304
s_add_u32 s52, s26, 81920
buffer_load_dwordx4 v16, s[32:35], s52 offen nt lds
buffer_load_dwordx4 v17, s[32:35], s52 offen offset:1024 nt lds
buffer_load_dwordx4 v18, s[32:35], s52 offen offset:2048 nt lds
buffer_load_dwordx4 v19, s[32:35], s52 offen offset:3072 nt lds
v_and_b32 v7, 1, v0
v_lshlrev_b32 v7, 4, v7
v_mov_b32 v8, 0x3f80
v_lshlrev_b32 v8, v7, v8
v_lshrrev_b32 v6, 1, v6
v_cmp_eq_u32 vcc, 0, v6
s_nop 1
v_cndmask_b32 v32, 0, v8, vcc
v_cmp_eq_u32 vcc, 1, v6
s_nop 1
v_cndmask_b32 v33, 0, v8, vcc
v_cmp_eq_u32 vcc, 2, v6
s_nop 1
v_cndmask_b32 v34, 0, v8, vcc
v_cmp_eq_u32 vcc, 3, v6
s_nop 1
v_cndmask_b32 v35, 0, v8, vcc
v_cmp_eq_u32 vcc, 4, v6
s_nop 1
v_cndmask_b32 v44, 0, v8, vcc
v_cmp_eq_u32 vcc, 5, v6
s_nop 1
v_cndmask_b32 v45, 0, v8, vcc
v_cmp_eq_u32 vcc, 6, v6
s_nop 1
v_cndmask_b32 v46, 0, v8, vcc
v_cmp_eq_u32 vcc, 7, v6
s_nop 1
v_cndmask_b32 v47, 0, v8, vcc
s_lshr_b32 s5, s11, 4
s_mul_i32 s5, s5, 0x1000
s_lshl_b32 s9, s7, 7
s_add_u32 s5, s5, 0xc000000
s_add_u32 s5, s5, s9
s_lshl_b32 s9, s24, 2
s_add_u32 s55, s5, s9
s_add_u32 s55, s55, 0x800
s_xor_b32 s9, s7, 1
s_lshl_b32 s9, s9, 2
s_add_u32 s9, s9, s24
s_lshl_b32 s9, s9, 13
s_add_u32 s54, s56, s9
s_add_u32 s54, s54, 0x140000
s_lshl_b32 s9, s7, 9
s_add_u32 s3, s56, s9
s_lshr_b32 s9, s7, 1
s_lshl_b32 s10, s8, 3
s_add_u32 s9, s9, s10
s_mul_i32 s10, s9, 18432
s_mul_i32 s9, s6, 1152
s_add_u32 s10, s10, s9
s_and_b32 s9, s7, 1
s_lshl_b32 s9, s9, 6
s_add_u32 s10, s10, s9
v_bfe_u32 v7, v0, 3, 2
v_lshlrev_b32 v36, 14, v7
v_lshrrev_b32 v7, 5, v0
v_lshl_add_u32 v36, v7, 7, v36
v_and_b32 v7, 7, v0
v_lshl_add_u32 v36, v7, 4, v36
s_and_b32 s9, s24, 1
s_lshl_b32 s9, s9, 16
s_lshr_b32 s52, s24, 1
s_lshl_b32 s52, s52, 13
s_add_u32 s9, s9, s52
v_add_u32 v36, s9, v36
v_mov_b32 v37, 0
v_mov_b32 v56, 0
v_mov_b32 v57, 0
v_mov_b32 v58, 0
v_mov_b32 v59, 0
v_lshlrev_b32 v52, 1, v2
v_add_u32 v52, 131136, v52
v_mov_b32 v51, 131136
s_waitcnt vmcnt(12)
s_barrier
s_add_u32 m0, s58, 114688
s_add_u32 s52, s26, 81920
buffer_load_dwordx4 v20, s[36:39], s52 offen nt lds
buffer_load_dwordx4 v23, s[36:39], s52 offen offset:1024 nt lds
buffer_load_dwordx4 v20, s[36:39], s52 offen offset:2048 nt lds
buffer_load_dwordx4 v23, s[36:39], s52 offen offset:3072 nt lds
s_waitcnt vmcnt(12)
s_barrier
s_add_u32 m0, s58, 131072
s_add_u32 s52, s26, 98304
buffer_load_dwordx4 v16, s[32:35], s52 offen nt lds
buffer_load_dwordx4 v17, s[32:35], s52 offen offset:1024 nt lds
buffer_load_dwordx4 v18, s[32:35], s52 offen offset:2048 nt lds
buffer_load_dwordx4 v19, s[32:35], s52 offen offset:3072 nt lds
s_mov_b32 s6, 1
s_cmp_lg_u32 s24, 0
s_cbranch_scc1 L_nochk2
s_load_dword s6, s[100:101], 0
L_nochk2:
s_waitcnt vmcnt(12)
s_barrier
s_add_u32 m0, s58, 147456
s_add_u32 s52, s26, 98304
buffer_load_dwordx4 v20, s[36:39], s52 offen nt lds
buffer_load_dwordx4 v23, s[36:39], s52 offen offset:1024 nt lds
buffer_load_dwordx4 v20, s[36:39], s52 offen offset:2048 nt lds
buffer_load_dwordx4 v23, s[36:39], s52 offen offset:3072 nt lds
s_waitcnt vmcnt(12)
s_barrier
s_add_u32 m0, s58, 0
s_add_u32 s52, s26, 114688
buffer_load_dwordx4 v16, s[32:35], s52 offen nt lds
buffer_load_dwordx4 v17, s[32:35], s52 offen offset:1024 nt lds
buffer_load_dwordx4 v18, s[32:35], s52 offen offset:2048 nt lds
buffer_load_dwordx4 v19, s[32:35], s52 offen offset:3072 nt lds
s_waitcnt vmcnt(12)
s_barrier
s_add_u32 m0, s58, 16384
s_add_u32 s52, s26, 114688
buffer_load_dwordx4 v20, s[36:39], s52 offen nt lds
buffer_load_dwordx4 v23, s[36:39], s52 offen offset:1024 nt lds
buffer_load_dwordx4 v20, s[36:39], s52 offen offset:2048 nt lds
buffer_load_dwordx4 v23, s[36:39], s52 offen offset:3072 nt lds
s_waitcnt vmcnt(12)
s_barrier
s_add_u32 m0, s58, 32768
s_add_u32 s53, s8, 8
s_cmp_ge_u32 s53, 9
s_cselect_b32 s52, 9, 0
s_sub_u32 s53, s53, s52
s_lshl_b32 s53, s53, 7
s_add_u32 s53, s53, s27
buffer_load_dwordx4 v24, s[44:47], s53 offen  lds
buffer_load_dwordx4 v25, s[44:47], s53 offen offset:1024  lds
buffer_load_dwordx4 v26, s[44:47], s53 offen offset:2048  lds
buffer_load_dwordx4 v27, s[44:47], s53 offen offset:3072  lds
s_waitcnt lgkmcnt(0)
s_cmp_eq_u32 s6, 1
s_cbranch_scc0 L_hs48
L_hsback48:
s_waitcnt vmcnt(12)
s_barrier
s_add_u32 m0, s58, 49152
s_add_u32 s53, s53, 147456
buffer_load_dwordx4 v24, s[44:47], s53 offen  lds
buffer_load_dwordx4 v25, s[44:47], s53 offen offset:1024  lds
buffer_load_dwordx4 v26, s[44:47], s53 offen offset:2048  lds
buffer_load_dwordx4 v27, s[44:47], s53 offen offset:3072  lds
s_waitcnt vmcnt(12)
s_barrier
s_add_u32 m0, s58, 65536
s_add_u32 s53, s57, 0
s_cmp_ge_u32 s53, 9
s_cselect_b32 s52, 9, 0
s_sub_u32 s53, s53, s52
s_lshl_b32 s53, s53, 7
s_add_u32 s53, s53, s27
buffer_load_dwordx4 v24, s[44:47], s53 offen  lds
buffer_load_dwordx4 v25, s[44:47], s53 offen offset:1024  lds
buffer_load_dwordx4 v26, s[44:47], s53 offen offset:2048  lds
buffer_load_dwordx4 v27, s[44:47], s53 offen offset:3072  lds
s_waitcnt vmcnt(12)
s_barrier
s_add_u32 m0, s58, 81920
s_add_u32 s53, s53, 147456
buffer_load_dwordx4 v24, s[44:47], s53 offen  lds
buffer_load_dwordx4 v25, s[44:47], s53 offen offset:1024  lds
buffer_load_dwordx4 v26, s[44:47], s53 offen offset:2048  lds
buffer_load_dwordx4 v27, s[44:47], s53 offen offset:3072  lds
s_waitcnt vmcnt(8)
s_barrier
s_add_u32 m0, s58, 98304
s_add_u32 s53, s57, 1
s_cmp_ge_u32 s53, 9
s_cselect_b32 s52, 9, 0
s_sub_u32 s53, s53, s52
s_lshl_b32 s53, s53, 7
s_add_u32 s53, s53, s27
buffer_load_dwordx4 v24, s[44:47], s53 offen  lds
buffer_load_dwordx4 v25, s[44:47], s53 offen offset:1024  lds
buffer_load_dwordx4 v26, s[44:47], s53 offen offset:2048  lds
buffer_load_dwordx4 v27, s[44:47], s53 offen offset:3072  lds
s_add_u32 m0, s58, 114688
s_add_u32 s53, s53, 147456
buffer_load_dwordx4 v24, s[44:47], s53 offen  lds
buffer_load_dwordx4 v25, s[44:47], s53 offen offset:1024  lds
buffer_load_dwordx4 v26, s[44:47], s53 offen offset:2048  lds
buffer_load_dwordx4 v27, s[44:47], s53 offen offset:3072  lds
s_barrier
s_buffer_load_dword s1, s[48:51], s55 glc
s_add_u32 m0, s58, 0
s_add_u32 s53, s57, 2
s_cmp_ge_u32 s53, 9
s_cselect_b32 s52, 9, 0
s_sub_u32 s53, s53, s52
s_lshl_b32 s53, s53, 7
s_add_u32 s53, s53, s27
buffer_load_dwordx4 v24, s[44:47], s53 offen  lds
buffer_load_dwordx4 v25, s[44:47], s53 offen offset:1024  lds
buffer_load_dwordx4 v26, s[44:47], s53 offen offset:2048  lds
buffer_load_dwordx4 v27, s[44:47], s53 offen offset:3072  lds
s_add_u32 m0, s58, 16384
s_add_u32 s53, s53, 147456
buffer_load_dwordx4 v24, s[44:47], s53 offen  lds
buffer_load_dwordx4 v25, s[44:47], s53 offen offset:1024  lds
buffer_load_dwordx4 v26, s[44:47], s53 offen offset:2048  lds
buffer_load_dwordx4 v27, s[44:47], s53 offen offset:3072  lds
s_waitcnt vmcnt(16)
s_barrier
s_waitcnt lgkmcnt(0)
s_cmp_eq_u32 s1, 1
s_cbranch_scc1 L_ze0
s_buffer_load_dword s1, s[48:51], s55 glc
s_add_u32 m0, s58, 32768
s_add_u32 s53, s57, 3
s_cmp_ge_u32 s53, 9
s_cselect_b32 s52, 9, 0
s_sub_u32 s53, s53, s52
s_lshl_b32 s53, s53, 7
s_add_u32 s53, s53, s27
buffer_load_dwordx4 v24, s[44:47], s53 offen  lds
buffer_load_dwordx4 v25, s[44:47], s53 offen offset:1024  lds
buffer_load_dwordx4 v26, s[44:47], s53 offen offset:2048  lds
buffer_load_dwordx4 v27, s[44:47], s53 offen offset:3072  lds
s_add_u32 m0, s58, 49152
s_add_u32 s53, s53, 147456
buffer_load_dwordx4 v24, s[44:47], s53 offen  lds
buffer_load_dwordx4 v25, s[44:47], s53 offen offset:1024  lds
buffer_load_dwordx4 v26, s[44:47], s53 offen offset:2048  lds
buffer_load_dwordx4 v27, s[44:47], s53 offen offset:3072  lds
s_waitcnt vmcnt(16)
s_barrier
s_waitcnt lgkmcnt(0)
s_cmp_eq_u32 s1, 1
s_cbranch_scc1 L_ze1
s_add_u32 m0, s58, 65536
s_add_u32 s53, s57, 0
s_cmp_ge_u32 s53, 9
s_cselect_b32 s52, 9, 0
s_sub_u32 s53, s53, s52
s_lshl_b32 s53, s53, 7
s_add_u32 s53, s53, s25
buffer_load_dwordx4 v24, s[44:47], s53 offen  lds
buffer_load_dwordx4 v25, s[44:47], s53 offen offset:1024  lds
buffer_load_dwordx4 v26, s[44:47], s53 offen offset:2048  lds
buffer_load_dwordx4 v27, s[44:47], s53 offen offset:3072  lds
s_add_u32 m0, s58, 81920
s_add_u32 s53, s53, 147456
buffer_load_dwordx4 v24, s[44:47], s53 offen  lds
buffer_load_dwordx4 v25, s[44:47], s53 offen offset:1024  lds
buffer_load_dwordx4 v26, s[44:47], s53 offen offset:2048  lds
buffer_load_dwordx4 v27, s[44:47], s53 offen offset:3072  lds
s_waitcnt vmcnt(16)
s_barrier
s_add_u32 m0, s58, 98304
s_add_u32 s53, s57, 1
s_cmp_ge_u32 s53, 9
s_cselect_b32 s52, 9, 0
s_sub_u32 s53, s53, s52
s_lshl_b32 s53, s53, 7
s_add_u32 s53, s53, s25
buffer_load_dwordx4 v24, s[44:47], s53 offen  lds
buffer_load_dwordx4 v25, s[44:47], s53 offen offset:1024  lds
buffer_load_dwordx4 v26, s[44:47], s53 offen offset:2048  lds
buffer_load_dwordx4 v27, s[44:47], s53 offen offset:3072  lds
s_add_u32 m0, s58, 114688
s_add_u32 s53, s53, 147456
buffer_load_dwordx4 v24, s[44:47], s53 offen  lds
buffer_load_dwordx4 v25, s[44:47], s53 offen offset:1024  lds
buffer_load_dwordx4 v26, s[44:47], s53 offen offset:2048  lds
buffer_load_dwordx4 v27, s[44:47], s53 offen offset:3072  lds
s_mov_b32 s52, 0
L_zp61:
s_buffer_load_dword s9, s[48:51], s55 glc
s_add_u32 s52, s52, 1
s_waitcnt lgkmcnt(0)
s_cmp_eq_u32 s9, 1
s_cbranch_scc1 L_zok61
s_cmp_lt_u32 s52, 64
s_cbranch_scc1 L_zp61
s_branch L_zv61
L_zok61:
s_lshl_b32 s9, s58, 1
s_add_u32 m0, s9, 131072
s_nop 0
buffer_load_dwordx4 v63, s[48:51], s54 offen sc1 lds
buffer_load_dwordx4 v63, s[48:51], s54 offen offset:1024 sc1 lds
buffer_load_dwordx4 v63, s[48:51], s54 offen offset:2048 sc1 lds
buffer_load_dwordx4 v63, s[48:51], s54 offen offset:3072 sc1 lds
s_lshl_b32 s9, s58, 1
s_add_u32 m0, s9, 135168
s_add_u32 s54, s54, 4096
buffer_load_dwordx4 v63, s[48:51], s54 offen sc1 lds
buffer_load_dwordx4 v63, s[48:51], s54 offen offset:1024 sc1 lds
buffer_load_dwordx4 v63, s[48:51], s54 offen offset:2048 sc1 lds
buffer_load_dwordx4 v63, s[48:51], s54 offen offset:3072 sc1 lds
s_waitcnt vmcnt(24)
s_barrier
s_add_u32 m0, s58, 0
s_add_u32 s53, s57, 2
s_cmp_ge_u32 s53, 9
s_cselect_b32 s52, 9, 0
s_sub_u32 s53, s53, s52
s_lshl_b32 s53, s53, 7
s_add_u32 s53, s53, s25
buffer_load_dwordx4 v24, s[44:47], s53 offen  lds
buffer_load_dwordx4 v25, s[44:47], s53 offen offset:1024  lds
buffer_load_dwordx4 v26, s[44:47], s53 offen offset:2048  lds
buffer_load_dwordx4 v27, s[44:47], s53 offen offset:3072  lds
s_add_u32 m0, s58, 16384
s_add_u32 s53, s53, 147456
buffer_load_dwordx4 v24, s[44:47], s53 offen  lds
buffer_load_dwordx4 v25, s[44:47], s53 offen offset:1024  lds
buffer_load_dwordx4 v26, s[44:47], s53 offen offset:2048  lds
buffer_load_dwordx4 v27, s[44:47], s53 offen offset:3072  lds
s_waitcnt vmcnt(8)
s_barrier
s_add_u32 m0, s58, 32768
s_add_u32 s53, s57, 3
s_cmp_ge_u32 s53, 9
s_cselect_b32 s52, 9, 0
s_sub_u32 s53, s53, s52
s_lshl_b32 s53, s53, 7
s_add_u32 s53, s53, s25
buffer_load_dwordx4 v24, s[44:47], s53 offen  lds
buffer_load_dwordx4 v25, s[44:47], s53 offen offset:1024  lds
buffer_load_dwordx4 v26, s[44:47], s53 offen offset:2048  lds
buffer_load_dwordx4 v27, s[44:47], s53 offen offset:3072  lds
s_add_u32 m0, s58, 49152
s_add_u32 s53, s53, 147456
buffer_load_dwordx4 v24, s[44:47], s53 offen  lds
buffer_load_dwordx4 v25, s[44:47], s53 offen offset:1024  lds
buffer_load_dwordx4 v26, s[44:47], s53 offen offset:2048  lds
buffer_load_dwordx4 v27, s[44:47], s53 offen offset:3072  lds
s_barrier
s_waitcnt vmcnt(8)
s_barrier
ds_write_b128 v51, v[56:59]
ds_write_b128 v51, v[56:59] offset:16
s_waitcnt lgkmcnt(0)
s_waitcnt vmcnt(0)
s_barrier
s_branch L_ltail
L_var3:
s_lshl_b32 s55, s57, 7
s_add_u32 s55, s55, s4
s_lshl_b32 s54, s57, 19
s_add_u32 s54, s54, s25
s_add_u32 m0, s59, 90112
s_nop 0
buffer_load_dwordx4 v10, s[28:31], s55 offen  lds
s_add_u32 m0, s58, 16384
s_nop 0
buffer_load_dwordx4 v12, s[40:43], s54 offen  lds
buffer_load_dwordx4 v13, s[40:43], s54 offen offset:1024  lds
buffer_load_dwordx4 v14, s[40:43], s54 offen offset:2048  lds
buffer_load_dwordx4 v15, s[40:43], s54 offen offset:3072  lds
s_add_u32 s57, s57, 1
s_cmp_eq_u32 s57, 9
s_cselect_b32 s57, 0, s57
s_add_u32 s55, s55, 64
s_add_u32 s54, s54, 262144
s_add_u32 m0, s59, 94208
s_nop 0
buffer_load_dwordx4 v10, s[28:31], s55 offen  lds
s_add_u32 m0, s58, 32768
s_nop 0
buffer_load_dwordx4 v12, s[40:43], s54 offen  lds
buffer_load_dwordx4 v13, s[40:43], s54 offen offset:1024  lds
buffer_load_dwordx4 v14, s[40:43], s54 offen offset:2048  lds
buffer_load_dwordx4 v15, s[40:43], s54 offen offset:3072  lds
s_waitcnt vmcnt(15)
s_barrier
s_waitcnt vmcnt(10)
s_barrier
s_lshl_b32 s55, s57, 7
s_add_u32 s55, s55, s4
s_lshl_b32 s54, s57, 19
s_add_u32 s54, s54, s25
s_add_u32 m0, s59, 81920
s_nop 0
buffer_load_dwordx4 v10, s[28:31], s55 offen  lds
s_add_u32 m0, s58, 49152
s_nop 0
buffer_load_dwordx4 v12, s[40:43], s54 offen  lds
buffer_load_dwordx4 v13, s[40:43], s54 offen offset:1024  lds
buffer_load_dwordx4 v14, s[40:43], s54 offen offset:2048  lds
buffer_load_dwordx4 v15, s[40:43], s54 offen offset:3072  lds
s_add_u32 s57, s57, 1
s_cmp_eq_u32 s57, 9
s_cselect_b32 s57, 0, s57
s_waitcnt vmcnt(10)
s_barrier
s_add_u32 s55, s55, 64
s_add_u32 s54, s54, 262144
s_add_u32 m0, s59, 86016
s_nop 0
buffer_load_dwordx4 v10, s[28:31], s55 offen  lds
s_add_u32 m0, s58, 65536
s_nop 0
buffer_load_dwordx4 v12, s[40:43], s54 offen  lds
buffer_load_dwordx4 v13, s[40:43], s54 offen offset:1024  lds
buffer_load_dwordx4 v14, s[40:43], s54 offen offset:2048  lds
buffer_load_dwordx4 v15, s[40:43], s54 offen offset:3072  lds
s_waitcnt vmcnt(10)
s_barrier
s_lshl_b32 s55, s57, 7
s_add_u32 s55, s55, s4
s_lshl_b32 s54, s57, 19
s_add_u32 s54, s54, s25
s_add_u32 m0, s59, 90112
s_nop 0
buffer_load_dwordx4 v10, s[28:31], s55 offen  lds
s_add_u32 m0, s58, 16384
s_nop 0
buffer_load_dwordx4 v12, s[40:43], s54 offen  lds
buffer_load_dwordx4 v13, s[40:43], s54 offen offset:1024  lds
buffer_load_dwordx4 v14, s[40:43], s54 offen offset:2048  lds
buffer_load_dwordx4 v15, s[40:43], s54 offen offset:3072  lds
s_add_u32 s57, s57, 1
s_cmp_eq_u32 s57, 9
s_cselect_b32 s57, 0, s57
s_add_u32 m0, s58, 98304
s_add_u32 s52, s26, 0
buffer_load_dwordx4 v16, s[32:35], s52 offen nt lds
buffer_load_dwordx4 v17, s[32:35], s52 offen offset:1024 nt lds
buffer_load_dwordx4 v18, s[32:35], s52 offen offset:2048 nt lds
buffer_load_dwordx4 v19, s[32:35], s52 offen offset:3072 nt lds
s_add_u32 m0, s58, 114688
s_add_u32 s52, s26, 0
buffer_load_dwordx4 v20, s[36:39], s52 offen nt lds
buffer_load_dwordx4 v23, s[36:39], s52 offen offset:1024 nt lds
buffer_load_dwordx4 v20, s[36:39], s52 offen offset:2048 nt lds
buffer_load_dwordx4 v23, s[36:39], s52 offen offset:3072 nt lds
s_waitcnt vmcnt(18)
s_barrier
s_add_u32 s55, s55, 64
s_add_u32 s54, s54, 262144
s_add_u32 m0, s59, 94208
s_nop 0
buffer_load_dwordx4 v10, s[28:31], s55 offen  lds
s_add_u32 m0, s58, 32768
s_nop 0
buffer_load_dwordx4 v12, s[40:43], s54 offen  lds
buffer_load_dwordx4 v13, s[40:43], s54 offen offset:1024  lds
buffer_load_dwordx4 v14, s[40:43], s54 offen offset:2048  lds
buffer_load_dwordx4 v15, s[40:43], s54 offen offset:3072  lds
s_waitcnt vmcnt(18)
s_barrier
s_lshl_b32 s55, s57, 7
s_add_u32 s55, s55, s4
s_lshl_b32 s54, s57, 19
s_add_u32 s54, s54, s25
s_add_u32 m0, s59, 81920
s_nop 0
buffer_load_dwordx4 v10, s[28:31], s55 offen  lds
s_add_u32 m0, s58, 49152
s_nop 0
buffer_load_dwordx4 v12, s[40:43], s54 offen  lds
buffer_load_dwordx4 v13, s[40:43], s54 offen offset:1024  lds
buffer_load_dwordx4 v14, s[40:43], s54 offen offset:2048  lds
buffer_load_dwordx4 v15, s[40:43], s54 offen offset:3072  lds
s_add_u32 s57, s57, 1
s_cmp_eq_u32 s57, 9
s_cselect_b32 s57, 0, s57
s_waitcnt vmcnt(18)
s_barrier
s_add_u32 s55, s55, 64
s_add_u32 s54, s54, 262144
s_add_u32 m0, s59, 86016
s_nop 0
buffer_load_dwordx4 v10, s[28:31], s55 offen  lds
s_add_u32 m0, s58, 65536
s_nop 0
buffer_load_dwordx4 v12, s[40:43], s54 offen  lds
buffer_load_dwordx4 v13, s[40:43], s54 offen offset:1024  lds
buffer_load_dwordx4 v14, s[40:43], s54 offen offset:2048  lds
buffer_load_dwordx4 v15, s[40:43], s54 offen offset:3072  lds
s_waitcnt vmcnt(10)
s_barrier
s_lshl_b32 s55, s57, 7
s_add_u32 s55, s55, s4
s_lshl_b32 s54, s57, 19
s_add_u32 s54, s54, s25
s_add_u32 m0, s59, 90112
s_nop 0
buffer_load_dwordx4 v10, s[28:31], s55 offen  lds
s_add_u32 m0, s58, 16384
s_nop 0
buffer_load_dwordx4 v12, s[40:43], s54 offen  lds
buffer_load_dwordx4 v13, s[40:43], s54 offen offset:1024  lds
buffer_load_dwordx4 v14, s[40:43], s54 offen offset:2048  lds
buffer_load_dwordx4 v15, s[40:43], s54 offen offset:3072  lds
s_add_u32 s57, s57, 1
s_cmp_eq_u32 s57, 9
s_cselect_b32 s57, 0, s57
s_waitcnt vmcnt(10)
s_barrier
s_add_u32 s55, s55, 64
s_add_u32 s54, s54, 262144
s_add_u32 m0, s59, 94208
s_nop 0
buffer_load_dwordx4 v10, s[28:31], s55 offen  lds
s_add_u32 m0, s58, 32768
s_nop 0
buffer_load_dwordx4 v12, s[40:43], s54 offen  lds
buffer_load_dwordx4 v13, s[40:43], s54 offen offset:1024  lds
buffer_load_dwordx4 v14, s[40:43], s54 offen offset:2048  lds
buffer_load_dwordx4 v15, s[40:43], s54 offen offset:3072  lds
s_waitcnt vmcnt(10)
s_barrier
s_lshl_b32 s55, s57, 7
s_add_u32 s55, s55, s4
s_lshl_b32 s54, s57, 19
s_add_u32 s54, s54, s25
s_add_u32 m0, s59, 81920
s_nop 0
buffer_load_dwordx4 v10, s[28:31], s55 offen  lds
s_add_u32 m0, s58, 49152
s_nop 0
buffer_load_dwordx4 v12, s[40:43], s54 offen  lds
buffer_load_dwordx4 v13, s[40:43], s54 offen offset:1024  lds
buffer_load_dwordx4 v14, s[40:43], s54 offen offset:2048  lds
buffer_load_dwordx4 v15, s[40:43], s54 offen offset:3072  lds
s_add_u32 s57, s57, 1
s_cmp_eq_u32 s57, 9
s_cselect_b32 s57, 0, s57
s_add_u32 m0, s58, 131072
s_add_u32 s52, s26, 16384
buffer_load_dwordx4 v16, s[32:35], s52 offen nt lds
buffer_load_dwordx4 v17, s[32:35], s52 offen offset:1024 nt lds
buffer_load_dwordx4 v18, s[32:35], s52 offen offset:2048 nt lds
buffer_load_dwordx4 v19, s[32:35], s52 offen offset:3072 nt lds
s_add_u32 m0, s58, 147456
s_add_u32 s52, s26, 16384
buffer_load_dwordx4 v20, s[36:39], s52 offen nt lds
buffer_load_dwordx4 v23, s[36:39], s52 offen offset:1024 nt lds
buffer_load_dwordx4 v20, s[36:39], s52 offen offset:2048 nt lds
buffer_load_dwordx4 v23, s[36:39], s52 offen offset:3072 nt lds
s_waitcnt vmcnt(18)
s_barrier
s_add_u32 s55, s55, 64
s_add_u32 s54, s54, 262144
s_add_u32 m0, s59, 86016
s_nop 0
buffer_load_dwordx4 v10, s[28:31], s55 offen  lds
s_add_u32 m0, s58, 65536
s_nop 0
buffer_load_dwordx4 v12, s[40:43], s54 offen  lds
buffer_load_dwordx4 v13, s[40:43], s54 offen offset:1024  lds
buffer_load_dwordx4 v14, s[40:43], s54 offen offset:2048  lds
buffer_load_dwordx4 v15, s[40:43], s54 offen offset:3072  lds
s_waitcnt vmcnt(18)
s_barrier
s_lshl_b32 s55, s57, 7
s_add_u32 s55, s55, s4
s_lshl_b32 s54, s57, 19
s_add_u32 s54, s54, s25
s_add_u32 m0, s59, 90112
s_nop 0
buffer_load_dwordx4 v10, s[28:31], s55 offen  lds
s_add_u32 m0, s58, 16384
s_nop 0
buffer_load_dwordx4 v12, s[40:43], s54 offen  lds
buffer_load_dwordx4 v13, s[40:43], s54 offen offset:1024  lds
buffer_load_dwordx4 v14, s[40:43], s54 offen offset:2048  lds
buffer_load_dwordx4 v15, s[40:43], s54 offen offset:3072  lds
s_add_u32 s57, s57, 1
s_cmp_eq_u32 s57, 9
s_cselect_b32 s57, 0, s57
s_waitcnt vmcnt(18)
s_barrier
s_add_u32 s55, s55, 64
s_add_u32 s54, s54, 262144
s_add_u32 m0, s59, 94208
s_nop 0
buffer_load_dwordx4 v10, s[28:31], s55 offen  lds
s_add_u32 m0, s58, 32768
s_nop 0
buffer_load_dwordx4 v12, s[40:43], s54 offen  lds
buffer_load_dwordx4 v13, s[40:43], s54 offen offset:1024  lds
buffer_load_dwordx4 v14, s[40:43], s54 offen offset:2048  lds
buffer_load_dwordx4 v15, s[40:43], s54 offen offset:3072  lds
s_waitcnt vmcnt(10)
s_barrier
s_lshl_b32 s55, s57, 7
s_add_u32 s55, s55, s4
s_lshl_b32 s54, s57, 19
s_add_u32 s54, s54, s25
s_add_u32 m0, s59, 81920
s_nop 0
buffer_load_dwordx4 v10, s[28:31], s55 offen  lds
s_add_u32 m0, s58, 49152
s_nop 0
buffer_load_dwordx4 v12, s[40:43], s54 offen  lds
buffer_load_dwordx4 v13, s[40:43], s54 offen offset:1024  lds
buffer_load_dwordx4 v14, s[40:43], s54 offen offset:2048  lds
buffer_load_dwordx4 v15, s[40:43], s54 offen offset:3072  lds
s_add_u32 s57, s57, 1
s_cmp_eq_u32 s57, 9
s_cselect_b32 s57, 0, s57
s_waitcnt vmcnt(10)
s_barrier
s_add_u32 s55, s55, 64
s_add_u32 s54, s54, 262144
s_add_u32 m0, s59, 86016
s_nop 0
buffer_load_dwordx4 v10, s[28:31], s55 offen  lds
s_add_u32 m0, s58, 65536
s_nop 0
buffer_load_dwordx4 v12, s[40:43], s54 offen  lds
buffer_load_dwordx4 v13, s[40:43], s54 offen offset:1024  lds
buffer_load_dwordx4 v14, s[40:43], s54 offen offset:2048  lds
buffer_load_dwordx4 v15, s[40:43], s54 offen offset:3072  lds
s_mov_b32 s57, s8
s_add_u32 m0, s58, 0
s_add_u32 s52, s26, 32768
buffer_load_dwordx4 v16, s[32:35], s52 offen nt lds
buffer_load_dwordx4 v17, s[32:35], s52 offen offset:1024 nt lds
buffer_load_dwordx4 v18, s[32:35], s52 offen offset:2048 nt lds
buffer_load_dwordx4 v19, s[32:35], s52 offen offset:3072 nt lds
s_waitcnt vmcnt(14)
s_barrier
s_add_u32 m0, s58, 16384
s_add_u32 s52, s26, 32768
buffer_load_dwordx4 v20, s[36:39], s52 offen nt lds
buffer_load_dwordx4 v23, s[36:39], s52 offen offset:1024 nt lds
buffer_load_dwordx4 v20, s[36:39], s52 offen offset:2048 nt lds
buffer_load_dwordx4 v23, s[36:39], s52 offen offset:3072 nt lds
s_waitcnt vmcnt(13)
s_barrier
s_waitcnt vmcnt(8)
s_barrier
s_barrier
s_add_u32 m0, s58, 32768
s_add_u32 s52, s26, 49152
buffer_load_dwordx4 v16, s[32:35], s52 offen nt lds
buffer_load_dwordx4 v17, s[32:35], s52 offen offset:1024 nt lds
buffer_load_dwordx4 v18, s[32:35], s52 offen offset:2048 nt lds
buffer_load_dwordx4 v19, s[32:35], s52 offen offset:3072 nt lds
s_barrier
s_add_u32 m0, s58, 49152
s_add_u32 s52, s26, 49152
buffer_load_dwordx4 v20, s[36:39], s52 offen nt lds
buffer_load_dwordx4 v23, s[36:39], s52 offen offset:1024 nt lds
buffer_load_dwordx4 v20, s[36:39], s52 offen offset:2048 nt lds
buffer_load_dwordx4 v23, s[36:39], s52 offen offset:3072 nt lds
s_barrier
s_add_u32 m0, s58, 65536
s_add_u32 s52, s26, 65536
buffer_load_dwordx4 v16, s[32:35], s52 offen nt lds
buffer_load_dwordx4 v17, s[32:35], s52 offen offset:1024 nt lds
buffer_load_dwordx4 v18, s[32:35], s52 offen offset:2048 nt lds
buffer_load_dwordx4 v19, s[32:35], s52 offen offset:3072 nt lds
v_lshrrev_b32 v5, 3, v0
v_mul_u32_u24 v6, 1152, v5
v_xor_b32 v7, v1, v2
v_and_b32 v7, 1, v7
v_lshl_add_u32 v6, v7, 6, v6
v_lshl_add_u32 v6, v4, 4, v6
v_add_u32 v24, 0, v6
v_add_u32 v25, 8192, v6
v_add_u32 v26, 16384, v6
v_add_u32 v27, 24576, v6
s_lshl_b32 s27, s7, 8
s_lshl_b32 s9, s24, 5
s_add_u32 s27, s27, s9
s_xor_b32 s25, s27, 256
s_mul_i32 s25, s25, 1152
s_and_b32 s57, s7, 1
s_lshl_b32 s57, s57, 2
s_add_u32 s57, s57, s8
v_lshlrev_b32 v63, 4, v0
s_mul_i32 s27, s27, 1152
v_lshlrev_b32 v21, 7, v0
v_min_u32 v22, 7, v0
v_lshlrev_b32 v22, 7, v22
v_add_u32 v22, 8192, v22
s_mov_b32 s44, s20
s_and_b32 s45, s21, 0xffff
s_mov_b32 s46, 0x480000
s_mov_b32 s47, 0x20000
s_mov_b32 s48, s22
s_and_b32 s49, s23, 0xffff
s_mov_b32 s50, 0x10000000
s_mov_b32 s51, 0x20000
s_mov_b32 s92, s96
s_and_b32 s93, s97, 0xffff
s_mov_b32 s94, 0x120000
s_mov_b32 s95, 0x20000
s_lshl_b32 s9, s6, 3
s_add_u32 s9, s9, s8
s_mul_i32 s56, s9, 0x200000
s_lshl_b32 s11, s9, 4
s_add_u32 s100, s98, s11
s_addc_u32 s101, s99, 0
s_mov_b32 s96, s98
s_and_b32 s97, s99, 0xffff
s_mov_b32 s98, 0x100
s_mov_b32 s99, 0x20000
v_and_b32 v6, 15, v0
v_lshlrev_b32 v28, 4, v6
v_lshl_add_u32 v28, v2, 11, v28
s_lshr_b32 s9, s24, 1
s_and_b32 s5, s24, 1
s_lshl_b32 s10, s5, 8
v_add_u32 v28, s10, v28
s_lshl_b32 s53, s9, 30
v_add_u32 v31, s53, v28
s_barrier
s_waitcnt vmcnt(16)
s_barrier
s_add_u32 m0, s58, 81920
s_add_u32 s52, s26, 65536
buffer_load_dwordx4 v20, s[36:39], s52 offen nt lds
buffer_load_dwordx4 v23, s[36:39], s52 offen offset:1024 nt lds
buffer_load_dwordx4 v20, s[36:39], s52 offen offset:2048 nt lds
buffer_load_dwordx4 v23, s[36:39], s52 offen offset:3072 nt lds
v_lshlrev_b32 v29, 4, v2
v_and_b32 v7, 7, v0
v_mul_u32_u24 v30, 2304, v7
v_and_b32 v7, 8, v0
v_lshl_add_u32 v30, v7, 1, v30
v_and_b32 v7, 16, v0
v_lshrrev_b32 v7, 1, v7
v_add_u32 v30, v7, v30
s_lshl_b32 s5, s5, 5
v_add_u32 v30, s5, v30
s_add_u32 s12, s8, s9
s_cmp_ge_u32 s12, 9
s_cselect_b32 s10, 9, 0
s_sub_u32 s12, s12, s10
s_add_u32 s13, s12, 2
s_cmp_ge_u32 s13, 9
s_cselect_b32 s10, 9, 0
s_sub_u32 s13, s13, s10
s_add_u32 s14, s13, 2
s_cmp_ge_u32 s14, 9
s_cselect_b32 s10, 9, 0
s_sub_u32 s14, s14, s10
s_add_u32 s15, s14, 2
s_cmp_ge_u32 s15, 9
s_cselect_b32 s10, 9, 0
s_sub_u32 s15, s15, s10
s_add_u32 s16, s15, 2
s_cmp_ge_u32 s16, 9
s_cselect_b32 s10, 9, 0
s_sub_u32 s16, s16, s10
s_lshl_b32 s10, s7, 13
s_add_u32 s10, s10, s56
s_lshl_b32 s20, s12, 17
s_add_u32 s20, s20, s10
s_lshl_b32 s12, s12, 7
s_lshl_b32 s21, s13, 17
s_add_u32 s21, s21, s10
s_lshl_b32 s13, s13, 7
s_lshl_b32 s22, s14, 17
s_add_u32 s22, s22, s10
s_lshl_b32 s14, s14, 7
s_lshl_b32 s23, s15, 17
s_add_u32 s23, s23, s10
s_lshl_b32 s15, s15, 7
s_lshl_b32 s4, s16, 17
s_add_u32 s4, s4, s10
s_lshl_b32 s16, s16, 7
s_or_b32 s16, s16, s53
v_cmp_gt_u32 vcc, 32, v0
v_mov_b32 v7, s12
v_mov_b32 v8, s13
v_cndmask_b32 v7, v8, v7, vcc
v_add_u32 v41, v7, v30
v_mov_b32 v7, s14
v_mov_b32 v8, s15
v_cndmask_b32 v7, v8, v7, vcc
v_add_u32 v42, v7, v30
v_mov_b32 v7, s16
v_mov_b32 v8, 0x40000000
v_cndmask_b32 v7, v8, v7, vcc
v_add_u32 v43, v7, v30
s_waitcnt vmcnt(16)
s_barrier
s_waitcnt vmcnt(12)
s_barrier
s_add_u32 m0, s58, 98304
s_add_u32 s52, s26, 81920
buffer_load_dwordx4 v16, s[32:35], s52 offen nt lds
buffer_load_dwordx4 v17, s[32:35], s52 offen offset:1024 nt lds
buffer_load_dwordx4 v18, s[32:35], s52 offen offset:2048 nt lds
buffer_load_dwordx4 v19, s[32:35], s52 offen offset:3072 nt lds
v_and_b32 v7, 1, v0
v_lshlrev_b32 v7, 4, v7
v_mov_b32 v8, 0x3f80
v_lshlrev_b32 v8, v7, v8
v_lshrrev_b32 v6, 1, v6
v_cmp_eq_u32 vcc, 0, v6
s_nop 1
v_cndmask_b32 v32, 0, v8, vcc
v_cmp_eq_u32 vcc, 1, v6
s_nop 1
v_cndmask_b32 v33, 0, v8, vcc
v_cmp_eq_u32 vcc, 2, v6
s_nop 1
v_cndmask_b32 v34, 0, v8, vcc
v_cmp_eq_u32 vcc, 3, v6
s_nop 1
v_cndmask_b32 v35, 0, v8, vcc
v_cmp_eq_u32 vcc, 4, v6
s_nop 1
v_cndmask_b32 v44, 0, v8, vcc
v_cmp_eq_u32 vcc, 5, v6
s_nop 1
v_cndmask_b32 v45, 0, v8, vcc
v_cmp_eq_u32 vcc, 6, v6
s_nop 1
v_cndmask_b32 v46, 0, v8, vcc
v_cmp_eq_u32 vcc, 7, v6
s_nop 1
v_cndmask_b32 v47, 0, v8, vcc
s_lshr_b32 s5, s11, 4
s_mul_i32 s5, s5, 0x1000
s_lshl_b32 s9, s7, 7
s_add_u32 s5, s5, 0xc000000
s_add_u32 s5, s5, s9
s_lshl_b32 s9, s24, 2
s_add_u32 s55, s5, s9
s_add_u32 s55, s55, 0x800
s_xor_b32 s9, s7, 1
s_lshl_b32 s9, s9, 2
s_add_u32 s9, s9, s24
s_lshl_b32 s9, s9, 13
s_add_u32 s54, s56, s9
s_add_u32 s54, s54, 0x140000
s_lshl_b32 s9, s7, 9
s_add_u32 s3, s56, s9
s_lshr_b32 s9, s7, 1
s_lshl_b32 s10, s8, 3
s_add_u32 s9, s9, s10
s_mul_i32 s10, s9, 18432
s_mul_i32 s9, s6, 1152
s_add_u32 s10, s10, s9
s_and_b32 s9, s7, 1
s_lshl_b32 s9, s9, 6
s_add_u32 s10, s10, s9
v_bfe_u32 v7, v0, 3, 2
v_lshlrev_b32 v36, 14, v7
v_lshrrev_b32 v7, 5, v0
v_lshl_add_u32 v36, v7, 7, v36
v_and_b32 v7, 7, v0
v_lshl_add_u32 v36, v7, 4, v36
s_and_b32 s9, s24, 1
s_lshl_b32 s9, s9, 16
s_lshr_b32 s52, s24, 1
s_lshl_b32 s52, s52, 13
s_add_u32 s9, s9, s52
v_add_u32 v36, s9, v36
v_mov_b32 v37, 0
v_mov_b32 v56, 0
v_mov_b32 v57, 0
v_mov_b32 v58, 0
v_mov_b32 v59, 0
v_lshlrev_b32 v52, 1, v2
v_add_u32 v52, 131136, v52
v_mov_b32 v51, 131136
s_waitcnt vmcnt(12)
s_barrier
s_add_u32 m0, s58, 114688
s_add_u32 s52, s26, 81920
buffer_load_dwordx4 v20, s[36:39], s52 offen nt lds
buffer_load_dwordx4 v23, s[36:39], s52 offen offset:1024 nt lds
buffer_load_dwordx4 v20, s[36:39], s52 offen offset:2048 nt lds
buffer_load_dwordx4 v23, s[36:39], s52 offen offset:3072 nt lds
s_waitcnt vmcnt(12)
s_barrier
s_add_u32 m0, s58, 131072
s_add_u32 s52, s26, 98304
buffer_load_dwordx4 v16, s[32:35], s52 offen nt lds
buffer_load_dwordx4 v17, s[32:35], s52 offen offset:1024 nt lds
buffer_load_dwordx4 v18, s[32:35], s52 offen offset:2048 nt lds
buffer_load_dwordx4 v19, s[32:35], s52 offen offset:3072 nt lds
s_mov_b32 s6, 1
s_cmp_lg_u32 s24, 0
s_cbranch_scc1 L_nochk3
s_load_dword s6, s[100:101], 0
L_nochk3:
s_waitcnt vmcnt(12)
s_barrier
s_add_u32 m0, s58, 147456
s_add_u32 s52, s26, 98304
buffer_load_dwordx4 v20, s[36:39], s52 offen nt lds
buffer_load_dwordx4 v23, s[36:39], s52 offen offset:1024 nt lds
buffer_load_dwordx4 v20, s[36:39], s52 offen offset:2048 nt lds
buffer_load_dwordx4 v23, s[36:39], s52 offen offset:3072 nt lds
s_waitcnt vmcnt(12)
s_barrier
s_add_u32 m0, s58, 0
s_add_u32 s52, s26, 114688
buffer_load_dwordx4 v16, s[32:35], s52 offen nt lds
buffer_load_dwordx4 v17, s[32:35], s52 offen offset:1024 nt lds
buffer_load_dwordx4 v18, s[32:35], s52 offen offset:2048 nt lds
buffer_load_dwordx4 v19, s[32:35], s52 offen offset:3072 nt lds
s_waitcnt vmcnt(12)
s_barrier
s_add_u32 m0, s58, 16384
s_add_u32 s52, s26, 114688
buffer_load_dwordx4 v20, s[36:39], s52 offen nt lds
buffer_load_dwordx4 v23, s[36:39], s52 offen offset:1024 nt lds
buffer_load_dwordx4 v20, s[36:39], s52 offen offset:2048 nt lds
buffer_load_dwordx4 v23, s[36:39], s52 offen offset:3072 nt lds
s_waitcnt vmcnt(12)
s_barrier
s_add_u32 m0, s58, 32768
s_add_u32 s53, s8, 8
s_cmp_ge_u32 s53, 9
s_cselect_b32 s52, 9, 0
s_sub_u32 s53, s53, s52
s_lshl_b32 s53, s53, 7
s_add_u32 s53, s53, s27
buffer_load_dwordx4 v24, s[44:47], s53 offen  lds
buffer_load_dwordx4 v25, s[44:47], s53 offen offset:1024  lds
buffer_load_dwordx4 v26, s[44:47], s53 offen offset:2048  lds
buffer_load_dwordx4 v27, s[44:47], s53 offen offset:3072  lds
s_waitcnt lgkmcnt(0)
s_cmp_eq_u32 s6, 1
s_cbranch_scc0 L_hs72
L_hsback72:
s_waitcnt vmcnt(12)
s_barrier
s_add_u32 m0, s58, 49152
s_add_u32 s53, s53, 147456
buffer_load_dwordx4 v24, s[44:47], s53 offen  lds
buffer_load_dwordx4 v25, s[44:47], s53 offen offset:1024  lds
buffer_load_dwordx4 v26, s[44:47], s53 offen offset:2048  lds
buffer_load_dwordx4 v27, s[44:47], s53 offen offset:3072  lds
s_waitcnt vmcnt(12)
s_barrier
s_add_u32 m0, s58, 65536
s_add_u32 s53, s57, 0
s_cmp_ge_u32 s53, 9
s_cselect_b32 s52, 9, 0
s_sub_u32 s53, s53, s52
s_lshl_b32 s53, s53, 7
s_add_u32 s53, s53, s27
buffer_load_dwordx4 v24, s[44:47], s53 offen  lds
buffer_load_dwordx4 v25, s[44:47], s53 offen offset:1024  lds
buffer_load_dwordx4 v26, s[44:47], s53 offen offset:2048  lds
buffer_load_dwordx4 v27, s[44:47], s53 offen offset:3072  lds
s_waitcnt vmcnt(12)
s_barrier
s_add_u32 m0, s58, 81920
s_add_u32 s53, s53, 147456
buffer_load_dwordx4 v24, s[44:47], s53 offen  lds
buffer_load_dwordx4 v25, s[44:47], s53 offen offset:1024  lds
buffer_load_dwordx4 v26, s[44:47], s53 offen offset:2048  lds
buffer_load_dwordx4 v27, s[44:47], s53 offen offset:3072  lds
s_waitcnt vmcnt(8)
s_barrier
s_add_u32 m0, s58, 98304
s_add_u32 s53, s57, 1
s_cmp_ge_u32 s53, 9
s_cselect_b32 s52, 9, 0
s_sub_u32 s53, s53, s52
s_lshl_b32 s53, s53, 7
s_add_u32 s53, s53, s27
buffer_load_dwordx4 v24, s[44:47], s53 offen  lds
buffer_load_dwordx4 v25, s[44:47], s53 offen offset:1024  lds
buffer_load_dwordx4 v26, s[44:47], s53 offen offset:2048  lds
buffer_load_dwordx4 v27, s[44:47], s53 offen offset:3072  lds
s_add_u32 m0, s58, 114688
s_add_u32 s53, s53, 147456
buffer_load_dwordx4 v24, s[44:47], s53 offen  lds
buffer_load_dwordx4 v25, s[44:47], s53 offen offset:1024  lds
buffer_load_dwordx4 v26, s[44:47], s53 offen offset:2048  lds
buffer_load_dwordx4 v27, s[44:47], s53 offen offset:3072  lds
s_barrier
s_buffer_load_dword s1, s[48:51], s55 glc
s_add_u32 m0, s58, 0
s_add_u32 s53, s57, 2
s_cmp_ge_u32 s53, 9
s_cselect_b32 s52, 9, 0
s_sub_u32 s53, s53, s52
s_lshl_b32 s53, s53, 7
s_add_u32 s53, s53, s27
buffer_load_dwordx4 v24, s[44:47], s53 offen  lds
buffer_load_dwordx4 v25, s[44:47], s53 offen offset:1024  lds
buffer_load_dwordx4 v26, s[44:47], s53 offen offset:2048  lds
buffer_load_dwordx4 v27, s[44:47], s53 offen offset:3072  lds
s_add_u32 m0, s58, 16384
s_add_u32 s53, s53, 147456
buffer_load_dwordx4 v24, s[44:47], s53 offen  lds
buffer_load_dwordx4 v25, s[44:47], s53 offen offset:1024  lds
buffer_load_dwordx4 v26, s[44:47], s53 offen offset:2048  lds
buffer_load_dwordx4 v27, s[44:47], s53 offen offset:3072  lds
s_waitcnt vmcnt(16)
s_barrier
s_waitcnt lgkmcnt(0)
s_cmp_eq_u32 s1, 1
s_cbranch_scc1 L_ze0
s_buffer_load_dword s1, s[48:51], s55 glc
s_add_u32 m0, s58, 32768
s_add_u32 s53, s57, 3
s_cmp_ge_u32 s53, 9
s_cselect_b32 s52, 9, 0
s_sub_u32 s53, s53, s52
s_lshl_b32 s53, s53, 7
s_add_u32 s53, s53, s27
buffer_load_dwordx4 v24, s[44:47], s53 offen  lds
buffer_load_dwordx4 v25, s[44:47], s53 offen offset:1024  lds
buffer_load_dwordx4 v26, s[44:47], s53 offen offset:2048  lds
buffer_load_dwordx4 v27, s[44:47], s53 offen offset:3072  lds
s_add_u32 m0, s58, 49152
s_add_u32 s53, s53, 147456
buffer_load_dwordx4 v24, s[44:47], s53 offen  lds
buffer_load_dwordx4 v25, s[44:47], s53 offen offset:1024  lds
buffer_load_dwordx4 v26, s[44:47], s53 offen offset:2048  lds
buffer_load_dwordx4 v27, s[44:47], s53 offen offset:3072  lds
s_waitcnt vmcnt(16)
s_barrier
s_waitcnt lgkmcnt(0)
s_cmp_eq_u32 s1, 1
s_cbranch_scc1 L_ze1
s_add_u32 m0, s58, 65536
s_add_u32 s53, s57, 0
s_cmp_ge_u32 s53, 9
s_cselect_b32 s52, 9, 0
s_sub_u32 s53, s53, s52
s_lshl_b32 s53, s53, 7
s_add_u32 s53, s53, s25
buffer_load_dwordx4 v24, s[44:47], s53 offen  lds
buffer_load_dwordx4 v25, s[44:47], s53 offen offset:1024  lds
buffer_load_dwordx4 v26, s[44:47], s53 offen offset:2048  lds
buffer_load_dwordx4 v27, s[44:47], s53 offen offset:3072  lds
s_add_u32 m0, s58, 81920
s_add_u32 s53, s53, 147456
buffer_load_dwordx4 v24, s[44:47], s53 offen  lds
buffer_load_dwordx4 v25, s[44:47], s53 offen offset:1024  lds
buffer_load_dwordx4 v26, s[44:47], s53 offen offset:2048  lds
buffer_load_dwordx4 v27, s[44:47], s53 offen offset:3072  lds
s_waitcnt vmcnt(16)
s_barrier
s_add_u32 m0, s58, 98304
s_add_u32 s53, s57, 1
s_cmp_ge_u32 s53, 9
s_cselect_b32 s52, 9, 0
s_sub_u32 s53, s53, s52
s_lshl_b32 s53, s53, 7
s_add_u32 s53, s53, s25
buffer_load_dwordx4 v24, s[44:47], s53 offen  lds
buffer_load_dwordx4 v25, s[44:47], s53 offen offset:1024  lds
buffer_load_dwordx4 v26, s[44:47], s53 offen offset:2048  lds
buffer_load_dwordx4 v27, s[44:47], s53 offen offset:3072  lds
s_add_u32 m0, s58, 114688
s_add_u32 s53, s53, 147456
buffer_load_dwordx4 v24, s[44:47], s53 offen  lds
buffer_load_dwordx4 v25, s[44:47], s53 offen offset:1024  lds
buffer_load_dwordx4 v26, s[44:47], s53 offen offset:2048  lds
buffer_load_dwordx4 v27, s[44:47], s53 offen offset:3072  lds
s_mov_b32 s52, 0
L_zp85:
s_buffer_load_dword s9, s[48:51], s55 glc
s_add_u32 s52, s52, 1
s_waitcnt lgkmcnt(0)
s_cmp_eq_u32 s9, 1
s_cbranch_scc1 L_zok85
s_cmp_lt_u32 s52, 64
s_cbranch_scc1 L_zp85
s_branch L_zv85
L_zok85:
s_lshl_b32 s9, s58, 1
s_add_u32 m0, s9, 131072
s_nop 0
buffer_load_dwordx4 v63, s[48:51], s54 offen sc1 lds
buffer_load_dwordx4 v63, s[48:51], s54 offen offset:1024 sc1 lds
buffer_load_dwordx4 v63, s[48:51], s54 offen offset:2048 sc1 lds
buffer_load_dwordx4 v63, s[48:51], s54 offen offset:3072 sc1 lds
s_lshl_b32 s9, s58, 1
s_add_u32 m0, s9, 135168
s_add_u32 s54, s54, 4096
buffer_load_dwordx4 v63, s[48:51], s54 offen sc1 lds
buffer_load_dwordx4 v63, s[48:51], s54 offen offset:1024 sc1 lds
buffer_load_dwordx4 v63, s[48:51], s54 offen offset:2048 sc1 lds
buffer_load_dwordx4 v63, s[48:51], s54 offen offset:3072 sc1 lds
s_waitcnt vmcnt(24)
s_barrier
s_add_u32 m0, s58, 0
s_add_u32 s53, s57, 2
s_cmp_ge_u32 s53, 9
s_cselect_b32 s52, 9, 0
s_sub_u32 s53, s53, s52
s_lshl_b32 s53, s53, 7
s_add_u32 s53, s53, s25
buffer_load_dwordx4 v24, s[44:47], s53 offen  lds
buffer_load_dwordx4 v25, s[44:47], s53 offen offset:1024  lds
buffer_load_dwordx4 v26, s[44:47], s53 offen offset:2048  lds
buffer_load_dwordx4 v27, s[44:47], s53 offen offset:3072  lds
s_add_u32 m0, s58, 16384
s_add_u32 s53, s53, 147456
buffer_load_dwordx4 v24, s[44:47], s53 offen  lds
buffer_load_dwordx4 v25, s[44:47], s53 offen offset:1024  lds
buffer_load_dwordx4 v26, s[44:47], s53 offen offset:2048  lds
buffer_load_dwordx4 v27, s[44:47], s53 offen offset:3072  lds
s_waitcnt vmcnt(8)
s_barrier
s_add_u32 m0, s58, 32768
s_add_u32 s53, s57, 3
s_cmp_ge_u32 s53, 9
s_cselect_b32 s52, 9, 0
s_sub_u32 s53, s53, s52
s_lshl_b32 s53, s53, 7
s_add_u32 s53, s53, s25
buffer_load_dwordx4 v24, s[44:47], s53 offen  lds
buffer_load_dwordx4 v25, s[44:47], s53 offen offset:1024  lds
buffer_load_dwordx4 v26, s[44:47], s53 offen offset:2048  lds
buffer_load_dwordx4 v27, s[44:47], s53 offen offset:3072  lds
s_add_u32 m0, s58, 49152
s_add_u32 s53, s53, 147456
buffer_load_dwordx4 v24, s[44:47], s53 offen  lds
buffer_load_dwordx4 v25, s[44:47], s53 offen offset:1024  lds
buffer_load_dwordx4 v26, s[44:47], s53 offen offset:2048  lds
buffer_load_dwordx4 v27, s[44:47], s53 offen offset:3072  lds
s_barrier
s_waitcnt vmcnt(8)
s_barrier
ds_write_b128 v51, v[56:59]
ds_write_b128 v51, v[56:59] offset:16
s_waitcnt lgkmcnt(0)
s_waitcnt vmcnt(0)
s_barrier
L_ltail:
s_mov_b64 s[12:13], 0
s_mov_b64 s[36:37], 0
s_mov_b64 s[14:15], 0
s_mov_b64 s[38:39], 0
s_mov_b64 s[16:17], 0
s_mov_b64 s[40:41], 0
s_mov_b64 s[18:19], 0
s_mov_b64 s[42:43], 0
s_mov_b32 s9, 0
s_barrier
L_poll:
ds_read_u16 v48, v52 offset:0
ds_read_u16 v49, v52 offset:8
ds_read_u16 v50, v52 offset:16
ds_read_u16 v51, v52 offset:24
s_mov_b64 exec, -1
s_add_u32 s9, s9, 1
s_waitcnt lgkmcnt(0)
v_cmp_ne_u32 s[28:29], 0, v48
v_cmp_ne_u32 s[30:31], 0, v49
v_cmp_ne_u32 s[32:33], 0, v50
v_cmp_ne_u32 s[34:35], 0, v51
s_andn2_b64 exec, s[28:29], s[12:13]
s_cbranch_scc0 L_sk0
s_or_b64 s[12:13], s[12:13], exec
buffer_load_dwordx4 v[64:67], v28, s[48:51], s20 offen offset:0 sc1
buffer_load_dwordx4 v[68:71], v28, s[48:51], s21 offen offset:0 sc1
buffer_load_dwordx4 v[80:83], v31, s[48:51], s4 offen offset:0 sc1
L_sk0:
s_andn2_b64 exec, s[30:31], s[14:15]
s_cbranch_scc0 L_sk1
s_or_b64 s[14:15], s[14:15], exec
buffer_load_dwordx4 v[92:95], v28, s[48:51], s22 offen offset:512 sc1
buffer_load_dwordx4 v[96:99], v28, s[48:51], s23 offen offset:512 sc1
buffer_load_dwordx4 v[100:103], v31, s[48:51], s4 offen offset:512 sc1
L_sk1:
s_andn2_b64 exec, s[32:33], s[16:17]
s_cbranch_scc0 L_sk2
s_or_b64 s[16:17], s[16:17], exec
buffer_load_dwordx4 v[104:107], v28, s[48:51], s20 offen offset:1024 sc1
buffer_load_dwordx4 v[108:111], v28, s[48:51], s21 offen offset:1024 sc1
buffer_load_dwordx4 v[120:123], v31, s[48:51], s4 offen offset:1024 sc1
L_sk2:
s_andn2_b64 exec, s[34:35], s[18:19]
s_cbranch_scc0 L_sk3
s_or_b64 s[18:19], s[18:19], exec
buffer_load_dwordx4 v[132:135], v28, s[48:51], s22 offen offset:1536 sc1
buffer_load_dwordx4 v[136:139], v28, s[48:51], s23 offen offset:1536 sc1
buffer_load_dwordx4 v[140:143], v31, s[48:51], s4 offen offset:1536 sc1
L_sk3:
s_mov_b64 exec, -1
s_and_b64 s[52:53], s[12:13], s[14:15]
s_and_b64 s[54:55], s[16:17], s[18:19]
s_and_b64 s[52:53], s[52:53], s[54:55]
s_cmp_eq_u64 s[52:53], -1
s_cbranch_scc1 L_pok0
s_cmp_lt_u32 s9, 4194304
s_cbranch_scc1 L_poll
L_pok0:
s_waitcnt vmcnt(0) lgkmcnt(0)
L_pok:
v_mfma_f32_16x16x32_bf16 v[160:163], v[32:35], v[64:67], 0
v_mfma_f32_16x16x32_bf16 v[168:171], v[32:35], v[80:83], 0
v_mfma_f32_16x16x32_bf16 v[160:163], v[44:47], v[68:71], v[160:163]
v_mfma_f32_16x16x32_bf16 v[164:167], v[32:35], v[92:95], 0
v_mfma_f32_16x16x32_bf16 v[168:171], v[32:35], v[100:103], v[168:171]
v_mfma_f32_16x16x32_bf16 v[164:167], v[44:47], v[96:99], v[164:167]
v_mfma_f32_16x16x32_bf16 v[160:163], v[32:35], v[104:107], v[160:163]
v_mfma_f32_16x16x32_bf16 v[168:171], v[32:35], v[120:123], v[168:171]
v_mfma_f32_16x16x32_bf16 v[160:163], v[44:47], v[108:111], v[160:163]
v_mfma_f32_16x16x32_bf16 v[164:167], v[32:35], v[132:135], v[164:167]
v_mfma_f32_16x16x32_bf16 v[168:171], v[32:35], v[140:143], v[168:171]
v_mfma_f32_16x16x32_bf16 v[164:167], v[44:47], v[136:139], v[164:167]
s_nop 4
v_cvt_pk_bf16_f32 v160, v160, v161
v_cvt_pk_bf16_f32 v161, v162, v163
buffer_store_dwordx2 v[160:161], v41, s[92:95], s10 offen
v_cvt_pk_bf16_f32 v164, v164, v165
v_cvt_pk_bf16_f32 v165, v166, v167
buffer_store_dwordx2 v[164:165], v42, s[92:95], s10 offen
v_cvt_pk_bf16_f32 v168, v168, v169
v_cvt_pk_bf16_f32 v169, v170, v171
buffer_store_dwordx2 v[168:169], v43, s[92:95], s10 offen
L_ldone:
s_endpgm
L_ze0:
s_lshl_b32 s9, s58, 1
s_add_u32 m0, s9, 131072
s_nop 0
buffer_load_dwordx4 v63, s[48:51], s54 offen sc1 lds
buffer_load_dwordx4 v63, s[48:51], s54 offen offset:1024 sc1 lds
buffer_load_dwordx4 v63, s[48:51], s54 offen offset:2048 sc1 lds
buffer_load_dwordx4 v63, s[48:51], s54 offen offset:3072 sc1 lds
s_lshl_b32 s9, s58, 1
s_add_u32 m0, s9, 135168
s_add_u32 s54, s54, 4096
buffer_load_dwordx4 v63, s[48:51], s54 offen sc1 lds
buffer_load_dwordx4 v63, s[48:51], s54 offen offset:1024 sc1 lds
buffer_load_dwordx4 v63, s[48:51], s54 offen offset:2048 sc1 lds
buffer_load_dwordx4 v63, s[48:51], s54 offen offset:3072 sc1 lds
s_add_u32 m0, s58, 32768
s_add_u32 s53, s57, 3
s_cmp_ge_u32 s53, 9
s_cselect_b32 s52, 9, 0
s_sub_u32 s53, s53, s52
s_lshl_b32 s53, s53, 7
s_add_u32 s53, s53, s27
buffer_load_dwordx4 v24, s[44:47], s53 offen  lds
buffer_load_dwordx4 v25, s[44:47], s53 offen offset:1024  lds
buffer_load_dwordx4 v26, s[44:47], s53 offen offset:2048  lds
buffer_load_dwordx4 v27, s[44:47], s53 offen offset:3072  lds
s_add_u32 m0, s58, 49152
s_add_u32 s53, s53, 147456
buffer_load_dwordx4 v24, s[44:47], s53 offen  lds
buffer_load_dwordx4 v25, s[44:47], s53 offen offset:1024  lds
buffer_load_dwordx4 v26, s[44:47], s53 offen offset:2048  lds
buffer_load_dwordx4 v27, s[44:47], s53 offen offset:3072  lds
s_waitcnt vmcnt(24)
s_barrier
s_add_u32 m0, s58, 65536
s_add_u32 s53, s57, 0
s_cmp_ge_u32 s53, 9
s_cselect_b32 s52, 9, 0
s_sub_u32 s53, s53, s52
s_lshl_b32 s53, s53, 7
s_add_u32 s53, s53, s25
buffer_load_dwordx4 v24, s[44:47], s53 offen  lds
buffer_load_dwordx4 v25, s[44:47], s53 offen offset:1024  lds
buffer_load_dwordx4 v26, s[44:47], s53 offen offset:2048  lds
buffer_load_dwordx4 v27, s[44:47], s53 offen offset:3072  lds
s_add_u32 m0, s58, 81920
s_add_u32 s53, s53, 147456
buffer_load_dwordx4 v24, s[44:47], s53 offen  lds
buffer_load_dwordx4 v25, s[44:47], s53 offen offset:1024  lds
buffer_load_dwordx4 v26, s[44:47], s53 offen offset:2048  lds
buffer_load_dwordx4 v27, s[44:47], s53 offen offset:3072  lds
s_waitcnt vmcnt(24)
s_barrier
s_add_u32 m0, s58, 98304
s_add_u32 s53, s57, 1
s_cmp_ge_u32 s53, 9
s_cselect_b32 s52, 9, 0
s_sub_u32 s53, s53, s52
s_lshl_b32 s53, s53, 7
s_add_u32 s53, s53, s25
buffer_load_dwordx4 v24, s[44:47], s53 offen  lds
buffer_load_dwordx4 v25, s[44:47], s53 offen offset:1024  lds
buffer_load_dwordx4 v26, s[44:47], s53 offen offset:2048  lds
buffer_load_dwordx4 v27, s[44:47], s53 offen offset:3072  lds
s_add_u32 m0, s58, 114688
s_add_u32 s53, s53, 147456
buffer_load_dwordx4 v24, s[44:47], s53 offen  lds
buffer_load_dwordx4 v25, s[44:47], s53 offen offset:1024  lds
buffer_load_dwordx4 v26, s[44:47], s53 offen offset:2048  lds
buffer_load_dwordx4 v27, s[44:47], s53 offen offset:3072  lds
s_waitcnt vmcnt(16)
s_barrier
s_add_u32 m0, s58, 0
s_add_u32 s53, s57, 2
s_cmp_ge_u32 s53, 9
s_cselect_b32 s52, 9, 0
s_sub_u32 s53, s53, s52
s_lshl_b32 s53, s53, 7
s_add_u32 s53, s53, s25
buffer_load_dwordx4 v24, s[44:47], s53 offen  lds
buffer_load_dwordx4 v25, s[44:47], s53 offen offset:1024  lds
buffer_load_dwordx4 v26, s[44:47], s53 offen offset:2048  lds
buffer_load_dwordx4 v27, s[44:47], s53 offen offset:3072  lds
s_add_u32 m0, s58, 16384
s_add_u32 s53, s53, 147456
buffer_load_dwordx4 v24, s[44:47], s53 offen  lds
buffer_load_dwordx4 v25, s[44:47], s53 offen offset:1024  lds
buffer_load_dwordx4 v26, s[44:47], s53 offen offset:2048  lds
buffer_load_dwordx4 v27, s[44:47], s53 offen offset:3072  lds
s_waitcnt vmcnt(16)
s_barrier
s_add_u32 m0, s58, 32768
s_add_u32 s53, s57, 3
s_cmp_ge_u32 s53, 9
s_cselect_b32 s52, 9, 0
s_sub_u32 s53, s53, s52
s_lshl_b32 s53, s53, 7
s_add_u32 s53, s53, s25
buffer_load_dwordx4 v24, s[44:47], s53 offen  lds
buffer_load_dwordx4 v25, s[44:47], s53 offen offset:1024  lds
buffer_load_dwordx4 v26, s[44:47], s53 offen offset:2048  lds
buffer_load_dwordx4 v27, s[44:47], s53 offen offset:3072  lds
s_add_u32 m0, s58, 49152
s_add_u32 s53, s53, 147456
buffer_load_dwordx4 v24, s[44:47], s53 offen  lds
buffer_load_dwordx4 v25, s[44:47], s53 offen offset:1024  lds
buffer_load_dwordx4 v26, s[44:47], s53 offen offset:2048  lds
buffer_load_dwordx4 v27, s[44:47], s53 offen offset:3072  lds
s_waitcnt vmcnt(16)
s_barrier
s_waitcnt vmcnt(8)
s_barrier
ds_write_b128 v51, v[56:59]
ds_write_b128 v51, v[56:59] offset:16
s_waitcnt lgkmcnt(0)
s_waitcnt vmcnt(0)
s_barrier
s_branch L_ltail
L_ze1:
s_lshl_b32 s9, s58, 1
s_add_u32 m0, s9, 131072
s_nop 0
buffer_load_dwordx4 v63, s[48:51], s54 offen sc1 lds
buffer_load_dwordx4 v63, s[48:51], s54 offen offset:1024 sc1 lds
buffer_load_dwordx4 v63, s[48:51], s54 offen offset:2048 sc1 lds
buffer_load_dwordx4 v63, s[48:51], s54 offen offset:3072 sc1 lds
s_lshl_b32 s9, s58, 1
s_add_u32 m0, s9, 135168
s_add_u32 s54, s54, 4096
buffer_load_dwordx4 v63, s[48:51], s54 offen sc1 lds
buffer_load_dwordx4 v63, s[48:51], s54 offen offset:1024 sc1 lds
buffer_load_dwordx4 v63, s[48:51], s54 offen offset:2048 sc1 lds
buffer_load_dwordx4 v63, s[48:51], s54 offen offset:3072 sc1 lds
s_add_u32 m0, s58, 65536
s_add_u32 s53, s57, 0
s_cmp_ge_u32 s53, 9
s_cselect_b32 s52, 9, 0
s_sub_u32 s53, s53, s52
s_lshl_b32 s53, s53, 7
s_add_u32 s53, s53, s25
buffer_load_dwordx4 v24, s[44:47], s53 offen  lds
buffer_load_dwordx4 v25, s[44:47], s53 offen offset:1024  lds
buffer_load_dwordx4 v26, s[44:47], s53 offen offset:2048  lds
buffer_load_dwordx4 v27, s[44:47], s53 offen offset:3072  lds
s_add_u32 m0, s58, 81920
s_add_u32 s53, s53, 147456
buffer_load_dwordx4 v24, s[44:47], s53 offen  lds
buffer_load_dwordx4 v25, s[44:47], s53 offen offset:1024  lds
buffer_load_dwordx4 v26, s[44:47], s53 offen offset:2048  lds
buffer_load_dwordx4 v27, s[44:47], s53 offen offset:3072  lds
s_waitcnt vmcnt(24)
s_barrier
s_add_u32 m0, s58, 98304
s_add_u32 s53, s57, 1
s_cmp_ge_u32 s53, 9
s_cselect_b32 s52, 9, 0
s_sub_u32 s53, s53, s52
s_lshl_b32 s53, s53, 7
s_add_u32 s53, s53, s25
buffer_load_dwordx4 v24, s[44:47], s53 offen  lds
buffer_load_dwordx4 v25, s[44:47], s53 offen offset:1024  lds
buffer_load_dwordx4 v26, s[44:47], s53 offen offset:2048  lds
buffer_load_dwordx4 v27, s[44:47], s53 offen offset:3072  lds
s_add_u32 m0, s58, 114688
s_add_u32 s53, s53, 147456
buffer_load_dwordx4 v24, s[44:47], s53 offen  lds
buffer_load_dwordx4 v25, s[44:47], s53 offen offset:1024  lds
buffer_load_dwordx4 v26, s[44:47], s53 offen offset:2048  lds
buffer_load_dwordx4 v27, s[44:47], s53 offen offset:3072  lds
s_waitcnt vmcnt(24)
s_barrier
s_add_u32 m0, s58, 0
s_add_u32 s53, s57, 2
s_cmp_ge_u32 s53, 9
s_cselect_b32 s52, 9, 0
s_sub_u32 s53, s53, s52
s_lshl_b32 s53, s53, 7
s_add_u32 s53, s53, s25
buffer_load_dwordx4 v24, s[44:47], s53 offen  lds
buffer_load_dwordx4 v25, s[44:47], s53 offen offset:1024  lds
buffer_load_dwordx4 v26, s[44:47], s53 offen offset:2048  lds
buffer_load_dwordx4 v27, s[44:47], s53 offen offset:3072  lds
s_add_u32 m0, s58, 16384
s_add_u32 s53, s53, 147456
buffer_load_dwordx4 v24, s[44:47], s53 offen  lds
buffer_load_dwordx4 v25, s[44:47], s53 offen offset:1024  lds
buffer_load_dwordx4 v26, s[44:47], s53 offen offset:2048  lds
buffer_load_dwordx4 v27, s[44:47], s53 offen offset:3072  lds
s_waitcnt vmcnt(16)
s_barrier
s_add_u32 m0, s58, 32768
s_add_u32 s53, s57, 3
s_cmp_ge_u32 s53, 9
s_cselect_b32 s52, 9, 0
s_sub_u32 s53, s53, s52
s_lshl_b32 s53, s53, 7
s_add_u32 s53, s53, s25
buffer_load_dwordx4 v24, s[44:47], s53 offen  lds
buffer_load_dwordx4 v25, s[44:47], s53 offen offset:1024  lds
buffer_load_dwordx4 v26, s[44:47], s53 offen offset:2048  lds
buffer_load_dwordx4 v27, s[44:47], s53 offen offset:3072  lds
s_add_u32 m0, s58, 49152
s_add_u32 s53, s53, 147456
buffer_load_dwordx4 v24, s[44:47], s53 offen  lds
buffer_load_dwordx4 v25, s[44:47], s53 offen offset:1024  lds
buffer_load_dwordx4 v26, s[44:47], s53 offen offset:2048  lds
buffer_load_dwordx4 v27, s[44:47], s53 offen offset:3072  lds
s_waitcnt vmcnt(16)
s_barrier
s_waitcnt vmcnt(8)
s_barrier
ds_write_b128 v51, v[56:59]
ds_write_b128 v51, v[56:59] offset:16
s_waitcnt lgkmcnt(0)
s_waitcnt vmcnt(0)
s_barrier
s_branch L_ltail
L_compute:
s_lshr_b32 s9, s24, 1
s_and_b32 s26, s24, 1
s_mov_b32 s48, s22
s_and_b32 s49, s23, 0xffff
s_mov_b32 s50, 0x10000000
s_mov_b32 s51, 0x20000
s_lshl_b32 s27, s6, 3
s_add_u32 s27, s27, s8
s_mul_i32 s56, s27, 0x200000
v_lshlrev_b32 v39, 8, v0
v_mov_b32 v7, 0x40000000
v_cmp_gt_u32 vcc, 4, v0
s_nop 1
v_cndmask_b32 v39, v7, v39, vcc
s_lshl_b32 s11, s26, 10
s_lshl_b32 s5, s9, 7
s_add_u32 s11, s11, s5
s_lshl_b32 s5, s3, 3
s_add_u32 s11, s11, s5
s_lshr_b32 s5, s7, 2
s_lshl_b32 s5, s5, 1
v_mov_b32 v40, -1
s_add_u32 s11, s11, s5
s_mul_i32 s5, s27, 0x1000
s_add_u32 s11, s11, s5
s_add_u32 s11, s11, 0xc000000
v_mov_b32 v46, 1
v_mov_b32 v46, 1
s_lshl_b32 s5, s24, 4
s_add_u32 s5, s5, s7
s_cmp_lg_u32 s5, 1
s_cbranch_scc1 L_noclr
v_lshrrev_b32 v7, 2, v0
v_lshlrev_b32 v7, 7, v7
v_and_b32 v8, 3, v0
v_lshl_add_u32 v7, v8, 4, v7
v_mov_b32 v56, 0
v_mov_b32 v57, 0
v_mov_b32 v58, 0
v_mov_b32 v59, 0
s_mul_i32 s5, s27, 0x1000
s_add_u32 s5, s5, 0xc000000
buffer_store_dwordx4 v[56:59], v7, s[48:51], s5 offen sc1
buffer_store_dwordx4 v[56:59], v7, s[48:51], s5 offen offset:64 sc1
buffer_store_dwordx4 v[56:59], v7, s[48:51], s5 offen offset:2048 sc1
L_noclr:
s_mov_b32 s92, s98
s_and_b32 s93, s99, 0xffff
s_mov_b32 s94, 0x100
s_mov_b32 s95, 0x20000
s_lshl_b32 s10, s27, 4
v_lshrrev_b32 v1, 5, v0
v_bfe_u32 v2, v0, 4, 1
v_bfe_u32 v3, v0, 2, 2
v_and_b32 v4, 3, v0
v_and_b32 v5, 31, v0
v_and_b32 v6, 1, v0
v_lshlrev_b32 v6, 4, v6
v_and_b32 v7, 2, v0
v_lshl_add_u32 v6, v7, 2, v6
v_lshl_add_u32 v7, v1, 3, v3
v_lshlrev_b32 v9, 9, v7
s_lshl_b32 s27, s9, 8
s_add_u32 s27, s27, 16384
v_add_u32 v9, s27, v9
v_lshl_add_u32 v9, v2, 5, v9
v_add_u32 v9, v9, v6
v_xor_b32 v10, 0, v3
v_lshl_add_u32 v16, v10, 6, v9
v_xor_b32 v10, 1, v3
v_lshl_add_u32 v17, v10, 6, v9
v_xor_b32 v10, 2, v3
v_lshl_add_u32 v18, v10, 6, v9
v_xor_b32 v10, 3, v3
v_lshl_add_u32 v19, v10, 6, v9
s_lshl_b32 s27, s26, 11
s_add_u32 s27, s27, 81920
v_lshl_add_u32 v9, v5, 6, s27
v_xor_b32 v10, v1, v3
v_xor_b32 v13, 0, v10
v_lshl_add_u32 v20, v13, 4, v9
v_xor_b32 v13, 2, v10
v_lshl_add_u32 v21, v13, 4, v9
v_and_b32 v10, 15, v0
v_lshlrev_b32 v9, 8, v10
v_add_u32 v9, 98304, v9
v_lshl_add_u32 v13, v2, 1, v1
v_xor_b32 v10, v10, v13
v_xor_b32 v13, 0, v10
v_lshl_add_u32 v22, v13, 4, v9
v_xor_b32 v13, 4, v10
v_lshl_add_u32 v23, v13, 4, v9
v_xor_b32 v13, 8, v10
v_lshl_add_u32 v24, v13, 4, v9
v_xor_b32 v13, 12, v10
v_lshl_add_u32 v25, v13, 4, v9
v_lshl_add_u32 v7, v2, 2, v3
v_lshl_add_u32 v9, v1, 3, v7
v_lshl_add_u32 v9, v9, 8, v6
v_add_u32 v9, 114688, v9
v_xor_b32 v10, 0, v7
v_lshl_add_u32 v26, v10, 5, v9
v_xor_b32 v10, 1, v7
v_lshl_add_u32 v27, v10, 5, v9
v_xor_b32 v10, 2, v7
v_lshl_add_u32 v28, v10, 5, v9
v_xor_b32 v10, 3, v7
v_lshl_add_u32 v29, v10, 5, v9
v_xor_b32 v10, 4, v7
v_lshl_add_u32 v30, v10, 5, v9
v_xor_b32 v10, 5, v7
v_lshl_add_u32 v31, v10, 5, v9
v_xor_b32 v10, 6, v7
v_lshl_add_u32 v32, v10, 5, v9
v_xor_b32 v10, 7, v7
v_lshl_add_u32 v33, v10, 5, v9
v_lshl_add_u32 v7, v1, 2, v3
v_lshlrev_b32 v9, 7, v7
v_add_u32 v9, 32768, v9
v_lshl_add_u32 v9, v2, 5, v9
v_add_u32 v9, v9, v6
v_lshrrev_b32 v10, 1, v3
v_xor_b32 v10, s9, v10
v_lshl_add_u32 v9, v10, 6, v9
s_lshl_b32 s27, s9, 14
v_add_u32 v34, s27, v9
s_xor_b32 s27, s27, 16384
v_add_u32 v35, s27, v9
s_lshl_b32 s27, s24, 13
s_add_u32 s27, s27, 131072
v_lshl_add_u32 v36, v0, 4, s27
v_xor_b32 v37, 16384, v36
v_lshrrev_b32 v9, 3, v5
v_lshlrev_b32 v9, 14, v9
v_lshl_add_u32 v9, v1, 7, v9
v_and_b32 v10, 7, v0
v_lshl_add_u32 v9, v10, 4, v9
s_lshl_b32 s27, s26, 16
s_lshl_b32 s4, s9, 13
s_add_u32 s27, s27, s4
v_add_u32 v38, s27, v9
s_lshl_b32 s12, s7, 15
s_add_u32 s12, s12, s56
s_add_u32 s12, s12, 0x120000
s_add_u32 s13, s12, 4096
s_lshl_b32 s14, s6, 3
s_add_u32 s14, s14, s8
s_mul_i32 s14, s14, 0x1000
s_xor_b32 s27, s7, 1
s_lshl_b32 s27, s27, 7
s_add_u32 s14, s14, s27
s_lshl_b32 s27, s24, 2
s_add_u32 s14, s14, s27
s_add_u32 s14, s14, 0xc000800
v_lshlrev_b32 v12, 28, v0
v_cmp_eq_u32 vcc, 0, v0
v_mov_b32 v7, 0x40000000
s_nop 0
v_cndmask_b32 v12, v7, 0, vcc
s_add_u32 s15, s8, 8
s_cmp_ge_u32 s15, 9
s_cselect_b32 s27, 9, 0
s_sub_u32 s15, s15, s27
s_and_b32 s27, s7, 1
s_lshl_b32 s27, s27, 2
s_add_u32 s57, s8, s27
s_cmp_ge_u32 s57, 9
s_cselect_b32 s27, 9, 0
s_sub_u32 s57, s57, s27
s_lshl_b32 s27, s7, 9
s_add_u32 s56, s56, s27
s_lshl_b32 s4, s6, 3
s_add_u32 s4, s4, s8
s_mul_i32 s4, s4, 0x1000
s_lshl_b32 s27, s7, 7
s_add_u32 s4, s4, s27
s_add_u32 s4, s4, 0xc000000
s_lshr_b32 s27, s7, 2
s_lshl_b32 s27, s27, 4
s_mov_b64 s[44:45], 0xffff
s_lshl_b64 s[44:45], s[44:45], s27
s_cmp_eq_u32 s3, 0
s_cselect_b64 s[36:37], s[44:45], 0
s_cmp_eq_u32 s3, 1
s_cselect_b64 s[38:39], s[44:45], 0
s_cmp_eq_u32 s3, 2
s_cselect_b64 s[40:41], s[44:45], 0
s_cmp_eq_u32 s3, 3
s_cselect_b64 s[42:43], s[44:45], 0
s_lshr_b32 s44, s7, 3
s_and_b32 s27, s7, 1
s_lshl_b32 s27, s27, 1
s_or_b32 s44, s44, s27
s_mov_b32 s25, 0x3e0293ee
s_mov_b32 s55, 0x40004000
s_lshl_b32 s5, s24, 4
s_add_u32 s5, s5, s7
s_cmp_lg_u32 s5, 1
s_cbranch_scc1 L_noset
v_lshlrev_b32 v7, 12, v0
s_waitcnt vmcnt(0)
buffer_store_dword v46, v7, s[92:95], s10 offen sc1
L_noset:
v_mov_b32 v4, 0x3f803f80
v_mov_b32 v5, 0x3f803f80
v_mov_b32 v6, 0x3f803f80
v_mov_b32 v7, 0x3f803f80
s_waitcnt lgkmcnt(0)
s_barrier
ds_read_b128 v[240:243], v20 offset:0
ds_read_b64_tr_b16 v[208:209], v16 offset:32768
ds_read_b64_tr_b16 v[210:211], v16 offset:34816
ds_read_b64_tr_b16 v[212:213], v17 offset:32768
ds_read_b64_tr_b16 v[214:215], v17 offset:34816
ds_read_b64_tr_b16 v[216:217], v18 offset:32768
ds_read_b64_tr_b16 v[218:219], v18 offset:34816
ds_read_b64_tr_b16 v[220:221], v19 offset:32768
ds_read_b64_tr_b16 v[222:223], v19 offset:34816
ds_read_b128 v[244:247], v21 offset:0
ds_read_b64_tr_b16 v[224:225], v16 offset:40960
ds_read_b64_tr_b16 v[226:227], v16 offset:43008
ds_read_b64_tr_b16 v[228:229], v17 offset:40960
ds_read_b64_tr_b16 v[230:231], v17 offset:43008
ds_read_b64_tr_b16 v[232:233], v18 offset:40960
ds_read_b64_tr_b16 v[234:235], v18 offset:43008
s_waitcnt lgkmcnt(7)
v_mfma_f32_32x32x16_bf16 v[80:95], v[208:211], v[240:243], 0
ds_read_b64_tr_b16 v[236:237], v19 offset:40960
ds_read_b64_tr_b16 v[238:239], v19 offset:43008
v_mfma_f32_32x32x16_bf16 v[96:111], v[212:215], v[240:243], 0
s_waitcnt lgkmcnt(0)
s_barrier
ds_read_b128 v[248:251], v20 offset:4096
ds_read_b64_tr_b16 v[208:209], v16 offset:49152
ds_read_b64_tr_b16 v[210:211], v16 offset:51200
v_mfma_f32_32x32x16_bf16 v[112:127], v[216:219], v[240:243], 0
ds_read_b64_tr_b16 v[212:213], v17 offset:49152
ds_read_b64_tr_b16 v[214:215], v17 offset:51200
v_mfma_f32_32x32x16_bf16 v[128:143], v[220:223], v[240:243], 0
ds_read_b64_tr_b16 v[216:217], v18 offset:49152
ds_read_b64_tr_b16 v[218:219], v18 offset:51200
v_mfma_f32_32x32x16_bf16 v[80:95], v[224:227], v[244:247], v[80:95]
ds_read_b64_tr_b16 v[220:221], v19 offset:49152
ds_read_b64_tr_b16 v[222:223], v19 offset:51200
v_mfma_f32_32x32x16_bf16 v[96:111], v[228:231], v[244:247], v[96:111]
ds_read_b128 v[252:255], v21 offset:4096
ds_read_b64_tr_b16 v[224:225], v16 offset:57344
ds_read_b64_tr_b16 v[226:227], v16 offset:59392
v_mfma_f32_32x32x16_bf16 v[112:127], v[232:235], v[244:247], v[112:127]
ds_read_b64_tr_b16 v[228:229], v17 offset:57344
ds_read_b64_tr_b16 v[230:231], v17 offset:59392
v_mfma_f32_32x32x16_bf16 v[128:143], v[236:239], v[244:247], v[128:143]
ds_read_b64_tr_b16 v[232:233], v18 offset:57344
ds_read_b64_tr_b16 v[234:235], v18 offset:59392
s_waitcnt lgkmcnt(7)
v_mfma_f32_32x32x16_bf16 v[80:95], v[208:211], v[248:251], v[80:95]
ds_read_b64_tr_b16 v[236:237], v19 offset:57344
ds_read_b64_tr_b16 v[238:239], v19 offset:59392
v_mfma_f32_32x32x16_bf16 v[96:111], v[212:215], v[248:251], v[96:111]
s_waitcnt lgkmcnt(0)
s_barrier
ds_read_b128 v[240:243], v20 offset:8192
ds_read_b64_tr_b16 v[208:209], v16 offset:0
ds_read_b64_tr_b16 v[210:211], v16 offset:2048
v_mfma_f32_32x32x16_bf16 v[112:127], v[216:219], v[248:251], v[112:127]
ds_read_b64_tr_b16 v[212:213], v17 offset:0
ds_read_b64_tr_b16 v[214:215], v17 offset:2048
v_mfma_f32_32x32x16_bf16 v[128:143], v[220:223], v[248:251], v[128:143]
ds_read_b64_tr_b16 v[216:217], v18 offset:0
ds_read_b64_tr_b16 v[218:219], v18 offset:2048
v_mfma_f32_32x32x16_bf16 v[80:95], v[224:227], v[252:255], v[80:95]
ds_read_b64_tr_b16 v[220:221], v19 offset:0
ds_read_b64_tr_b16 v[222:223], v19 offset:2048
v_mfma_f32_32x32x16_bf16 v[96:111], v[228:231], v[252:255], v[96:111]
ds_read_b128 v[244:247], v21 offset:8192
ds_read_b64_tr_b16 v[224:225], v16 offset:8192
ds_read_b64_tr_b16 v[226:227], v16 offset:10240
v_mfma_f32_32x32x16_bf16 v[112:127], v[232:235], v[252:255], v[112:127]
ds_read_b64_tr_b16 v[228:229], v17 offset:8192
ds_read_b64_tr_b16 v[230:231], v17 offset:10240
v_mfma_f32_32x32x16_bf16 v[128:143], v[236:239], v[252:255], v[128:143]
ds_read_b64_tr_b16 v[232:233], v18 offset:8192
ds_read_b64_tr_b16 v[234:235], v18 offset:10240
s_waitcnt lgkmcnt(7)
v_mfma_f32_32x32x16_bf16 v[80:95], v[208:211], v[240:243], v[80:95]
ds_read_b64_tr_b16 v[236:237], v19 offset:8192
ds_read_b64_tr_b16 v[238:239], v19 offset:10240
v_mfma_f32_32x32x16_bf16 v[96:111], v[212:215], v[240:243], v[96:111]
s_waitcnt lgkmcnt(0)
s_barrier
ds_read_b128 v[248:251], v20 offset:12288
ds_read_b64_tr_b16 v[208:209], v16 offset:16384
ds_read_b64_tr_b16 v[210:211], v16 offset:18432
v_mfma_f32_32x32x16_bf16 v[112:127], v[216:219], v[240:243], v[112:127]
ds_read_b64_tr_b16 v[212:213], v17 offset:16384
ds_read_b64_tr_b16 v[214:215], v17 offset:18432
v_mfma_f32_32x32x16_bf16 v[128:143], v[220:223], v[240:243], v[128:143]
ds_read_b64_tr_b16 v[216:217], v18 offset:16384
ds_read_b64_tr_b16 v[218:219], v18 offset:18432
v_mfma_f32_32x32x16_bf16 v[80:95], v[224:227], v[244:247], v[80:95]
ds_read_b64_tr_b16 v[220:221], v19 offset:16384
ds_read_b64_tr_b16 v[222:223], v19 offset:18432
v_mfma_f32_32x32x16_bf16 v[96:111], v[228:231], v[244:247], v[96:111]
ds_read_b128 v[252:255], v21 offset:12288
ds_read_b64_tr_b16 v[224:225], v16 offset:24576
ds_read_b64_tr_b16 v[226:227], v16 offset:26624
v_mfma_f32_32x32x16_bf16 v[112:127], v[232:235], v[244:247], v[112:127]
ds_read_b64_tr_b16 v[228:229], v17 offset:24576
ds_read_b64_tr_b16 v[230:231], v17 offset:26624
v_mfma_f32_32x32x16_bf16 v[128:143], v[236:239], v[244:247], v[128:143]
ds_read_b64_tr_b16 v[232:233], v18 offset:24576
ds_read_b64_tr_b16 v[234:235], v18 offset:26624
s_waitcnt lgkmcnt(7)
v_mfma_f32_32x32x16_bf16 v[80:95], v[208:211], v[248:251], v[80:95]
ds_read_b64_tr_b16 v[236:237], v19 offset:24576
ds_read_b64_tr_b16 v[238:239], v19 offset:26624
v_mfma_f32_32x32x16_bf16 v[96:111], v[212:215], v[248:251], v[96:111]
s_waitcnt lgkmcnt(0)
s_barrier
ds_read_b128 v[240:243], v20 offset:0
ds_read_b64_tr_b16 v[208:209], v16 offset:32768
ds_read_b64_tr_b16 v[210:211], v16 offset:34816
v_mfma_f32_32x32x16_bf16 v[112:127], v[216:219], v[248:251], v[112:127]
ds_read_b64_tr_b16 v[212:213], v17 offset:32768
ds_read_b64_tr_b16 v[214:215], v17 offset:34816
v_mfma_f32_32x32x16_bf16 v[128:143], v[220:223], v[248:251], v[128:143]
ds_read_b64_tr_b16 v[216:217], v18 offset:32768
ds_read_b64_tr_b16 v[218:219], v18 offset:34816
v_mfma_f32_32x32x16_bf16 v[80:95], v[224:227], v[252:255], v[80:95]
ds_read_b64_tr_b16 v[220:221], v19 offset:32768
ds_read_b64_tr_b16 v[222:223], v19 offset:34816
v_mfma_f32_32x32x16_bf16 v[96:111], v[228:231], v[252:255], v[96:111]
ds_read_b128 v[244:247], v21 offset:0
ds_read_b64_tr_b16 v[224:225], v16 offset:40960
ds_read_b64_tr_b16 v[226:227], v16 offset:43008
v_mfma_f32_32x32x16_bf16 v[112:127], v[232:235], v[252:255], v[112:127]
ds_read_b64_tr_b16 v[228:229], v17 offset:40960
ds_read_b64_tr_b16 v[230:231], v17 offset:43008
v_mfma_f32_32x32x16_bf16 v[128:143], v[236:239], v[252:255], v[128:143]
ds_read_b64_tr_b16 v[232:233], v18 offset:40960
ds_read_b64_tr_b16 v[234:235], v18 offset:43008
s_waitcnt lgkmcnt(7)
v_mfma_f32_32x32x16_bf16 v[80:95], v[208:211], v[240:243], v[80:95]
ds_read_b64_tr_b16 v[236:237], v19 offset:40960
ds_read_b64_tr_b16 v[238:239], v19 offset:43008
v_mfma_f32_32x32x16_bf16 v[96:111], v[212:215], v[240:243], v[96:111]
s_waitcnt lgkmcnt(0)
s_barrier
ds_read_b128 v[248:251], v20 offset:4096
ds_read_b64_tr_b16 v[208:209], v16 offset:49152
ds_read_b64_tr_b16 v[210:211], v16 offset:51200
v_mfma_f32_32x32x16_bf16 v[112:127], v[216:219], v[240:243], v[112:127]
ds_read_b64_tr_b16 v[212:213], v17 offset:49152
ds_read_b64_tr_b16 v[214:215], v17 offset:51200
v_mfma_f32_32x32x16_bf16 v[128:143], v[220:223], v[240:243], v[128:143]
ds_read_b64_tr_b16 v[216:217], v18 offset:49152
ds_read_b64_tr_b16 v[218:219], v18 offset:51200
v_mfma_f32_32x32x16_bf16 v[80:95], v[224:227], v[244:247], v[80:95]
ds_read_b64_tr_b16 v[220:221], v19 offset:49152
ds_read_b64_tr_b16 v[222:223], v19 offset:51200
v_mfma_f32_32x32x16_bf16 v[96:111], v[228:231], v[244:247], v[96:111]
ds_read_b128 v[252:255], v21 offset:4096
ds_read_b64_tr_b16 v[224:225], v16 offset:57344
ds_read_b64_tr_b16 v[226:227], v16 offset:59392
v_mfma_f32_32x32x16_bf16 v[112:127], v[232:235], v[244:247], v[112:127]
ds_read_b64_tr_b16 v[228:229], v17 offset:57344
ds_read_b64_tr_b16 v[230:231], v17 offset:59392
v_mfma_f32_32x32x16_bf16 v[128:143], v[236:239], v[244:247], v[128:143]
ds_read_b64_tr_b16 v[232:233], v18 offset:57344
ds_read_b64_tr_b16 v[234:235], v18 offset:59392
s_waitcnt lgkmcnt(7)
v_mfma_f32_32x32x16_bf16 v[80:95], v[208:211], v[248:251], v[80:95]
ds_read_b64_tr_b16 v[236:237], v19 offset:57344
ds_read_b64_tr_b16 v[238:239], v19 offset:59392
v_mfma_f32_32x32x16_bf16 v[96:111], v[212:215], v[248:251], v[96:111]
s_waitcnt lgkmcnt(0)
s_barrier
ds_read_b128 v[240:243], v20 offset:8192
ds_read_b64_tr_b16 v[208:209], v16 offset:0
ds_read_b64_tr_b16 v[210:211], v16 offset:2048
v_mfma_f32_32x32x16_bf16 v[112:127], v[216:219], v[248:251], v[112:127]
ds_read_b64_tr_b16 v[212:213], v17 offset:0
ds_read_b64_tr_b16 v[214:215], v17 offset:2048
v_mfma_f32_32x32x16_bf16 v[128:143], v[220:223], v[248:251], v[128:143]
ds_read_b64_tr_b16 v[216:217], v18 offset:0
ds_read_b64_tr_b16 v[218:219], v18 offset:2048
v_mfma_f32_32x32x16_bf16 v[80:95], v[224:227], v[252:255], v[80:95]
ds_read_b64_tr_b16 v[220:221], v19 offset:0
ds_read_b64_tr_b16 v[222:223], v19 offset:2048
v_mfma_f32_32x32x16_bf16 v[96:111], v[228:231], v[252:255], v[96:111]
ds_read_b128 v[244:247], v21 offset:8192
ds_read_b64_tr_b16 v[224:225], v16 offset:8192
ds_read_b64_tr_b16 v[226:227], v16 offset:10240
v_mfma_f32_32x32x16_bf16 v[112:127], v[232:235], v[252:255], v[112:127]
ds_read_b64_tr_b16 v[228:229], v17 offset:8192
ds_read_b64_tr_b16 v[230:231], v17 offset:10240
v_mfma_f32_32x32x16_bf16 v[128:143], v[236:239], v[252:255], v[128:143]
ds_read_b64_tr_b16 v[232:233], v18 offset:8192
ds_read_b64_tr_b16 v[234:235], v18 offset:10240
s_waitcnt lgkmcnt(7)
v_mfma_f32_32x32x16_bf16 v[80:95], v[208:211], v[240:243], v[80:95]
ds_read_b64_tr_b16 v[236:237], v19 offset:8192
ds_read_b64_tr_b16 v[238:239], v19 offset:10240
v_mfma_f32_32x32x16_bf16 v[96:111], v[212:215], v[240:243], v[96:111]
s_waitcnt lgkmcnt(0)
s_barrier
ds_read_b128 v[248:251], v20 offset:12288
ds_read_b64_tr_b16 v[208:209], v16 offset:16384
ds_read_b64_tr_b16 v[210:211], v16 offset:18432
v_mfma_f32_32x32x16_bf16 v[112:127], v[216:219], v[240:243], v[112:127]
ds_read_b64_tr_b16 v[212:213], v17 offset:16384
ds_read_b64_tr_b16 v[214:215], v17 offset:18432
v_mfma_f32_32x32x16_bf16 v[128:143], v[220:223], v[240:243], v[128:143]
ds_read_b64_tr_b16 v[216:217], v18 offset:16384
ds_read_b64_tr_b16 v[218:219], v18 offset:18432
v_mfma_f32_32x32x16_bf16 v[80:95], v[224:227], v[244:247], v[80:95]
ds_read_b64_tr_b16 v[220:221], v19 offset:16384
ds_read_b64_tr_b16 v[222:223], v19 offset:18432
v_mfma_f32_32x32x16_bf16 v[96:111], v[228:231], v[244:247], v[96:111]
ds_read_b128 v[252:255], v21 offset:12288
ds_read_b64_tr_b16 v[224:225], v16 offset:24576
ds_read_b64_tr_b16 v[226:227], v16 offset:26624
v_mfma_f32_32x32x16_bf16 v[112:127], v[232:235], v[244:247], v[112:127]
ds_read_b64_tr_b16 v[228:229], v17 offset:24576
ds_read_b64_tr_b16 v[230:231], v17 offset:26624
v_mfma_f32_32x32x16_bf16 v[128:143], v[236:239], v[244:247], v[128:143]
ds_read_b64_tr_b16 v[232:233], v18 offset:24576
ds_read_b64_tr_b16 v[234:235], v18 offset:26624
s_waitcnt lgkmcnt(7)
v_mfma_f32_32x32x16_bf16 v[80:95], v[208:211], v[248:251], v[80:95]
ds_read_b64_tr_b16 v[236:237], v19 offset:24576
ds_read_b64_tr_b16 v[238:239], v19 offset:26624
v_mfma_f32_32x32x16_bf16 v[96:111], v[212:215], v[248:251], v[96:111]
s_waitcnt lgkmcnt(0)
s_barrier
ds_read_b128 v[240:243], v20 offset:0
ds_read_b64_tr_b16 v[208:209], v16 offset:32768
ds_read_b64_tr_b16 v[210:211], v16 offset:34816
v_mfma_f32_32x32x16_bf16 v[112:127], v[216:219], v[248:251], v[112:127]
ds_read_b64_tr_b16 v[212:213], v17 offset:32768
ds_read_b64_tr_b16 v[214:215], v17 offset:34816
v_mfma_f32_32x32x16_bf16 v[128:143], v[220:223], v[248:251], v[128:143]
ds_read_b64_tr_b16 v[216:217], v18 offset:32768
ds_read_b64_tr_b16 v[218:219], v18 offset:34816
v_mfma_f32_32x32x16_bf16 v[80:95], v[224:227], v[252:255], v[80:95]
ds_read_b64_tr_b16 v[220:221], v19 offset:32768
ds_read_b64_tr_b16 v[222:223], v19 offset:34816
v_mfma_f32_32x32x16_bf16 v[96:111], v[228:231], v[252:255], v[96:111]
ds_read_b128 v[244:247], v21 offset:0
ds_read_b64_tr_b16 v[224:225], v16 offset:40960
ds_read_b64_tr_b16 v[226:227], v16 offset:43008
v_mfma_f32_32x32x16_bf16 v[112:127], v[232:235], v[252:255], v[112:127]
ds_read_b64_tr_b16 v[228:229], v17 offset:40960
ds_read_b64_tr_b16 v[230:231], v17 offset:43008
v_mfma_f32_32x32x16_bf16 v[128:143], v[236:239], v[252:255], v[128:143]
ds_read_b64_tr_b16 v[232:233], v18 offset:40960
ds_read_b64_tr_b16 v[234:235], v18 offset:43008
s_waitcnt lgkmcnt(7)
v_mfma_f32_32x32x16_bf16 v[80:95], v[208:211], v[240:243], v[80:95]
ds_read_b64_tr_b16 v[236:237], v19 offset:40960
ds_read_b64_tr_b16 v[238:239], v19 offset:43008
v_mfma_f32_32x32x16_bf16 v[96:111], v[212:215], v[240:243], v[96:111]
s_waitcnt lgkmcnt(0)
s_barrier
ds_read_b128 v[248:251], v20 offset:4096
ds_read_b64_tr_b16 v[208:209], v16 offset:49152
ds_read_b64_tr_b16 v[210:211], v16 offset:51200
v_mfma_f32_32x32x16_bf16 v[112:127], v[216:219], v[240:243], v[112:127]
ds_read_b64_tr_b16 v[212:213], v17 offset:49152
ds_read_b64_tr_b16 v[214:215], v17 offset:51200
v_mfma_f32_32x32x16_bf16 v[128:143], v[220:223], v[240:243], v[128:143]
ds_read_b64_tr_b16 v[216:217], v18 offset:49152
ds_read_b64_tr_b16 v[218:219], v18 offset:51200
v_mfma_f32_32x32x16_bf16 v[80:95], v[224:227], v[244:247], v[80:95]
ds_read_b64_tr_b16 v[220:221], v19 offset:49152
ds_read_b64_tr_b16 v[222:223], v19 offset:51200
v_mfma_f32_32x32x16_bf16 v[96:111], v[228:231], v[244:247], v[96:111]
ds_read_b128 v[252:255], v21 offset:4096
ds_read_b64_tr_b16 v[224:225], v16 offset:57344
ds_read_b64_tr_b16 v[226:227], v16 offset:59392
v_mfma_f32_32x32x16_bf16 v[112:127], v[232:235], v[244:247], v[112:127]
ds_read_b64_tr_b16 v[228:229], v17 offset:57344
ds_read_b64_tr_b16 v[230:231], v17 offset:59392
v_mfma_f32_32x32x16_bf16 v[128:143], v[236:239], v[244:247], v[128:143]
ds_read_b64_tr_b16 v[232:233], v18 offset:57344
ds_read_b64_tr_b16 v[234:235], v18 offset:59392
s_waitcnt lgkmcnt(7)
v_mfma_f32_32x32x16_bf16 v[80:95], v[208:211], v[248:251], v[80:95]
ds_read_b64_tr_b16 v[236:237], v19 offset:57344
ds_read_b64_tr_b16 v[238:239], v19 offset:59392
v_mfma_f32_32x32x16_bf16 v[96:111], v[212:215], v[248:251], v[96:111]
s_waitcnt lgkmcnt(0)
s_barrier
ds_read_b128 v[240:243], v20 offset:8192
ds_read_b64_tr_b16 v[208:209], v16 offset:0
ds_read_b64_tr_b16 v[210:211], v16 offset:2048
v_mfma_f32_32x32x16_bf16 v[112:127], v[216:219], v[248:251], v[112:127]
ds_read_b64_tr_b16 v[212:213], v17 offset:0
ds_read_b64_tr_b16 v[214:215], v17 offset:2048
v_mfma_f32_32x32x16_bf16 v[128:143], v[220:223], v[248:251], v[128:143]
ds_read_b64_tr_b16 v[216:217], v18 offset:0
ds_read_b64_tr_b16 v[218:219], v18 offset:2048
v_mfma_f32_32x32x16_bf16 v[80:95], v[224:227], v[252:255], v[80:95]
ds_read_b64_tr_b16 v[220:221], v19 offset:0
ds_read_b64_tr_b16 v[222:223], v19 offset:2048
v_mfma_f32_32x32x16_bf16 v[96:111], v[228:231], v[252:255], v[96:111]
ds_read_b128 v[244:247], v21 offset:8192
ds_read_b64_tr_b16 v[224:225], v16 offset:8192
ds_read_b64_tr_b16 v[226:227], v16 offset:10240
v_mfma_f32_32x32x16_bf16 v[112:127], v[232:235], v[252:255], v[112:127]
ds_read_b64_tr_b16 v[228:229], v17 offset:8192
ds_read_b64_tr_b16 v[230:231], v17 offset:10240
v_mfma_f32_32x32x16_bf16 v[128:143], v[236:239], v[252:255], v[128:143]
ds_read_b64_tr_b16 v[232:233], v18 offset:8192
ds_read_b64_tr_b16 v[234:235], v18 offset:10240
s_waitcnt lgkmcnt(7)
v_mfma_f32_32x32x16_bf16 v[80:95], v[208:211], v[240:243], v[80:95]
ds_read_b64_tr_b16 v[236:237], v19 offset:8192
ds_read_b64_tr_b16 v[238:239], v19 offset:10240
v_mfma_f32_32x32x16_bf16 v[96:111], v[212:215], v[240:243], v[96:111]
s_waitcnt lgkmcnt(0)
s_barrier
ds_read_b128 v[248:251], v20 offset:12288
ds_read_b64_tr_b16 v[208:209], v16 offset:16384
ds_read_b64_tr_b16 v[210:211], v16 offset:18432
v_mfma_f32_32x32x16_bf16 v[112:127], v[216:219], v[240:243], v[112:127]
ds_read_b64_tr_b16 v[212:213], v17 offset:16384
ds_read_b64_tr_b16 v[214:215], v17 offset:18432
v_mfma_f32_32x32x16_bf16 v[128:143], v[220:223], v[240:243], v[128:143]
ds_read_b64_tr_b16 v[216:217], v18 offset:16384
ds_read_b64_tr_b16 v[218:219], v18 offset:18432
v_mfma_f32_32x32x16_bf16 v[80:95], v[224:227], v[244:247], v[80:95]
ds_read_b64_tr_b16 v[220:221], v19 offset:16384
ds_read_b64_tr_b16 v[222:223], v19 offset:18432
v_mfma_f32_32x32x16_bf16 v[96:111], v[228:231], v[244:247], v[96:111]
ds_read_b128 v[252:255], v21 offset:12288
ds_read_b64_tr_b16 v[224:225], v16 offset:24576
ds_read_b64_tr_b16 v[226:227], v16 offset:26624
v_mfma_f32_32x32x16_bf16 v[112:127], v[232:235], v[244:247], v[112:127]
ds_read_b64_tr_b16 v[228:229], v17 offset:24576
ds_read_b64_tr_b16 v[230:231], v17 offset:26624
v_mfma_f32_32x32x16_bf16 v[128:143], v[236:239], v[244:247], v[128:143]
ds_read_b64_tr_b16 v[232:233], v18 offset:24576
ds_read_b64_tr_b16 v[234:235], v18 offset:26624
s_waitcnt lgkmcnt(7)
v_mfma_f32_32x32x16_bf16 v[80:95], v[208:211], v[248:251], v[80:95]
ds_read_b64_tr_b16 v[236:237], v19 offset:24576
ds_read_b64_tr_b16 v[238:239], v19 offset:26624
v_mfma_f32_32x32x16_bf16 v[96:111], v[212:215], v[248:251], v[96:111]
s_waitcnt lgkmcnt(0)
s_barrier
ds_read_b128 v[240:243], v20 offset:0
ds_read_b64_tr_b16 v[208:209], v16 offset:32768
ds_read_b64_tr_b16 v[210:211], v16 offset:34816
v_mfma_f32_32x32x16_bf16 v[112:127], v[216:219], v[248:251], v[112:127]
ds_read_b64_tr_b16 v[212:213], v17 offset:32768
ds_read_b64_tr_b16 v[214:215], v17 offset:34816
v_mfma_f32_32x32x16_bf16 v[128:143], v[220:223], v[248:251], v[128:143]
ds_read_b64_tr_b16 v[216:217], v18 offset:32768
ds_read_b64_tr_b16 v[218:219], v18 offset:34816
v_mfma_f32_32x32x16_bf16 v[80:95], v[224:227], v[252:255], v[80:95]
ds_read_b64_tr_b16 v[220:221], v19 offset:32768
ds_read_b64_tr_b16 v[222:223], v19 offset:34816
v_mfma_f32_32x32x16_bf16 v[96:111], v[228:231], v[252:255], v[96:111]
ds_read_b128 v[244:247], v21 offset:0
ds_read_b64_tr_b16 v[224:225], v16 offset:40960
ds_read_b64_tr_b16 v[226:227], v16 offset:43008
v_mfma_f32_32x32x16_bf16 v[112:127], v[232:235], v[252:255], v[112:127]
ds_read_b64_tr_b16 v[228:229], v17 offset:40960
ds_read_b64_tr_b16 v[230:231], v17 offset:43008
v_mfma_f32_32x32x16_bf16 v[128:143], v[236:239], v[252:255], v[128:143]
ds_read_b64_tr_b16 v[232:233], v18 offset:40960
ds_read_b64_tr_b16 v[234:235], v18 offset:43008
s_waitcnt lgkmcnt(7)
v_mfma_f32_32x32x16_bf16 v[80:95], v[208:211], v[240:243], v[80:95]
ds_read_b64_tr_b16 v[236:237], v19 offset:40960
ds_read_b64_tr_b16 v[238:239], v19 offset:43008
v_mfma_f32_32x32x16_bf16 v[96:111], v[212:215], v[240:243], v[96:111]
s_waitcnt lgkmcnt(0)
s_barrier
ds_read_b128 v[248:251], v20 offset:4096
ds_read_b64_tr_b16 v[208:209], v16 offset:49152
ds_read_b64_tr_b16 v[210:211], v16 offset:51200
v_mfma_f32_32x32x16_bf16 v[112:127], v[216:219], v[240:243], v[112:127]
ds_read_b64_tr_b16 v[212:213], v17 offset:49152
ds_read_b64_tr_b16 v[214:215], v17 offset:51200
v_mfma_f32_32x32x16_bf16 v[128:143], v[220:223], v[240:243], v[128:143]
ds_read_b64_tr_b16 v[216:217], v18 offset:49152
ds_read_b64_tr_b16 v[218:219], v18 offset:51200
v_mfma_f32_32x32x16_bf16 v[80:95], v[224:227], v[244:247], v[80:95]
ds_read_b64_tr_b16 v[220:221], v19 offset:49152
ds_read_b64_tr_b16 v[222:223], v19 offset:51200
v_mfma_f32_32x32x16_bf16 v[96:111], v[228:231], v[244:247], v[96:111]
ds_read_b128 v[252:255], v21 offset:4096
ds_read_b64_tr_b16 v[224:225], v16 offset:57344
ds_read_b64_tr_b16 v[226:227], v16 offset:59392
v_mfma_f32_32x32x16_bf16 v[112:127], v[232:235], v[244:247], v[112:127]
ds_read_b64_tr_b16 v[228:229], v17 offset:57344
ds_read_b64_tr_b16 v[230:231], v17 offset:59392
v_mfma_f32_32x32x16_bf16 v[128:143], v[236:239], v[244:247], v[128:143]
ds_read_b64_tr_b16 v[232:233], v18 offset:57344
ds_read_b64_tr_b16 v[234:235], v18 offset:59392
s_waitcnt lgkmcnt(7)
v_mfma_f32_32x32x16_bf16 v[80:95], v[208:211], v[248:251], v[80:95]
ds_read_b64_tr_b16 v[236:237], v19 offset:57344
ds_read_b64_tr_b16 v[238:239], v19 offset:59392
v_mfma_f32_32x32x16_bf16 v[96:111], v[212:215], v[248:251], v[96:111]
s_waitcnt lgkmcnt(0)
s_barrier
ds_read_b128 v[240:243], v20 offset:8192
ds_read_b64_tr_b16 v[208:209], v16 offset:0
ds_read_b64_tr_b16 v[210:211], v16 offset:2048
v_mfma_f32_32x32x16_bf16 v[112:127], v[216:219], v[248:251], v[112:127]
ds_read_b64_tr_b16 v[212:213], v17 offset:0
ds_read_b64_tr_b16 v[214:215], v17 offset:2048
v_mfma_f32_32x32x16_bf16 v[128:143], v[220:223], v[248:251], v[128:143]
ds_read_b64_tr_b16 v[216:217], v18 offset:0
ds_read_b64_tr_b16 v[218:219], v18 offset:2048
v_mfma_f32_32x32x16_bf16 v[80:95], v[224:227], v[252:255], v[80:95]
ds_read_b64_tr_b16 v[220:221], v19 offset:0
ds_read_b64_tr_b16 v[222:223], v19 offset:2048
v_mfma_f32_32x32x16_bf16 v[96:111], v[228:231], v[252:255], v[96:111]
ds_read_b128 v[244:247], v21 offset:8192
ds_read_b64_tr_b16 v[224:225], v16 offset:8192
ds_read_b64_tr_b16 v[226:227], v16 offset:10240
v_mfma_f32_32x32x16_bf16 v[112:127], v[232:235], v[252:255], v[112:127]
ds_read_b64_tr_b16 v[228:229], v17 offset:8192
ds_read_b64_tr_b16 v[230:231], v17 offset:10240
v_mfma_f32_32x32x16_bf16 v[128:143], v[236:239], v[252:255], v[128:143]
ds_read_b64_tr_b16 v[232:233], v18 offset:8192
ds_read_b64_tr_b16 v[234:235], v18 offset:10240
s_waitcnt lgkmcnt(7)
v_mfma_f32_32x32x16_bf16 v[80:95], v[208:211], v[240:243], v[80:95]
ds_read_b64_tr_b16 v[236:237], v19 offset:8192
ds_read_b64_tr_b16 v[238:239], v19 offset:10240
v_mfma_f32_32x32x16_bf16 v[96:111], v[212:215], v[240:243], v[96:111]
s_waitcnt lgkmcnt(0)
s_barrier
ds_read_b128 v[248:251], v20 offset:12288
ds_read_b64_tr_b16 v[208:209], v16 offset:16384
ds_read_b64_tr_b16 v[210:211], v16 offset:18432
v_mfma_f32_32x32x16_bf16 v[112:127], v[216:219], v[240:243], v[112:127]
ds_read_b64_tr_b16 v[212:213], v17 offset:16384
ds_read_b64_tr_b16 v[214:215], v17 offset:18432
v_mfma_f32_32x32x16_bf16 v[128:143], v[220:223], v[240:243], v[128:143]
ds_read_b64_tr_b16 v[216:217], v18 offset:16384
ds_read_b64_tr_b16 v[218:219], v18 offset:18432
v_mfma_f32_32x32x16_bf16 v[80:95], v[224:227], v[244:247], v[80:95]
ds_read_b64_tr_b16 v[220:221], v19 offset:16384
ds_read_b64_tr_b16 v[222:223], v19 offset:18432
v_mfma_f32_32x32x16_bf16 v[96:111], v[228:231], v[244:247], v[96:111]
ds_read_b128 v[252:255], v21 offset:12288
ds_read_b64_tr_b16 v[224:225], v16 offset:24576
ds_read_b64_tr_b16 v[226:227], v16 offset:26624
v_mfma_f32_32x32x16_bf16 v[112:127], v[232:235], v[244:247], v[112:127]
ds_read_b64_tr_b16 v[228:229], v17 offset:24576
ds_read_b64_tr_b16 v[230:231], v17 offset:26624
v_mfma_f32_32x32x16_bf16 v[128:143], v[236:239], v[244:247], v[128:143]
ds_read_b64_tr_b16 v[232:233], v18 offset:24576
ds_read_b64_tr_b16 v[234:235], v18 offset:26624
s_waitcnt lgkmcnt(7)
v_mfma_f32_32x32x16_bf16 v[80:95], v[208:211], v[248:251], v[80:95]
ds_read_b64_tr_b16 v[236:237], v19 offset:24576
ds_read_b64_tr_b16 v[238:239], v19 offset:26624
v_mfma_f32_32x32x16_bf16 v[96:111], v[212:215], v[248:251], v[96:111]
s_waitcnt lgkmcnt(0)
s_barrier
ds_read_b128 v[240:243], v20 offset:0
ds_read_b64_tr_b16 v[208:209], v16 offset:32768
ds_read_b64_tr_b16 v[210:211], v16 offset:34816
v_mfma_f32_32x32x16_bf16 v[112:127], v[216:219], v[248:251], v[112:127]
ds_read_b64_tr_b16 v[212:213], v17 offset:32768
ds_read_b64_tr_b16 v[214:215], v17 offset:34816
v_mfma_f32_32x32x16_bf16 v[128:143], v[220:223], v[248:251], v[128:143]
ds_read_b64_tr_b16 v[216:217], v18 offset:32768
ds_read_b64_tr_b16 v[218:219], v18 offset:34816
v_mfma_f32_32x32x16_bf16 v[80:95], v[224:227], v[252:255], v[80:95]
ds_read_b64_tr_b16 v[220:221], v19 offset:32768
ds_read_b64_tr_b16 v[222:223], v19 offset:34816
v_mfma_f32_32x32x16_bf16 v[96:111], v[228:231], v[252:255], v[96:111]
ds_read_b128 v[244:247], v21 offset:0
ds_read_b64_tr_b16 v[224:225], v16 offset:40960
ds_read_b64_tr_b16 v[226:227], v16 offset:43008
v_mfma_f32_32x32x16_bf16 v[112:127], v[232:235], v[252:255], v[112:127]
ds_read_b64_tr_b16 v[228:229], v17 offset:40960
ds_read_b64_tr_b16 v[230:231], v17 offset:43008
v_mfma_f32_32x32x16_bf16 v[128:143], v[236:239], v[252:255], v[128:143]
ds_read_b64_tr_b16 v[232:233], v18 offset:40960
ds_read_b64_tr_b16 v[234:235], v18 offset:43008
s_waitcnt lgkmcnt(7)
v_mfma_f32_32x32x16_bf16 v[80:95], v[208:211], v[240:243], v[80:95]
ds_read_b64_tr_b16 v[236:237], v19 offset:40960
ds_read_b64_tr_b16 v[238:239], v19 offset:43008
v_mfma_f32_32x32x16_bf16 v[96:111], v[212:215], v[240:243], v[96:111]
s_waitcnt lgkmcnt(0)
s_barrier
ds_read_b128 v[248:251], v20 offset:4096
ds_read_b64_tr_b16 v[208:209], v16 offset:49152
ds_read_b64_tr_b16 v[210:211], v16 offset:51200
v_mfma_f32_32x32x16_bf16 v[112:127], v[216:219], v[240:243], v[112:127]
ds_read_b128 v[252:255], v21 offset:4096
ds_read_b64_tr_b16 v[212:213], v16 offset:57344
ds_read_b64_tr_b16 v[214:215], v16 offset:59392
v_mfma_f32_32x32x16_bf16 v[128:143], v[220:223], v[240:243], v[128:143]
ds_read_b64_tr_b16 v[216:217], v17 offset:49152
ds_read_b64_tr_b16 v[218:219], v17 offset:51200
v_mfma_f32_32x32x16_bf16 v[80:95], v[224:227], v[244:247], v[80:95]
ds_read_b64_tr_b16 v[220:221], v17 offset:57344
ds_read_b64_tr_b16 v[222:223], v17 offset:59392
v_mfma_f32_32x32x16_bf16 v[96:111], v[228:231], v[244:247], v[96:111]
ds_read_b64_tr_b16 v[224:225], v18 offset:49152
ds_read_b64_tr_b16 v[226:227], v18 offset:51200
v_mfma_f32_32x32x16_bf16 v[112:127], v[232:235], v[244:247], v[112:127]
ds_read_b64_tr_b16 v[228:229], v18 offset:57344
ds_read_b64_tr_b16 v[230:231], v18 offset:59392
v_mfma_f32_32x32x16_bf16 v[128:143], v[236:239], v[244:247], v[128:143]
ds_read_b64_tr_b16 v[232:233], v19 offset:49152
ds_read_b64_tr_b16 v[234:235], v19 offset:51200
s_waitcnt lgkmcnt(6)
v_mfma_f32_32x32x16_bf16 v[80:95], v[208:211], v[248:251], v[80:95]
ds_read_b64_tr_b16 v[236:237], v19 offset:57344
ds_read_b64_tr_b16 v[238:239], v19 offset:59392
v_mfma_f32_32x32x16_bf16 v[80:95], v[212:215], v[252:255], v[80:95]
s_waitcnt lgkmcnt(0)
s_barrier
ds_read_b128 v[208:211], v22 offset:0
v_mfma_f32_32x32x16_bf16 v[96:111], v[216:219], v[248:251], v[96:111]
ds_read_b128 v[212:215], v22 offset:4096
v_mfma_f32_32x32x16_bf16 v[96:111], v[220:223], v[252:255], v[96:111]
ds_read_b128 v[216:219], v23 offset:0
s_nop 4
v_mul_f32 v80, s25, v80
v_mul_f32 v81, s25, v81
v_mul_f32 v82, s25, v82
v_mul_f32 v83, s25, v83
v_mfma_f32_32x32x16_bf16 v[112:127], v[224:227], v[248:251], v[112:127]
ds_read_b128 v[220:223], v23 offset:4096
v_mul_f32 v84, s25, v84
v_mul_f32 v85, s25, v85
v_mul_f32 v86, s25, v86
v_mul_f32 v87, s25, v87
v_cvt_pk_bf16_f32 v48, v80, v81
v_mfma_f32_32x32x16_bf16 v[112:127], v[228:231], v[252:255], v[112:127]
ds_read_b128 v[224:227], v24 offset:0
v_cvt_pk_bf16_f32 v49, v82, v83
v_cvt_pk_bf16_f32 v50, v84, v85
v_cvt_pk_bf16_f32 v51, v86, v87
v_mul_f32 v88, s25, v88
v_mul_f32 v89, s25, v89
v_mfma_f32_32x32x16_bf16 v[128:143], v[232:235], v[248:251], v[128:143]
ds_read_b128 v[228:231], v24 offset:4096
v_mul_f32 v90, s25, v90
v_mul_f32 v91, s25, v91
v_mul_f32 v92, s25, v92
v_mul_f32 v93, s25, v93
v_mul_f32 v94, s25, v94
v_mfma_f32_32x32x16_bf16 v[128:143], v[236:239], v[252:255], v[128:143]
ds_read_b128 v[232:235], v25 offset:0
v_mul_f32 v95, s25, v95
v_cvt_pk_bf16_f32 v52, v88, v89
v_cvt_pk_bf16_f32 v53, v90, v91
v_cvt_pk_bf16_f32 v54, v92, v93
v_cvt_pk_bf16_f32 v55, v94, v95
v_permlane16_swap_b32 v48, v52
v_permlane16_swap_b32 v49, v53
v_permlane16_swap_b32 v50, v54
v_permlane16_swap_b32 v51, v55
s_waitcnt lgkmcnt(3)
s_nop 0
v_mfma_f32_16x16x32_bf16 v[144:147], v[208:211], v[48:51], 0
ds_read_b128 v[236:239], v25 offset:4096
v_mul_f32 v96, s25, v96
v_mul_f32 v97, s25, v97
v_mfma_f32_16x16x32_bf16 v[152:155], v[208:211], v[52:55], 0
v_mul_f32 v98, s25, v98
v_mul_f32 v99, s25, v99
v_mul_f32 v100, s25, v100
v_mfma_f32_16x16x32_bf16 v[148:151], v[212:215], v[48:51], 0
ds_read_b128 v[208:211], v22 offset:8192
v_mul_f32 v101, s25, v101
v_mul_f32 v102, s25, v102
v_mul_f32 v103, s25, v103
v_cvt_pk_bf16_f32 v56, v96, v97
v_cvt_pk_bf16_f32 v57, v98, v99
v_cvt_pk_bf16_f32 v58, v100, v101
v_cvt_pk_bf16_f32 v59, v102, v103
v_mul_f32 v104, s25, v104
v_mul_f32 v105, s25, v105
v_mul_f32 v106, s25, v106
v_mul_f32 v107, s25, v107
v_mfma_f32_16x16x32_bf16 v[156:159], v[212:215], v[52:55], 0
v_mul_f32 v108, s25, v108
v_mul_f32 v109, s25, v109
v_mul_f32 v110, s25, v110
v_mul_f32 v111, s25, v111
v_cvt_pk_bf16_f32 v60, v104, v105
v_cvt_pk_bf16_f32 v61, v106, v107
v_cvt_pk_bf16_f32 v62, v108, v109
v_cvt_pk_bf16_f32 v63, v110, v111
v_permlane16_swap_b32 v56, v60
v_permlane16_swap_b32 v57, v61
v_permlane16_swap_b32 v58, v62
v_permlane16_swap_b32 v59, v63
s_nop 1
v_mfma_f32_16x16x32_bf16 v[144:147], v[216:219], v[56:59], v[144:147]
ds_read_b128 v[212:215], v22 offset:12288
v_mul_f32 v112, s25, v112
v_mul_f32 v113, s25, v113
v_mfma_f32_16x16x32_bf16 v[152:155], v[216:219], v[60:63], v[152:155]
v_mul_f32 v114, s25, v114
v_mul_f32 v115, s25, v115
v_mul_f32 v116, s25, v116
v_mfma_f32_16x16x32_bf16 v[148:151], v[220:223], v[56:59], v[148:151]
ds_read_b128 v[216:219], v23 offset:8192
v_mul_f32 v117, s25, v117
v_mul_f32 v118, s25, v118
v_mul_f32 v119, s25, v119
v_cvt_pk_bf16_f32 v64, v112, v113
v_cvt_pk_bf16_f32 v65, v114, v115
v_cvt_pk_bf16_f32 v66, v116, v117
v_cvt_pk_bf16_f32 v67, v118, v119
v_mul_f32 v120, s25, v120
v_mul_f32 v121, s25, v121
v_mul_f32 v122, s25, v122
v_mul_f32 v123, s25, v123
v_mfma_f32_16x16x32_bf16 v[156:159], v[220:223], v[60:63], v[156:159]
v_mul_f32 v124, s25, v124
v_mul_f32 v125, s25, v125
v_mul_f32 v126, s25, v126
v_mul_f32 v127, s25, v127
v_cvt_pk_bf16_f32 v68, v120, v121
v_cvt_pk_bf16_f32 v69, v122, v123
v_cvt_pk_bf16_f32 v70, v124, v125
v_cvt_pk_bf16_f32 v71, v126, v127
v_permlane16_swap_b32 v64, v68
v_permlane16_swap_b32 v65, v69
v_permlane16_swap_b32 v66, v70
v_permlane16_swap_b32 v67, v71
s_waitcnt lgkmcnt(3)
s_nop 0
v_mfma_f32_16x16x32_bf16 v[144:147], v[224:227], v[64:67], v[144:147]
ds_read_b128 v[220:223], v23 offset:12288
v_mul_f32 v128, s25, v128
v_mul_f32 v129, s25, v129
v_mfma_f32_16x16x32_bf16 v[152:155], v[224:227], v[68:71], v[152:155]
v_mul_f32 v130, s25, v130
v_mul_f32 v131, s25, v131
v_mul_f32 v132, s25, v132
v_mfma_f32_16x16x32_bf16 v[148:151], v[228:231], v[64:67], v[148:151]
ds_read_b128 v[224:227], v24 offset:8192
v_mul_f32 v133, s25, v133
v_mul_f32 v134, s25, v134
v_mul_f32 v135, s25, v135
v_cvt_pk_bf16_f32 v72, v128, v129
v_cvt_pk_bf16_f32 v73, v130, v131
v_cvt_pk_bf16_f32 v74, v132, v133
v_cvt_pk_bf16_f32 v75, v134, v135
v_mul_f32 v136, s25, v136
v_mul_f32 v137, s25, v137
v_mul_f32 v138, s25, v138
v_mul_f32 v139, s25, v139
v_mfma_f32_16x16x32_bf16 v[156:159], v[228:231], v[68:71], v[156:159]
v_mul_f32 v140, s25, v140
v_mul_f32 v141, s25, v141
v_mul_f32 v142, s25, v142
v_mul_f32 v143, s25, v143
v_cvt_pk_bf16_f32 v76, v136, v137
v_cvt_pk_bf16_f32 v77, v138, v139
v_cvt_pk_bf16_f32 v78, v140, v141
v_cvt_pk_bf16_f32 v79, v142, v143
v_permlane16_swap_b32 v72, v76
v_permlane16_swap_b32 v73, v77
v_permlane16_swap_b32 v74, v78
v_permlane16_swap_b32 v75, v79
s_nop 1
v_mfma_f32_16x16x32_bf16 v[144:147], v[232:235], v[72:75], v[144:147]
ds_read_b128 v[228:231], v24 offset:12288
v_mfma_f32_16x16x32_bf16 v[152:155], v[232:235], v[76:79], v[152:155]
v_mfma_f32_16x16x32_bf16 v[148:151], v[236:239], v[72:75], v[148:151]
ds_read_b128 v[232:235], v25 offset:8192
s_nop 3
v_max3_f32 v42, v144, v145, v146
s_nop 1
v_max3_f32 v42, v42, v147, v148
v_max3_f32 v42, v42, v149, v150
v_max_f32 v42, v42, v151
v_max3_f32 v249, v152, v153, v154
v_mfma_f32_16x16x32_bf16 v[156:159], v[236:239], v[76:79], v[156:159]
s_nop 7
v_max3_f32 v249, v249, v155, v156
v_max3_f32 v249, v249, v157, v158
v_max_f32 v249, v249, v159
s_nop 1
v_permlane16_swap_b32 v42, v249
v_max_f32 v42, v42, v249
v_mov_b32 v249, v42
s_nop 1
v_permlane32_swap_b32 v42, v249
v_max_f32 v42, v42, v249
v_mov_b32 v249, v42
s_nop 1
v_permlane16_swap_b32 v42, v249
v_sub_f32 v240, 0xc2000000, v42
v_sub_f32 v244, 0xc2000000, v249
v_sub_f32 v241, 0xc2000000, v42
v_sub_f32 v245, 0xc2000000, v249
v_sub_f32 v242, 0xc2000000, v42
v_sub_f32 v246, 0xc2000000, v249
v_sub_f32 v243, 0xc2000000, v42
v_sub_f32 v247, 0xc2000000, v249
s_waitcnt lgkmcnt(3)
v_mfma_f32_16x16x32_bf16 v[160:163], v[208:211], v[48:51], v[240:243]
ds_read_b128 v[236:239], v25 offset:12288
v_add_f32 v192, v144, v240
v_mfma_f32_16x16x32_bf16 v[168:171], v[208:211], v[52:55], v[244:247]
v_exp_f32 v192, v192
v_add_f32 v193, v145, v240
v_mfma_f32_16x16x32_bf16 v[164:167], v[212:215], v[48:51], v[240:243]
v_exp_f32 v193, v193
v_add_f32 v194, v146, v240
v_mfma_f32_16x16x32_bf16 v[172:175], v[212:215], v[52:55], v[244:247]
s_barrier
ds_read_b64_tr_b16 v[208:209], v26 offset:0
ds_read_b64_tr_b16 v[210:211], v26 offset:4096
v_mfma_f32_16x16x32_bf16 v[160:163], v[216:219], v[56:59], v[160:163]
ds_read_b64_tr_b16 v[212:213], v27 offset:0
ds_read_b64_tr_b16 v[214:215], v27 offset:4096
v_mfma_f32_16x16x32_bf16 v[168:171], v[216:219], v[60:63], v[168:171]
v_exp_f32 v194, v194
v_add_f32 v195, v147, v240
v_mfma_f32_16x16x32_bf16 v[164:167], v[220:223], v[56:59], v[164:167]
ds_read_b64_tr_b16 v[216:217], v28 offset:0
v_exp_f32 v195, v195
v_mfma_f32_16x16x32_bf16 v[172:175], v[220:223], v[60:63], v[172:175]
ds_read_b64_tr_b16 v[218:219], v28 offset:4096
v_cvt_pk_bf16_f32 v176, v192, v193
s_waitcnt lgkmcnt(6)
v_mfma_f32_16x16x32_bf16 v[160:163], v[224:227], v[64:67], v[160:163]
ds_read_b64_tr_b16 v[220:221], v29 offset:0
ds_read_b64_tr_b16 v[222:223], v29 offset:4096
v_add_f32 v196, v148, v240
v_mfma_f32_16x16x32_bf16 v[168:171], v[224:227], v[68:71], v[168:171]
v_exp_f32 v196, v196
v_add_f32 v197, v149, v240
v_mfma_f32_16x16x32_bf16 v[164:167], v[228:231], v[64:67], v[164:167]
ds_read_b64_tr_b16 v[224:225], v30 offset:0
v_exp_f32 v197, v197
v_mfma_f32_16x16x32_bf16 v[172:175], v[228:231], v[68:71], v[172:175]
ds_read_b64_tr_b16 v[226:227], v30 offset:4096
v_cvt_pk_bf16_f32 v177, v194, v195
v_add_f32 v198, v150, v240
v_mfma_f32_16x16x32_bf16 v[160:163], v[232:235], v[72:75], v[160:163]
ds_read_b64_tr_b16 v[228:229], v31 offset:0
ds_read_b64_tr_b16 v[230:231], v31 offset:4096
v_mfma_f32_16x16x32_bf16 v[168:171], v[232:235], v[76:79], v[168:171]
v_exp_f32 v198, v198
v_add_f32 v199, v151, v240
v_mfma_f32_16x16x32_bf16 v[164:167], v[236:239], v[72:75], v[164:167]
ds_read_b64_tr_b16 v[232:233], v32 offset:0
ds_read_b64_tr_b16 v[234:235], v32 offset:4096
v_exp_f32 v199, v199
v_cvt_pk_bf16_f32 v178, v196, v197
v_add_f32 v192, v152, v244
v_exp_f32 v192, v192
v_add_f32 v193, v153, v244
v_exp_f32 v193, v193
v_cvt_pk_bf16_f32 v179, v198, v199
v_add_f32 v194, v154, v244
v_exp_f32 v194, v194
v_add_f32 v195, v155, v244
v_exp_f32 v195, v195
v_mfma_f32_16x16x32_bf16 v[172:175], v[236:239], v[76:79], v[172:175]
v_cvt_pk_bf16_f32 v180, v192, v193
v_add_f32 v196, v156, v244
v_exp_f32 v196, v196
v_add_f32 v197, v157, v244
v_exp_f32 v197, v197
v_cvt_pk_bf16_f32 v181, v194, v195
v_add_f32 v198, v158, v244
v_exp_f32 v198, v198
v_add_f32 v199, v159, v244
v_exp_f32 v199, v199
v_cvt_pk_bf16_f32 v182, v196, v197
v_cvt_pk_bf16_f32 v183, v198, v199
s_waitcnt lgkmcnt(6)
v_mfma_f32_16x16x32_bf16 v[80:83], v[208:211], v[176:179], 0
ds_read_b64_tr_b16 v[236:237], v33 offset:0
v_mfma_f32_16x16x32_bf16 v[84:87], v[208:211], v[180:183], 0
ds_read_b64_tr_b16 v[238:239], v33 offset:4096
v_mfma_f32_16x16x32_bf16 v[88:91], v[212:215], v[176:179], 0
v_exp_f32 v192, v160
v_mfma_f32_16x16x32_bf16 v[92:95], v[212:215], v[180:183], 0
v_exp_f32 v193, v161
v_exp_f32 v194, v162
v_mfma_f32_16x16x32_bf16 v[96:99], v[216:219], v[176:179], 0
v_exp_f32 v195, v163
v_mfma_f32_16x16x32_bf16 v[100:103], v[216:219], v[180:183], 0
v_cvt_pk_bf16_f32 v184, v192, v193
s_barrier
ds_read_b128 v[208:211], v22 offset:32768
v_mfma_f32_16x16x32_bf16 v[104:107], v[220:223], v[176:179], 0
ds_read_b128 v[212:215], v22 offset:36864
v_exp_f32 v196, v164
v_mfma_f32_16x16x32_bf16 v[108:111], v[220:223], v[180:183], 0
v_exp_f32 v197, v165
s_waitcnt lgkmcnt(2)
v_mfma_f32_16x16x32_bf16 v[112:115], v[224:227], v[176:179], 0
v_cvt_pk_bf16_f32 v185, v194, v195
v_exp_f32 v198, v166
v_mfma_f32_16x16x32_bf16 v[116:119], v[224:227], v[180:183], 0
ds_read_b128 v[216:219], v23 offset:32768
v_exp_f32 v199, v167
v_mfma_f32_16x16x32_bf16 v[120:123], v[228:231], v[176:179], 0
ds_read_b128 v[220:223], v23 offset:36864
v_cvt_pk_bf16_f32 v186, v196, v197
v_mfma_f32_16x16x32_bf16 v[124:127], v[228:231], v[180:183], 0
v_or3_b32 v201, v184, v185, v186
v_exp_f32 v192, v168
v_mfma_f32_16x16x32_bf16 v[128:131], v[232:235], v[176:179], 0
ds_read_b128 v[224:227], v24 offset:32768
v_exp_f32 v193, v169
v_mfma_f32_16x16x32_bf16 v[132:135], v[232:235], v[180:183], 0
v_cvt_pk_bf16_f32 v187, v198, v199
v_exp_f32 v194, v170
v_mfma_f32_16x16x32_bf16 v[136:139], v[236:239], v[176:179], 0
ds_read_b128 v[228:231], v24 offset:36864
v_exp_f32 v195, v171
v_mfma_f32_16x16x32_bf16 v[140:143], v[236:239], v[180:183], 0
v_cvt_pk_bf16_f32 v188, v192, v193
s_waitcnt lgkmcnt(3)
v_mfma_f32_16x16x32_bf16 v[204:207], v[4:7], v[176:179], 0
ds_read_b128 v[232:235], v25 offset:32768
v_or3_b32 v201, v201, v187, v188
v_mfma_f32_16x16x32_bf16 v[252:255], v[4:7], v[180:183], 0
v_exp_f32 v196, v172
v_mfma_f32_16x16x32_bf16 v[144:147], v[208:211], v[48:51], v[240:243]
v_exp_f32 v197, v173
v_mfma_f32_16x16x32_bf16 v[152:155], v[208:211], v[52:55], v[244:247]
ds_read_b128 v[236:239], v25 offset:36864
v_cvt_pk_bf16_f32 v189, v194, v195
v_mfma_f32_16x16x32_bf16 v[148:151], v[212:215], v[48:51], v[240:243]
ds_read_b64_tr_b16 v[208:209], v26 offset:8192
ds_read_b64_tr_b16 v[210:211], v26 offset:12288
v_mfma_f32_16x16x32_bf16 v[156:159], v[212:215], v[52:55], v[244:247]
v_exp_f32 v198, v174
v_mfma_f32_16x16x32_bf16 v[144:147], v[216:219], v[56:59], v[144:147]
ds_read_b64_tr_b16 v[212:213], v27 offset:8192
ds_read_b64_tr_b16 v[214:215], v27 offset:12288
v_mfma_f32_16x16x32_bf16 v[152:155], v[216:219], v[60:63], v[152:155]
v_exp_f32 v199, v175
s_waitcnt lgkmcnt(5)
v_mfma_f32_16x16x32_bf16 v[148:151], v[220:223], v[56:59], v[148:151]
ds_read_b64_tr_b16 v[216:217], v28 offset:8192
ds_read_b64_tr_b16 v[218:219], v28 offset:12288
v_mfma_f32_16x16x32_bf16 v[156:159], v[220:223], v[60:63], v[156:159]
v_cvt_pk_bf16_f32 v190, v196, v197
v_or3_b32 v201, v201, v189, v190
v_and_b32 v201, s55, v201
v_mfma_f32_16x16x32_bf16 v[144:147], v[224:227], v[64:67], v[144:147]
ds_read_b64_tr_b16 v[220:221], v29 offset:8192
ds_read_b64_tr_b16 v[222:223], v29 offset:12288
v_mfma_f32_16x16x32_bf16 v[152:155], v[224:227], v[68:71], v[152:155]
v_cvt_pk_bf16_f32 v191, v198, v199
v_and_or_b32 v201, v191, s55, v201
v_mfma_f32_16x16x32_bf16 v[148:151], v[228:231], v[64:67], v[148:151]
ds_read_b64_tr_b16 v[224:225], v30 offset:8192
v_mfma_f32_16x16x32_bf16 v[156:159], v[228:231], v[68:71], v[156:159]
ds_read_b64_tr_b16 v[226:227], v30 offset:12288
v_mfma_f32_16x16x32_bf16 v[144:147], v[232:235], v[72:75], v[144:147]
ds_read_b64_tr_b16 v[228:229], v31 offset:8192
ds_read_b64_tr_b16 v[230:231], v31 offset:12288
v_mfma_f32_16x16x32_bf16 v[152:155], v[232:235], v[76:79], v[152:155]
s_waitcnt lgkmcnt(6)
v_mfma_f32_16x16x32_bf16 v[148:151], v[236:239], v[72:75], v[148:151]
ds_read_b64_tr_b16 v[232:233], v32 offset:8192
ds_read_b64_tr_b16 v[234:235], v32 offset:12288
v_mfma_f32_16x16x32_bf16 v[156:159], v[236:239], v[76:79], v[156:159]
v_cmp_ne_u32 vcc, 0, v201
s_nop 0
s_cbranch_vccnz L_slow1
L_back1:
v_mfma_f32_16x16x32_bf16 v[80:83], v[208:211], v[184:187], v[80:83]
ds_read_b64_tr_b16 v[236:237], v33 offset:8192
v_mfma_f32_16x16x32_bf16 v[84:87], v[208:211], v[188:191], v[84:87]
ds_read_b64_tr_b16 v[238:239], v33 offset:12288
v_mfma_f32_16x16x32_bf16 v[88:91], v[212:215], v[184:187], v[88:91]
v_exp_f32 v192, v144
v_mfma_f32_16x16x32_bf16 v[92:95], v[212:215], v[188:191], v[92:95]
v_exp_f32 v193, v145
v_mfma_f32_16x16x32_bf16 v[96:99], v[216:219], v[184:187], v[96:99]
v_exp_f32 v194, v146
v_mfma_f32_16x16x32_bf16 v[100:103], v[216:219], v[188:191], v[100:103]
ds_read_b128 v[208:211], v22 offset:40960
s_waitcnt lgkmcnt(3)
v_mfma_f32_16x16x32_bf16 v[104:107], v[220:223], v[184:187], v[104:107]
v_exp_f32 v195, v147
v_mfma_f32_16x16x32_bf16 v[108:111], v[220:223], v[188:191], v[108:111]
ds_read_b128 v[212:215], v22 offset:45056
v_cvt_pk_bf16_f32 v176, v192, v193
v_mfma_f32_16x16x32_bf16 v[112:115], v[224:227], v[184:187], v[112:115]
ds_read_b128 v[216:219], v23 offset:40960
v_exp_f32 v196, v148
v_mfma_f32_16x16x32_bf16 v[116:119], v[224:227], v[188:191], v[116:119]
v_exp_f32 v197, v149
v_mfma_f32_16x16x32_bf16 v[120:123], v[228:231], v[184:187], v[120:123]
ds_read_b128 v[220:223], v23 offset:45056
v_cvt_pk_bf16_f32 v177, v194, v195
v_mfma_f32_16x16x32_bf16 v[124:127], v[228:231], v[188:191], v[124:127]
v_exp_f32 v198, v150
v_mfma_f32_16x16x32_bf16 v[128:131], v[232:235], v[184:187], v[128:131]
ds_read_b128 v[224:227], v24 offset:40960
v_exp_f32 v199, v151
v_mfma_f32_16x16x32_bf16 v[132:135], v[232:235], v[188:191], v[132:135]
v_cvt_pk_bf16_f32 v178, v196, v197
s_waitcnt lgkmcnt(3)
v_mfma_f32_16x16x32_bf16 v[136:139], v[236:239], v[184:187], v[136:139]
ds_read_b128 v[228:231], v24 offset:45056
v_or3_b32 v200, v176, v177, v178
v_mfma_f32_16x16x32_bf16 v[140:143], v[236:239], v[188:191], v[140:143]
v_exp_f32 v192, v152
v_mfma_f32_16x16x32_bf16 v[204:207], v[4:7], v[184:187], v[204:207]
v_exp_f32 v193, v153
v_mfma_f32_16x16x32_bf16 v[252:255], v[4:7], v[188:191], v[252:255]
ds_read_b128 v[232:235], v25 offset:40960
v_cvt_pk_bf16_f32 v179, v198, v199
v_mfma_f32_16x16x32_bf16 v[160:163], v[208:211], v[48:51], v[240:243]
ds_read_b128 v[236:239], v25 offset:45056
v_exp_f32 v194, v154
v_mfma_f32_16x16x32_bf16 v[168:171], v[208:211], v[52:55], v[244:247]
v_exp_f32 v195, v155
v_mfma_f32_16x16x32_bf16 v[164:167], v[212:215], v[48:51], v[240:243]
v_cvt_pk_bf16_f32 v180, v192, v193
v_mfma_f32_16x16x32_bf16 v[172:175], v[212:215], v[52:55], v[244:247]
s_barrier
ds_read_b64_tr_b16 v[208:209], v26 offset:32768
ds_read_b64_tr_b16 v[210:211], v26 offset:36864
s_waitcnt lgkmcnt(4)
v_mfma_f32_16x16x32_bf16 v[160:163], v[216:219], v[56:59], v[160:163]
ds_read_b64_tr_b16 v[212:213], v27 offset:32768
ds_read_b64_tr_b16 v[214:215], v27 offset:36864
v_mfma_f32_16x16x32_bf16 v[168:171], v[216:219], v[60:63], v[168:171]
v_or3_b32 v200, v200, v179, v180
v_exp_f32 v196, v156
v_mfma_f32_16x16x32_bf16 v[164:167], v[220:223], v[56:59], v[164:167]
ds_read_b64_tr_b16 v[216:217], v28 offset:32768
ds_read_b64_tr_b16 v[218:219], v28 offset:36864
v_mfma_f32_16x16x32_bf16 v[172:175], v[220:223], v[60:63], v[172:175]
v_exp_f32 v197, v157
v_cvt_pk_bf16_f32 v181, v194, v195
v_mfma_f32_16x16x32_bf16 v[160:163], v[224:227], v[64:67], v[160:163]
ds_read_b64_tr_b16 v[220:221], v29 offset:32768
ds_read_b64_tr_b16 v[222:223], v29 offset:36864
v_mfma_f32_16x16x32_bf16 v[168:171], v[224:227], v[68:71], v[168:171]
v_exp_f32 v198, v158
v_mfma_f32_16x16x32_bf16 v[164:167], v[228:231], v[64:67], v[164:167]
ds_read_b64_tr_b16 v[224:225], v30 offset:32768
ds_read_b64_tr_b16 v[226:227], v30 offset:36864
v_mfma_f32_16x16x32_bf16 v[172:175], v[228:231], v[68:71], v[172:175]
v_exp_f32 v199, v159
s_waitcnt lgkmcnt(6)
v_mfma_f32_16x16x32_bf16 v[160:163], v[232:235], v[72:75], v[160:163]
ds_read_b64_tr_b16 v[228:229], v31 offset:32768
ds_read_b64_tr_b16 v[230:231], v31 offset:36864
v_mfma_f32_16x16x32_bf16 v[168:171], v[232:235], v[76:79], v[168:171]
v_cvt_pk_bf16_f32 v182, v196, v197
v_or3_b32 v200, v200, v181, v182
v_and_b32 v200, s55, v200
v_mfma_f32_16x16x32_bf16 v[164:167], v[236:239], v[72:75], v[164:167]
ds_read_b64_tr_b16 v[232:233], v32 offset:32768
ds_read_b64_tr_b16 v[234:235], v32 offset:36864
v_cvt_pk_bf16_f32 v183, v198, v199
v_mfma_f32_16x16x32_bf16 v[172:175], v[236:239], v[76:79], v[172:175]
v_and_or_b32 v200, v183, s55, v200
v_cmp_ne_u32 vcc, 0, v200
s_nop 0
s_cbranch_vccnz L_slow2
L_back2:
v_mfma_f32_16x16x32_bf16 v[80:83], v[208:211], v[176:179], v[80:83]
ds_read_b64_tr_b16 v[236:237], v33 offset:32768
v_mfma_f32_16x16x32_bf16 v[84:87], v[208:211], v[180:183], v[84:87]
ds_read_b64_tr_b16 v[238:239], v33 offset:36864
v_mfma_f32_16x16x32_bf16 v[88:91], v[212:215], v[176:179], v[88:91]
v_exp_f32 v192, v160
v_mfma_f32_16x16x32_bf16 v[92:95], v[212:215], v[180:183], v[92:95]
v_exp_f32 v193, v161
s_waitcnt lgkmcnt(4)
v_mfma_f32_16x16x32_bf16 v[96:99], v[216:219], v[176:179], v[96:99]
v_mfma_f32_16x16x32_bf16 v[100:103], v[216:219], v[180:183], v[100:103]
s_barrier
v_add_u32 v22, 0xfffe8000, v22
v_add_u32 v23, 0xfffe8000, v23
v_add_u32 v24, 0xfffe8000, v24
v_add_u32 v25, 0xfffe8000, v25
ds_read_b128 v[208:211], v22 offset:0
v_mfma_f32_16x16x32_bf16 v[104:107], v[220:223], v[176:179], v[104:107]
ds_read_b128 v[212:215], v22 offset:4096
v_exp_f32 v194, v162
v_mfma_f32_16x16x32_bf16 v[108:111], v[220:223], v[180:183], v[108:111]
v_exp_f32 v195, v163
v_mfma_f32_16x16x32_bf16 v[112:115], v[224:227], v[176:179], v[112:115]
ds_read_b128 v[216:219], v23 offset:0
v_cvt_pk_bf16_f32 v184, v192, v193
v_mfma_f32_16x16x32_bf16 v[116:119], v[224:227], v[180:183], v[116:119]
v_exp_f32 v196, v164
v_mfma_f32_16x16x32_bf16 v[120:123], v[228:231], v[176:179], v[120:123]
ds_read_b128 v[220:223], v23 offset:4096
v_exp_f32 v197, v165
v_mfma_f32_16x16x32_bf16 v[124:127], v[228:231], v[180:183], v[124:127]
v_cvt_pk_bf16_f32 v185, v194, v195
s_waitcnt lgkmcnt(3)
v_mfma_f32_16x16x32_bf16 v[128:131], v[232:235], v[176:179], v[128:131]
ds_read_b128 v[224:227], v24 offset:0
v_exp_f32 v198, v166
v_mfma_f32_16x16x32_bf16 v[132:135], v[232:235], v[180:183], v[132:135]
v_exp_f32 v199, v167
v_mfma_f32_16x16x32_bf16 v[136:139], v[236:239], v[176:179], v[136:139]
ds_read_b128 v[228:231], v24 offset:4096
v_cvt_pk_bf16_f32 v186, v196, v197
v_mfma_f32_16x16x32_bf16 v[140:143], v[236:239], v[180:183], v[140:143]
v_or3_b32 v201, v184, v185, v186
v_exp_f32 v192, v168
v_mfma_f32_16x16x32_bf16 v[204:207], v[4:7], v[176:179], v[204:207]
v_exp_f32 v193, v169
v_mfma_f32_16x16x32_bf16 v[252:255], v[4:7], v[180:183], v[252:255]
ds_read_b128 v[232:235], v25 offset:0
v_cvt_pk_bf16_f32 v187, v198, v199
v_mfma_f32_16x16x32_bf16 v[144:147], v[208:211], v[48:51], v[240:243]
v_exp_f32 v194, v170
v_mfma_f32_16x16x32_bf16 v[152:155], v[208:211], v[52:55], v[244:247]
ds_read_b128 v[236:239], v25 offset:4096
s_waitcnt lgkmcnt(3)
v_mfma_f32_16x16x32_bf16 v[148:151], v[212:215], v[48:51], v[240:243]
ds_read_b64_tr_b16 v[208:209], v26 offset:40960
ds_read_b64_tr_b16 v[210:211], v26 offset:45056
v_mfma_f32_16x16x32_bf16 v[156:159], v[212:215], v[52:55], v[244:247]
v_exp_f32 v195, v171
v_cvt_pk_bf16_f32 v188, v192, v193
v_mfma_f32_16x16x32_bf16 v[144:147], v[216:219], v[56:59], v[144:147]
ds_read_b64_tr_b16 v[212:213], v27 offset:40960
ds_read_b64_tr_b16 v[214:215], v27 offset:45056
v_mfma_f32_16x16x32_bf16 v[152:155], v[216:219], v[60:63], v[152:155]
v_or3_b32 v201, v201, v187, v188
v_exp_f32 v196, v172
v_mfma_f32_16x16x32_bf16 v[148:151], v[220:223], v[56:59], v[148:151]
ds_read_b64_tr_b16 v[216:217], v28 offset:40960
ds_read_b64_tr_b16 v[218:219], v28 offset:45056
v_mfma_f32_16x16x32_bf16 v[156:159], v[220:223], v[60:63], v[156:159]
v_exp_f32 v197, v173
v_cvt_pk_bf16_f32 v189, v194, v195
v_mfma_f32_16x16x32_bf16 v[144:147], v[224:227], v[64:67], v[144:147]
ds_read_b64_tr_b16 v[220:221], v29 offset:40960
ds_read_b64_tr_b16 v[222:223], v29 offset:45056
v_mfma_f32_16x16x32_bf16 v[152:155], v[224:227], v[68:71], v[152:155]
v_exp_f32 v198, v174
s_waitcnt lgkmcnt(6)
v_mfma_f32_16x16x32_bf16 v[148:151], v[228:231], v[64:67], v[148:151]
ds_read_b64_tr_b16 v[224:225], v30 offset:40960
ds_read_b64_tr_b16 v[226:227], v30 offset:45056
v_mfma_f32_16x16x32_bf16 v[156:159], v[228:231], v[68:71], v[156:159]
v_exp_f32 v199, v175
v_cvt_pk_bf16_f32 v190, v196, v197
v_mfma_f32_16x16x32_bf16 v[144:147], v[232:235], v[72:75], v[144:147]
ds_read_b64_tr_b16 v[228:229], v31 offset:40960
ds_read_b64_tr_b16 v[230:231], v31 offset:45056
v_mfma_f32_16x16x32_bf16 v[152:155], v[232:235], v[76:79], v[152:155]
v_or3_b32 v201, v201, v189, v190
v_and_b32 v201, s55, v201
v_cvt_pk_bf16_f32 v191, v198, v199
v_mfma_f32_16x16x32_bf16 v[148:151], v[236:239], v[72:75], v[148:151]
ds_read_b64_tr_b16 v[232:233], v32 offset:40960
ds_read_b64_tr_b16 v[234:235], v32 offset:45056
v_and_or_b32 v201, v191, s55, v201
v_mfma_f32_16x16x32_bf16 v[156:159], v[236:239], v[76:79], v[156:159]
v_cmp_ne_u32 vcc, 0, v201
s_nop 0
s_cbranch_vccnz L_slow3
L_back3:
v_mfma_f32_16x16x32_bf16 v[80:83], v[208:211], v[184:187], v[80:83]
ds_read_b64_tr_b16 v[236:237], v33 offset:40960
ds_read_b64_tr_b16 v[238:239], v33 offset:45056
v_mfma_f32_16x16x32_bf16 v[84:87], v[208:211], v[188:191], v[84:87]
s_waitcnt lgkmcnt(6)
v_mfma_f32_16x16x32_bf16 v[88:91], v[212:215], v[184:187], v[88:91]
v_exp_f32 v192, v144
v_mfma_f32_16x16x32_bf16 v[92:95], v[212:215], v[188:191], v[92:95]
v_exp_f32 v193, v145
v_mfma_f32_16x16x32_bf16 v[96:99], v[216:219], v[184:187], v[96:99]
ds_read_b128 v[208:211], v22 offset:8192
v_exp_f32 v194, v146
v_mfma_f32_16x16x32_bf16 v[100:103], v[216:219], v[188:191], v[100:103]
v_exp_f32 v195, v147
v_mfma_f32_16x16x32_bf16 v[104:107], v[220:223], v[184:187], v[104:107]
ds_read_b128 v[212:215], v22 offset:12288
v_cvt_pk_bf16_f32 v176, v192, v193
v_mfma_f32_16x16x32_bf16 v[108:111], v[220:223], v[188:191], v[108:111]
v_exp_f32 v196, v148
v_mfma_f32_16x16x32_bf16 v[112:115], v[224:227], v[184:187], v[112:115]
ds_read_b128 v[216:219], v23 offset:8192
v_exp_f32 v197, v149
v_mfma_f32_16x16x32_bf16 v[116:119], v[224:227], v[188:191], v[116:119]
v_cvt_pk_bf16_f32 v177, v194, v195
s_waitcnt lgkmcnt(3)
v_mfma_f32_16x16x32_bf16 v[120:123], v[228:231], v[184:187], v[120:123]
ds_read_b128 v[220:223], v23 offset:12288
v_exp_f32 v198, v150
v_mfma_f32_16x16x32_bf16 v[124:127], v[228:231], v[188:191], v[124:127]
v_exp_f32 v199, v151
v_mfma_f32_16x16x32_bf16 v[128:131], v[232:235], v[184:187], v[128:131]
ds_read_b128 v[224:227], v24 offset:8192
v_cvt_pk_bf16_f32 v178, v196, v197
v_mfma_f32_16x16x32_bf16 v[132:135], v[232:235], v[188:191], v[132:135]
v_or3_b32 v200, v176, v177, v178
v_exp_f32 v192, v152
v_mfma_f32_16x16x32_bf16 v[136:139], v[236:239], v[184:187], v[136:139]
v_exp_f32 v193, v153
v_mfma_f32_16x16x32_bf16 v[140:143], v[236:239], v[188:191], v[140:143]
ds_read_b128 v[228:231], v24 offset:12288
v_cvt_pk_bf16_f32 v179, v198, v199
v_mfma_f32_16x16x32_bf16 v[204:207], v[4:7], v[184:187], v[204:207]
v_exp_f32 v194, v154
v_mfma_f32_16x16x32_bf16 v[252:255], v[4:7], v[188:191], v[252:255]
ds_read_b128 v[232:235], v25 offset:8192
s_waitcnt lgkmcnt(3)
v_mfma_f32_16x16x32_bf16 v[160:163], v[208:211], v[48:51], v[240:243]
ds_read_b128 v[236:239], v25 offset:12288
v_exp_f32 v195, v155
v_mfma_f32_16x16x32_bf16 v[168:171], v[208:211], v[52:55], v[244:247]
v_cvt_pk_bf16_f32 v180, v192, v193
v_or3_b32 v200, v200, v179, v180
v_mfma_f32_16x16x32_bf16 v[164:167], v[212:215], v[48:51], v[240:243]
v_mfma_f32_16x16x32_bf16 v[172:175], v[212:215], v[52:55], v[244:247]
s_barrier
v_add_u32 v26, 0xfffe8000, v26
v_add_u32 v27, 0xfffe8000, v27
v_add_u32 v28, 0xfffe8000, v28
v_add_u32 v29, 0xfffe8000, v29
v_add_u32 v30, 0xfffe8000, v30
v_add_u32 v31, 0xfffe8000, v31
v_add_u32 v32, 0xfffe8000, v32
v_add_u32 v33, 0xfffe8000, v33
ds_read_b64_tr_b16 v[208:209], v26 offset:0
ds_read_b64_tr_b16 v[210:211], v26 offset:4096
v_mfma_f32_16x16x32_bf16 v[160:163], v[216:219], v[56:59], v[160:163]
ds_read_b64_tr_b16 v[212:213], v27 offset:0
ds_read_b64_tr_b16 v[214:215], v27 offset:4096
v_mfma_f32_16x16x32_bf16 v[168:171], v[216:219], v[60:63], v[168:171]
v_exp_f32 v196, v156
v_mfma_f32_16x16x32_bf16 v[164:167], v[220:223], v[56:59], v[164:167]
ds_read_b64_tr_b16 v[216:217], v28 offset:0
ds_read_b64_tr_b16 v[218:219], v28 offset:4096
v_mfma_f32_16x16x32_bf16 v[172:175], v[220:223], v[60:63], v[172:175]
v_exp_f32 v197, v157
s_waitcnt lgkmcnt(6)
v_mfma_f32_16x16x32_bf16 v[160:163], v[224:227], v[64:67], v[160:163]
ds_read_b64_tr_b16 v[220:221], v29 offset:0
ds_read_b64_tr_b16 v[222:223], v29 offset:4096
v_mfma_f32_16x16x32_bf16 v[168:171], v[224:227], v[68:71], v[168:171]
v_cvt_pk_bf16_f32 v181, v194, v195
v_exp_f32 v198, v158
v_mfma_f32_16x16x32_bf16 v[164:167], v[228:231], v[64:67], v[164:167]
ds_read_b64_tr_b16 v[224:225], v30 offset:0
ds_read_b64_tr_b16 v[226:227], v30 offset:4096
v_mfma_f32_16x16x32_bf16 v[172:175], v[228:231], v[68:71], v[172:175]
v_exp_f32 v199, v159
v_cvt_pk_bf16_f32 v182, v196, v197
v_mfma_f32_16x16x32_bf16 v[160:163], v[232:235], v[72:75], v[160:163]
ds_read_b64_tr_b16 v[228:229], v31 offset:0
ds_read_b64_tr_b16 v[230:231], v31 offset:4096
v_mfma_f32_16x16x32_bf16 v[168:171], v[232:235], v[76:79], v[168:171]
v_or3_b32 v200, v200, v181, v182
v_and_b32 v200, s55, v200
v_cvt_pk_bf16_f32 v183, v198, v199
v_mfma_f32_16x16x32_bf16 v[164:167], v[236:239], v[72:75], v[164:167]
ds_read_b64_tr_b16 v[232:233], v32 offset:0
ds_read_b64_tr_b16 v[234:235], v32 offset:4096
v_and_or_b32 v200, v183, s55, v200
v_mfma_f32_16x16x32_bf16 v[172:175], v[236:239], v[76:79], v[172:175]
v_cmp_ne_u32 vcc, 0, v200
s_nop 0
s_cbranch_vccnz L_slow4
L_back4:
s_waitcnt lgkmcnt(6)
v_mfma_f32_16x16x32_bf16 v[80:83], v[208:211], v[176:179], v[80:83]
ds_read_b64_tr_b16 v[236:237], v33 offset:0
v_mfma_f32_16x16x32_bf16 v[84:87], v[208:211], v[180:183], v[84:87]
ds_read_b64_tr_b16 v[238:239], v33 offset:4096
v_mfma_f32_16x16x32_bf16 v[88:91], v[212:215], v[176:179], v[88:91]
v_exp_f32 v192, v160
v_mfma_f32_16x16x32_bf16 v[92:95], v[212:215], v[180:183], v[92:95]
v_exp_f32 v193, v161
v_mfma_f32_16x16x32_bf16 v[96:99], v[216:219], v[176:179], v[96:99]
v_exp_f32 v194, v162
v_mfma_f32_16x16x32_bf16 v[100:103], v[216:219], v[180:183], v[100:103]
s_barrier
ds_read_b128 v[208:211], v22 offset:32768
v_mfma_f32_16x16x32_bf16 v[104:107], v[220:223], v[176:179], v[104:107]
ds_read_b128 v[212:215], v22 offset:36864
v_exp_f32 v195, v163
v_mfma_f32_16x16x32_bf16 v[108:111], v[220:223], v[180:183], v[108:111]
v_cvt_pk_bf16_f32 v184, v192, v193
s_waitcnt lgkmcnt(2)
v_mfma_f32_16x16x32_bf16 v[112:115], v[224:227], v[176:179], v[112:115]
ds_read_b128 v[216:219], v23 offset:32768
v_exp_f32 v196, v164
v_mfma_f32_16x16x32_bf16 v[116:119], v[224:227], v[180:183], v[116:119]
v_exp_f32 v197, v165
v_mfma_f32_16x16x32_bf16 v[120:123], v[228:231], v[176:179], v[120:123]
ds_read_b128 v[220:223], v23 offset:36864
v_cvt_pk_bf16_f32 v185, v194, v195
v_mfma_f32_16x16x32_bf16 v[124:127], v[228:231], v[180:183], v[124:127]
v_exp_f32 v198, v166
v_mfma_f32_16x16x32_bf16 v[128:131], v[232:235], v[176:179], v[128:131]
ds_read_b128 v[224:227], v24 offset:32768
v_exp_f32 v199, v167
v_mfma_f32_16x16x32_bf16 v[132:135], v[232:235], v[180:183], v[132:135]
v_cvt_pk_bf16_f32 v186, v196, v197
v_or3_b32 v201, v184, v185, v186
v_mfma_f32_16x16x32_bf16 v[136:139], v[236:239], v[176:179], v[136:139]
v_exp_f32 v192, v168
v_mfma_f32_16x16x32_bf16 v[140:143], v[236:239], v[180:183], v[140:143]
ds_read_b128 v[228:231], v24 offset:36864
s_waitcnt lgkmcnt(3)
v_mfma_f32_16x16x32_bf16 v[204:207], v[4:7], v[176:179], v[204:207]
v_exp_f32 v193, v169
v_mfma_f32_16x16x32_bf16 v[252:255], v[4:7], v[180:183], v[252:255]
ds_read_b128 v[232:235], v25 offset:32768
v_cvt_pk_bf16_f32 v187, v198, v199
v_mfma_f32_16x16x32_bf16 v[144:147], v[208:211], v[48:51], v[240:243]
ds_read_b128 v[236:239], v25 offset:36864
v_exp_f32 v194, v170
v_mfma_f32_16x16x32_bf16 v[152:155], v[208:211], v[52:55], v[244:247]
v_exp_f32 v195, v171
v_mfma_f32_16x16x32_bf16 v[148:151], v[212:215], v[48:51], v[240:243]
ds_read_b64_tr_b16 v[208:209], v26 offset:8192
ds_read_b64_tr_b16 v[210:211], v26 offset:12288
v_mfma_f32_16x16x32_bf16 v[156:159], v[212:215], v[52:55], v[244:247]
v_cvt_pk_bf16_f32 v188, v192, v193
v_or3_b32 v201, v201, v187, v188
v_mfma_f32_16x16x32_bf16 v[144:147], v[216:219], v[56:59], v[144:147]
ds_read_b64_tr_b16 v[212:213], v27 offset:8192
ds_read_b64_tr_b16 v[214:215], v27 offset:12288
v_mfma_f32_16x16x32_bf16 v[152:155], v[216:219], v[60:63], v[152:155]
v_exp_f32 v196, v172
s_waitcnt lgkmcnt(5)
v_mfma_f32_16x16x32_bf16 v[148:151], v[220:223], v[56:59], v[148:151]
ds_read_b64_tr_b16 v[216:217], v28 offset:8192
ds_read_b64_tr_b16 v[218:219], v28 offset:12288
v_mfma_f32_16x16x32_bf16 v[156:159], v[220:223], v[60:63], v[156:159]
v_exp_f32 v197, v173
v_cvt_pk_bf16_f32 v189, v194, v195
v_mfma_f32_16x16x32_bf16 v[144:147], v[224:227], v[64:67], v[144:147]
ds_read_b64_tr_b16 v[220:221], v29 offset:8192
ds_read_b64_tr_b16 v[222:223], v29 offset:12288
v_mfma_f32_16x16x32_bf16 v[152:155], v[224:227], v[68:71], v[152:155]
v_exp_f32 v198, v174
v_mfma_f32_16x16x32_bf16 v[148:151], v[228:231], v[64:67], v[148:151]
ds_read_b64_tr_b16 v[224:225], v30 offset:8192
ds_read_b64_tr_b16 v[226:227], v30 offset:12288
v_mfma_f32_16x16x32_bf16 v[156:159], v[228:231], v[68:71], v[156:159]
v_exp_f32 v199, v175
v_cvt_pk_bf16_f32 v190, v196, v197
v_mfma_f32_16x16x32_bf16 v[144:147], v[232:235], v[72:75], v[144:147]
ds_read_b64_tr_b16 v[228:229], v31 offset:8192
ds_read_b64_tr_b16 v[230:231], v31 offset:12288
v_mfma_f32_16x16x32_bf16 v[152:155], v[232:235], v[76:79], v[152:155]
v_or3_b32 v201, v201, v189, v190
v_and_b32 v201, s55, v201
s_waitcnt lgkmcnt(6)
v_mfma_f32_16x16x32_bf16 v[148:151], v[236:239], v[72:75], v[148:151]
ds_read_b64_tr_b16 v[232:233], v32 offset:8192
ds_read_b64_tr_b16 v[234:235], v32 offset:12288
v_cvt_pk_bf16_f32 v191, v198, v199
v_mfma_f32_16x16x32_bf16 v[156:159], v[236:239], v[76:79], v[156:159]
v_and_or_b32 v201, v191, s55, v201
v_cmp_ne_u32 vcc, 0, v201
s_nop 0
s_cbranch_vccnz L_slow5
L_back5:
v_mfma_f32_16x16x32_bf16 v[80:83], v[208:211], v[184:187], v[80:83]
ds_read_b64_tr_b16 v[236:237], v33 offset:8192
v_mfma_f32_16x16x32_bf16 v[84:87], v[208:211], v[188:191], v[84:87]
ds_read_b64_tr_b16 v[238:239], v33 offset:12288
v_mfma_f32_16x16x32_bf16 v[88:91], v[212:215], v[184:187], v[88:91]
v_exp_f32 v192, v144
v_mfma_f32_16x16x32_bf16 v[92:95], v[212:215], v[188:191], v[92:95]
v_exp_f32 v193, v145
v_mfma_f32_16x16x32_bf16 v[96:99], v[216:219], v[184:187], v[96:99]
v_exp_f32 v194, v146
v_mfma_f32_16x16x32_bf16 v[100:103], v[216:219], v[188:191], v[100:103]
ds_read_b128 v[208:211], v22 offset:40960
s_waitcnt lgkmcnt(3)
v_mfma_f32_16x16x32_bf16 v[104:107], v[220:223], v[184:187], v[104:107]
v_exp_f32 v195, v147
v_mfma_f32_16x16x32_bf16 v[108:111], v[220:223], v[188:191], v[108:111]
ds_read_b128 v[212:215], v22 offset:45056
v_cvt_pk_bf16_f32 v176, v192, v193
v_mfma_f32_16x16x32_bf16 v[112:115], v[224:227], v[184:187], v[112:115]
ds_read_b128 v[216:219], v23 offset:40960
v_exp_f32 v196, v148
v_mfma_f32_16x16x32_bf16 v[116:119], v[224:227], v[188:191], v[116:119]
v_exp_f32 v197, v149
v_mfma_f32_16x16x32_bf16 v[120:123], v[228:231], v[184:187], v[120:123]
ds_read_b128 v[220:223], v23 offset:45056
v_cvt_pk_bf16_f32 v177, v194, v195
v_mfma_f32_16x16x32_bf16 v[124:127], v[228:231], v[188:191], v[124:127]
v_exp_f32 v198, v150
v_mfma_f32_16x16x32_bf16 v[128:131], v[232:235], v[184:187], v[128:131]
ds_read_b128 v[224:227], v24 offset:40960
v_exp_f32 v199, v151
v_mfma_f32_16x16x32_bf16 v[132:135], v[232:235], v[188:191], v[132:135]
v_cvt_pk_bf16_f32 v178, v196, v197
s_waitcnt lgkmcnt(3)
v_mfma_f32_16x16x32_bf16 v[136:139], v[236:239], v[184:187], v[136:139]
ds_read_b128 v[228:231], v24 offset:45056
v_or3_b32 v200, v176, v177, v178
v_mfma_f32_16x16x32_bf16 v[140:143], v[236:239], v[188:191], v[140:143]
v_exp_f32 v192, v152
v_mfma_f32_16x16x32_bf16 v[204:207], v[4:7], v[184:187], v[204:207]
v_exp_f32 v193, v153
v_mfma_f32_16x16x32_bf16 v[252:255], v[4:7], v[188:191], v[252:255]
ds_read_b128 v[232:235], v25 offset:40960
v_cvt_pk_bf16_f32 v179, v198, v199
v_mfma_f32_16x16x32_bf16 v[160:163], v[208:211], v[48:51], v[240:243]
ds_read_b128 v[236:239], v25 offset:45056
v_exp_f32 v194, v154
v_mfma_f32_16x16x32_bf16 v[168:171], v[208:211], v[52:55], v[244:247]
v_exp_f32 v195, v155
v_mfma_f32_16x16x32_bf16 v[164:167], v[212:215], v[48:51], v[240:243]
v_cvt_pk_bf16_f32 v180, v192, v193
v_mfma_f32_16x16x32_bf16 v[172:175], v[212:215], v[52:55], v[244:247]
s_barrier
ds_read_b64_tr_b16 v[208:209], v26 offset:32768
ds_read_b64_tr_b16 v[210:211], v26 offset:36864
s_waitcnt lgkmcnt(4)
v_mfma_f32_16x16x32_bf16 v[160:163], v[216:219], v[56:59], v[160:163]
ds_read_b64_tr_b16 v[212:213], v27 offset:32768
ds_read_b64_tr_b16 v[214:215], v27 offset:36864
v_mfma_f32_16x16x32_bf16 v[168:171], v[216:219], v[60:63], v[168:171]
v_or3_b32 v200, v200, v179, v180
v_exp_f32 v196, v156
v_mfma_f32_16x16x32_bf16 v[164:167], v[220:223], v[56:59], v[164:167]
ds_read_b64_tr_b16 v[216:217], v28 offset:32768
ds_read_b64_tr_b16 v[218:219], v28 offset:36864
v_mfma_f32_16x16x32_bf16 v[172:175], v[220:223], v[60:63], v[172:175]
v_exp_f32 v197, v157
v_cvt_pk_bf16_f32 v181, v194, v195
v_mfma_f32_16x16x32_bf16 v[160:163], v[224:227], v[64:67], v[160:163]
ds_read_b64_tr_b16 v[220:221], v29 offset:32768
ds_read_b64_tr_b16 v[222:223], v29 offset:36864
v_mfma_f32_16x16x32_bf16 v[168:171], v[224:227], v[68:71], v[168:171]
v_exp_f32 v198, v158
v_mfma_f32_16x16x32_bf16 v[164:167], v[228:231], v[64:67], v[164:167]
ds_read_b64_tr_b16 v[224:225], v30 offset:32768
ds_read_b64_tr_b16 v[226:227], v30 offset:36864
v_mfma_f32_16x16x32_bf16 v[172:175], v[228:231], v[68:71], v[172:175]
v_exp_f32 v199, v159
s_waitcnt lgkmcnt(6)
v_mfma_f32_16x16x32_bf16 v[160:163], v[232:235], v[72:75], v[160:163]
ds_read_b64_tr_b16 v[228:229], v31 offset:32768
ds_read_b64_tr_b16 v[230:231], v31 offset:36864
v_mfma_f32_16x16x32_bf16 v[168:171], v[232:235], v[76:79], v[168:171]
v_cvt_pk_bf16_f32 v182, v196, v197
v_or3_b32 v200, v200, v181, v182
v_and_b32 v200, s55, v200
v_mfma_f32_16x16x32_bf16 v[164:167], v[236:239], v[72:75], v[164:167]
ds_read_b64_tr_b16 v[232:233], v32 offset:32768
ds_read_b64_tr_b16 v[234:235], v32 offset:36864
v_cvt_pk_bf16_f32 v183, v198, v199
v_mfma_f32_16x16x32_bf16 v[172:175], v[236:239], v[76:79], v[172:175]
v_and_or_b32 v200, v183, s55, v200
v_cmp_ne_u32 vcc, 0, v200
s_nop 0
s_cbranch_vccnz L_slow6
L_back6:
v_mfma_f32_16x16x32_bf16 v[80:83], v[208:211], v[176:179], v[80:83]
ds_read_b64_tr_b16 v[236:237], v33 offset:32768
v_mfma_f32_16x16x32_bf16 v[84:87], v[208:211], v[180:183], v[84:87]
ds_read_b64_tr_b16 v[238:239], v33 offset:36864
v_mfma_f32_16x16x32_bf16 v[88:91], v[212:215], v[176:179], v[88:91]
v_exp_f32 v192, v160
v_mfma_f32_16x16x32_bf16 v[92:95], v[212:215], v[180:183], v[92:95]
v_exp_f32 v193, v161
s_waitcnt lgkmcnt(4)
v_mfma_f32_16x16x32_bf16 v[96:99], v[216:219], v[176:179], v[96:99]
v_mfma_f32_16x16x32_bf16 v[100:103], v[216:219], v[180:183], v[100:103]
s_barrier
v_add_u32 v22, 0x10000, v22
v_add_u32 v23, 0x10000, v23
v_add_u32 v24, 0x10000, v24
v_add_u32 v25, 0x10000, v25
ds_read_b128 v[208:211], v22 offset:0
v_mfma_f32_16x16x32_bf16 v[104:107], v[220:223], v[176:179], v[104:107]
ds_read_b128 v[212:215], v22 offset:4096
v_exp_f32 v194, v162
v_mfma_f32_16x16x32_bf16 v[108:111], v[220:223], v[180:183], v[108:111]
v_exp_f32 v195, v163
v_mfma_f32_16x16x32_bf16 v[112:115], v[224:227], v[176:179], v[112:115]
ds_read_b128 v[216:219], v23 offset:0
v_cvt_pk_bf16_f32 v184, v192, v193
v_mfma_f32_16x16x32_bf16 v[116:119], v[224:227], v[180:183], v[116:119]
v_exp_f32 v196, v164
v_mfma_f32_16x16x32_bf16 v[120:123], v[228:231], v[176:179], v[120:123]
ds_read_b128 v[220:223], v23 offset:4096
v_exp_f32 v197, v165
v_mfma_f32_16x16x32_bf16 v[124:127], v[228:231], v[180:183], v[124:127]
v_cvt_pk_bf16_f32 v185, v194, v195
s_waitcnt lgkmcnt(3)
v_mfma_f32_16x16x32_bf16 v[128:131], v[232:235], v[176:179], v[128:131]
ds_read_b128 v[224:227], v24 offset:0
v_exp_f32 v198, v166
v_mfma_f32_16x16x32_bf16 v[132:135], v[232:235], v[180:183], v[132:135]
v_exp_f32 v199, v167
v_mfma_f32_16x16x32_bf16 v[136:139], v[236:239], v[176:179], v[136:139]
ds_read_b128 v[228:231], v24 offset:4096
v_cvt_pk_bf16_f32 v186, v196, v197
v_mfma_f32_16x16x32_bf16 v[140:143], v[236:239], v[180:183], v[140:143]
v_or3_b32 v201, v184, v185, v186
v_exp_f32 v192, v168
v_mfma_f32_16x16x32_bf16 v[204:207], v[4:7], v[176:179], v[204:207]
v_exp_f32 v193, v169
v_mfma_f32_16x16x32_bf16 v[252:255], v[4:7], v[180:183], v[252:255]
ds_read_b128 v[232:235], v25 offset:0
v_cvt_pk_bf16_f32 v187, v198, v199
v_mfma_f32_16x16x32_bf16 v[144:147], v[208:211], v[48:51], v[240:243]
v_exp_f32 v194, v170
v_mfma_f32_16x16x32_bf16 v[152:155], v[208:211], v[52:55], v[244:247]
ds_read_b128 v[236:239], v25 offset:4096
s_waitcnt lgkmcnt(3)
v_mfma_f32_16x16x32_bf16 v[148:151], v[212:215], v[48:51], v[240:243]
ds_read_b64_tr_b16 v[208:209], v26 offset:40960
ds_read_b64_tr_b16 v[210:211], v26 offset:45056
v_mfma_f32_16x16x32_bf16 v[156:159], v[212:215], v[52:55], v[244:247]
v_exp_f32 v195, v171
v_cvt_pk_bf16_f32 v188, v192, v193
v_mfma_f32_16x16x32_bf16 v[144:147], v[216:219], v[56:59], v[144:147]
ds_read_b64_tr_b16 v[212:213], v27 offset:40960
ds_read_b64_tr_b16 v[214:215], v27 offset:45056
v_mfma_f32_16x16x32_bf16 v[152:155], v[216:219], v[60:63], v[152:155]
v_or3_b32 v201, v201, v187, v188
v_exp_f32 v196, v172
v_mfma_f32_16x16x32_bf16 v[148:151], v[220:223], v[56:59], v[148:151]
ds_read_b64_tr_b16 v[216:217], v28 offset:40960
ds_read_b64_tr_b16 v[218:219], v28 offset:45056
v_mfma_f32_16x16x32_bf16 v[156:159], v[220:223], v[60:63], v[156:159]
v_exp_f32 v197, v173
v_cvt_pk_bf16_f32 v189, v194, v195
v_mfma_f32_16x16x32_bf16 v[144:147], v[224:227], v[64:67], v[144:147]
ds_read_b64_tr_b16 v[220:221], v29 offset:40960
ds_read_b64_tr_b16 v[222:223], v29 offset:45056
v_mfma_f32_16x16x32_bf16 v[152:155], v[224:227], v[68:71], v[152:155]
v_exp_f32 v198, v174
s_waitcnt lgkmcnt(6)
v_mfma_f32_16x16x32_bf16 v[148:151], v[228:231], v[64:67], v[148:151]
ds_read_b64_tr_b16 v[224:225], v30 offset:40960
ds_read_b64_tr_b16 v[226:227], v30 offset:45056
v_mfma_f32_16x16x32_bf16 v[156:159], v[228:231], v[68:71], v[156:159]
v_exp_f32 v199, v175
v_cvt_pk_bf16_f32 v190, v196, v197
v_mfma_f32_16x16x32_bf16 v[144:147], v[232:235], v[72:75], v[144:147]
ds_read_b64_tr_b16 v[228:229], v31 offset:40960
ds_read_b64_tr_b16 v[230:231], v31 offset:45056
v_mfma_f32_16x16x32_bf16 v[152:155], v[232:235], v[76:79], v[152:155]
v_or3_b32 v201, v201, v189, v190
v_and_b32 v201, s55, v201
v_cvt_pk_bf16_f32 v191, v198, v199
v_mfma_f32_16x16x32_bf16 v[148:151], v[236:239], v[72:75], v[148:151]
ds_read_b64_tr_b16 v[232:233], v32 offset:40960
ds_read_b64_tr_b16 v[234:235], v32 offset:45056
v_and_or_b32 v201, v191, s55, v201
v_mfma_f32_16x16x32_bf16 v[156:159], v[236:239], v[76:79], v[156:159]
v_cmp_ne_u32 vcc, 0, v201
s_nop 0
s_cbranch_vccnz L_slow7
L_back7:
v_mfma_f32_16x16x32_bf16 v[80:83], v[208:211], v[184:187], v[80:83]
ds_read_b64_tr_b16 v[236:237], v33 offset:40960
ds_read_b64_tr_b16 v[238:239], v33 offset:45056
v_mfma_f32_16x16x32_bf16 v[84:87], v[208:211], v[188:191], v[84:87]
s_waitcnt lgkmcnt(6)
v_mfma_f32_16x16x32_bf16 v[88:91], v[212:215], v[184:187], v[88:91]
v_exp_f32 v192, v144
v_mfma_f32_16x16x32_bf16 v[92:95], v[212:215], v[188:191], v[92:95]
v_exp_f32 v193, v145
v_mfma_f32_16x16x32_bf16 v[96:99], v[216:219], v[184:187], v[96:99]
ds_read_b128 v[208:211], v22 offset:8192
v_exp_f32 v194, v146
v_mfma_f32_16x16x32_bf16 v[100:103], v[216:219], v[188:191], v[100:103]
v_exp_f32 v195, v147
v_mfma_f32_16x16x32_bf16 v[104:107], v[220:223], v[184:187], v[104:107]
ds_read_b128 v[212:215], v22 offset:12288
v_cvt_pk_bf16_f32 v176, v192, v193
v_mfma_f32_16x16x32_bf16 v[108:111], v[220:223], v[188:191], v[108:111]
v_exp_f32 v196, v148
v_mfma_f32_16x16x32_bf16 v[112:115], v[224:227], v[184:187], v[112:115]
ds_read_b128 v[216:219], v23 offset:8192
v_exp_f32 v197, v149
v_mfma_f32_16x16x32_bf16 v[116:119], v[224:227], v[188:191], v[116:119]
v_cvt_pk_bf16_f32 v177, v194, v195
s_waitcnt lgkmcnt(3)
v_mfma_f32_16x16x32_bf16 v[120:123], v[228:231], v[184:187], v[120:123]
ds_read_b128 v[220:223], v23 offset:12288
v_exp_f32 v198, v150
v_mfma_f32_16x16x32_bf16 v[124:127], v[228:231], v[188:191], v[124:127]
v_exp_f32 v199, v151
v_mfma_f32_16x16x32_bf16 v[128:131], v[232:235], v[184:187], v[128:131]
ds_read_b128 v[224:227], v24 offset:8192
v_cvt_pk_bf16_f32 v178, v196, v197
v_mfma_f32_16x16x32_bf16 v[132:135], v[232:235], v[188:191], v[132:135]
v_or3_b32 v200, v176, v177, v178
v_exp_f32 v192, v152
v_mfma_f32_16x16x32_bf16 v[136:139], v[236:239], v[184:187], v[136:139]
v_exp_f32 v193, v153
v_mfma_f32_16x16x32_bf16 v[140:143], v[236:239], v[188:191], v[140:143]
ds_read_b128 v[228:231], v24 offset:12288
v_cvt_pk_bf16_f32 v179, v198, v199
v_mfma_f32_16x16x32_bf16 v[204:207], v[4:7], v[184:187], v[204:207]
v_exp_f32 v194, v154
v_mfma_f32_16x16x32_bf16 v[252:255], v[4:7], v[188:191], v[252:255]
ds_read_b128 v[232:235], v25 offset:8192
s_waitcnt lgkmcnt(3)
v_mfma_f32_16x16x32_bf16 v[160:163], v[208:211], v[48:51], v[240:243]
ds_read_b128 v[236:239], v25 offset:12288
v_exp_f32 v195, v155
v_mfma_f32_16x16x32_bf16 v[168:171], v[208:211], v[52:55], v[244:247]
v_cvt_pk_bf16_f32 v180, v192, v193
v_or3_b32 v200, v200, v179, v180
v_mfma_f32_16x16x32_bf16 v[164:167], v[212:215], v[48:51], v[240:243]
v_mfma_f32_16x16x32_bf16 v[172:175], v[212:215], v[52:55], v[244:247]
s_barrier
v_add_u32 v26, 0x10000, v26
v_add_u32 v27, 0x10000, v27
v_add_u32 v28, 0x10000, v28
v_add_u32 v29, 0x10000, v29
v_add_u32 v30, 0x10000, v30
v_add_u32 v31, 0x10000, v31
v_add_u32 v32, 0x10000, v32
v_add_u32 v33, 0x10000, v33
ds_read_b64_tr_b16 v[208:209], v26 offset:0
ds_read_b64_tr_b16 v[210:211], v26 offset:4096
v_mfma_f32_16x16x32_bf16 v[160:163], v[216:219], v[56:59], v[160:163]
ds_read_b64_tr_b16 v[212:213], v27 offset:0
ds_read_b64_tr_b16 v[214:215], v27 offset:4096
v_mfma_f32_16x16x32_bf16 v[168:171], v[216:219], v[60:63], v[168:171]
v_exp_f32 v196, v156
v_mfma_f32_16x16x32_bf16 v[164:167], v[220:223], v[56:59], v[164:167]
ds_read_b64_tr_b16 v[216:217], v28 offset:0
ds_read_b64_tr_b16 v[218:219], v28 offset:4096
v_mfma_f32_16x16x32_bf16 v[172:175], v[220:223], v[60:63], v[172:175]
v_exp_f32 v197, v157
s_waitcnt lgkmcnt(6)
v_mfma_f32_16x16x32_bf16 v[160:163], v[224:227], v[64:67], v[160:163]
ds_read_b64_tr_b16 v[220:221], v29 offset:0
ds_read_b64_tr_b16 v[222:223], v29 offset:4096
v_mfma_f32_16x16x32_bf16 v[168:171], v[224:227], v[68:71], v[168:171]
v_cvt_pk_bf16_f32 v181, v194, v195
v_exp_f32 v198, v158
v_mfma_f32_16x16x32_bf16 v[164:167], v[228:231], v[64:67], v[164:167]
ds_read_b64_tr_b16 v[224:225], v30 offset:0
ds_read_b64_tr_b16 v[226:227], v30 offset:4096
v_mfma_f32_16x16x32_bf16 v[172:175], v[228:231], v[68:71], v[172:175]
v_exp_f32 v199, v159
v_cvt_pk_bf16_f32 v182, v196, v197
v_mfma_f32_16x16x32_bf16 v[160:163], v[232:235], v[72:75], v[160:163]
ds_read_b64_tr_b16 v[228:229], v31 offset:0
ds_read_b64_tr_b16 v[230:231], v31 offset:4096
v_mfma_f32_16x16x32_bf16 v[168:171], v[232:235], v[76:79], v[168:171]
v_or3_b32 v200, v200, v181, v182
v_and_b32 v200, s55, v200
v_cvt_pk_bf16_f32 v183, v198, v199
v_mfma_f32_16x16x32_bf16 v[164:167], v[236:239], v[72:75], v[164:167]
ds_read_b64_tr_b16 v[232:233], v32 offset:0
ds_read_b64_tr_b16 v[234:235], v32 offset:4096
v_and_or_b32 v200, v183, s55, v200
v_mfma_f32_16x16x32_bf16 v[172:175], v[236:239], v[76:79], v[172:175]
v_cmp_ne_u32 vcc, 0, v200
s_nop 0
s_cbranch_vccnz L_slow8
L_back8:
s_waitcnt lgkmcnt(6)
v_mfma_f32_16x16x32_bf16 v[80:83], v[208:211], v[176:179], v[80:83]
ds_read_b64_tr_b16 v[236:237], v33 offset:0
v_mfma_f32_16x16x32_bf16 v[84:87], v[208:211], v[180:183], v[84:87]
ds_read_b64_tr_b16 v[238:239], v33 offset:4096
v_mfma_f32_16x16x32_bf16 v[88:91], v[212:215], v[176:179], v[88:91]
v_exp_f32 v192, v160
v_mfma_f32_16x16x32_bf16 v[92:95], v[212:215], v[180:183], v[92:95]
v_exp_f32 v193, v161
v_mfma_f32_16x16x32_bf16 v[96:99], v[216:219], v[176:179], v[96:99]
v_exp_f32 v194, v162
v_mfma_f32_16x16x32_bf16 v[100:103], v[216:219], v[180:183], v[100:103]
s_barrier
ds_read_b128 v[208:211], v22 offset:32768
v_mfma_f32_16x16x32_bf16 v[104:107], v[220:223], v[176:179], v[104:107]
ds_read_b128 v[212:215], v22 offset:36864
v_exp_f32 v195, v163
v_mfma_f32_16x16x32_bf16 v[108:111], v[220:223], v[180:183], v[108:111]
v_cvt_pk_bf16_f32 v184, v192, v193
s_waitcnt lgkmcnt(2)
v_mfma_f32_16x16x32_bf16 v[112:115], v[224:227], v[176:179], v[112:115]
ds_read_b128 v[216:219], v23 offset:32768
v_exp_f32 v196, v164
v_mfma_f32_16x16x32_bf16 v[116:119], v[224:227], v[180:183], v[116:119]
v_exp_f32 v197, v165
v_mfma_f32_16x16x32_bf16 v[120:123], v[228:231], v[176:179], v[120:123]
ds_read_b128 v[220:223], v23 offset:36864
v_cvt_pk_bf16_f32 v185, v194, v195
v_mfma_f32_16x16x32_bf16 v[124:127], v[228:231], v[180:183], v[124:127]
v_exp_f32 v198, v166
v_mfma_f32_16x16x32_bf16 v[128:131], v[232:235], v[176:179], v[128:131]
ds_read_b128 v[224:227], v24 offset:32768
v_exp_f32 v199, v167
v_mfma_f32_16x16x32_bf16 v[132:135], v[232:235], v[180:183], v[132:135]
v_cvt_pk_bf16_f32 v186, v196, v197
v_or3_b32 v201, v184, v185, v186
v_mfma_f32_16x16x32_bf16 v[136:139], v[236:239], v[176:179], v[136:139]
v_exp_f32 v192, v168
v_mfma_f32_16x16x32_bf16 v[140:143], v[236:239], v[180:183], v[140:143]
ds_read_b128 v[228:231], v24 offset:36864
s_waitcnt lgkmcnt(3)
v_mfma_f32_16x16x32_bf16 v[204:207], v[4:7], v[176:179], v[204:207]
v_exp_f32 v193, v169
v_mfma_f32_16x16x32_bf16 v[252:255], v[4:7], v[180:183], v[252:255]
ds_read_b128 v[232:235], v25 offset:32768
v_cvt_pk_bf16_f32 v187, v198, v199
v_mfma_f32_16x16x32_bf16 v[144:147], v[208:211], v[48:51], v[240:243]
ds_read_b128 v[236:239], v25 offset:36864
v_exp_f32 v194, v170
v_mfma_f32_16x16x32_bf16 v[152:155], v[208:211], v[52:55], v[244:247]
v_exp_f32 v195, v171
v_mfma_f32_16x16x32_bf16 v[148:151], v[212:215], v[48:51], v[240:243]
ds_read_b64_tr_b16 v[208:209], v26 offset:8192
ds_read_b64_tr_b16 v[210:211], v26 offset:12288
v_mfma_f32_16x16x32_bf16 v[156:159], v[212:215], v[52:55], v[244:247]
v_cvt_pk_bf16_f32 v188, v192, v193
v_or3_b32 v201, v201, v187, v188
v_mfma_f32_16x16x32_bf16 v[144:147], v[216:219], v[56:59], v[144:147]
ds_read_b64_tr_b16 v[212:213], v27 offset:8192
ds_read_b64_tr_b16 v[214:215], v27 offset:12288
v_mfma_f32_16x16x32_bf16 v[152:155], v[216:219], v[60:63], v[152:155]
v_exp_f32 v196, v172
s_waitcnt lgkmcnt(5)
v_mfma_f32_16x16x32_bf16 v[148:151], v[220:223], v[56:59], v[148:151]
ds_read_b64_tr_b16 v[216:217], v28 offset:8192
ds_read_b64_tr_b16 v[218:219], v28 offset:12288
v_mfma_f32_16x16x32_bf16 v[156:159], v[220:223], v[60:63], v[156:159]
v_exp_f32 v197, v173
v_cvt_pk_bf16_f32 v189, v194, v195
v_mfma_f32_16x16x32_bf16 v[144:147], v[224:227], v[64:67], v[144:147]
ds_read_b64_tr_b16 v[220:221], v29 offset:8192
ds_read_b64_tr_b16 v[222:223], v29 offset:12288
v_mfma_f32_16x16x32_bf16 v[152:155], v[224:227], v[68:71], v[152:155]
v_exp_f32 v198, v174
v_mfma_f32_16x16x32_bf16 v[148:151], v[228:231], v[64:67], v[148:151]
ds_read_b64_tr_b16 v[224:225], v30 offset:8192
ds_read_b64_tr_b16 v[226:227], v30 offset:12288
v_mfma_f32_16x16x32_bf16 v[156:159], v[228:231], v[68:71], v[156:159]
v_exp_f32 v199, v175
v_cvt_pk_bf16_f32 v190, v196, v197
v_mfma_f32_16x16x32_bf16 v[144:147], v[232:235], v[72:75], v[144:147]
ds_read_b64_tr_b16 v[228:229], v31 offset:8192
ds_read_b64_tr_b16 v[230:231], v31 offset:12288
v_mfma_f32_16x16x32_bf16 v[152:155], v[232:235], v[76:79], v[152:155]
v_or3_b32 v201, v201, v189, v190
v_and_b32 v201, s55, v201
s_waitcnt lgkmcnt(6)
v_mfma_f32_16x16x32_bf16 v[148:151], v[236:239], v[72:75], v[148:151]
ds_read_b64_tr_b16 v[232:233], v32 offset:8192
ds_read_b64_tr_b16 v[234:235], v32 offset:12288
v_cvt_pk_bf16_f32 v191, v198, v199
v_mfma_f32_16x16x32_bf16 v[156:159], v[236:239], v[76:79], v[156:159]
v_and_or_b32 v201, v191, s55, v201
v_cmp_ne_u32 vcc, 0, v201
s_nop 0
s_cbranch_vccnz L_slow9
L_back9:
v_mfma_f32_16x16x32_bf16 v[80:83], v[208:211], v[184:187], v[80:83]
ds_read_b64_tr_b16 v[236:237], v33 offset:8192
v_mfma_f32_16x16x32_bf16 v[84:87], v[208:211], v[188:191], v[84:87]
ds_read_b64_tr_b16 v[238:239], v33 offset:12288
v_mfma_f32_16x16x32_bf16 v[88:91], v[212:215], v[184:187], v[88:91]
v_exp_f32 v192, v144
v_mfma_f32_16x16x32_bf16 v[92:95], v[212:215], v[188:191], v[92:95]
v_exp_f32 v193, v145
v_mfma_f32_16x16x32_bf16 v[96:99], v[216:219], v[184:187], v[96:99]
v_exp_f32 v194, v146
v_mfma_f32_16x16x32_bf16 v[100:103], v[216:219], v[188:191], v[100:103]
ds_read_b128 v[208:211], v22 offset:40960
s_waitcnt lgkmcnt(3)
v_mfma_f32_16x16x32_bf16 v[104:107], v[220:223], v[184:187], v[104:107]
v_exp_f32 v195, v147
v_mfma_f32_16x16x32_bf16 v[108:111], v[220:223], v[188:191], v[108:111]
ds_read_b128 v[212:215], v22 offset:45056
v_cvt_pk_bf16_f32 v176, v192, v193
v_mfma_f32_16x16x32_bf16 v[112:115], v[224:227], v[184:187], v[112:115]
ds_read_b128 v[216:219], v23 offset:40960
v_exp_f32 v196, v148
v_mfma_f32_16x16x32_bf16 v[116:119], v[224:227], v[188:191], v[116:119]
v_exp_f32 v197, v149
v_mfma_f32_16x16x32_bf16 v[120:123], v[228:231], v[184:187], v[120:123]
ds_read_b128 v[220:223], v23 offset:45056
v_cvt_pk_bf16_f32 v177, v194, v195
v_mfma_f32_16x16x32_bf16 v[124:127], v[228:231], v[188:191], v[124:127]
v_exp_f32 v198, v150
v_mfma_f32_16x16x32_bf16 v[128:131], v[232:235], v[184:187], v[128:131]
ds_read_b128 v[224:227], v24 offset:40960
v_exp_f32 v199, v151
v_mfma_f32_16x16x32_bf16 v[132:135], v[232:235], v[188:191], v[132:135]
v_cvt_pk_bf16_f32 v178, v196, v197
s_waitcnt lgkmcnt(3)
v_mfma_f32_16x16x32_bf16 v[136:139], v[236:239], v[184:187], v[136:139]
ds_read_b128 v[228:231], v24 offset:45056
v_or3_b32 v200, v176, v177, v178
v_mfma_f32_16x16x32_bf16 v[140:143], v[236:239], v[188:191], v[140:143]
v_exp_f32 v192, v152
v_mfma_f32_16x16x32_bf16 v[204:207], v[4:7], v[184:187], v[204:207]
v_exp_f32 v193, v153
v_mfma_f32_16x16x32_bf16 v[252:255], v[4:7], v[188:191], v[252:255]
ds_read_b128 v[232:235], v25 offset:40960
v_cvt_pk_bf16_f32 v179, v198, v199
v_mfma_f32_16x16x32_bf16 v[160:163], v[208:211], v[48:51], v[240:243]
ds_read_b128 v[236:239], v25 offset:45056
v_exp_f32 v194, v154
v_mfma_f32_16x16x32_bf16 v[168:171], v[208:211], v[52:55], v[244:247]
v_exp_f32 v195, v155
v_mfma_f32_16x16x32_bf16 v[164:167], v[212:215], v[48:51], v[240:243]
v_cvt_pk_bf16_f32 v180, v192, v193
v_mfma_f32_16x16x32_bf16 v[172:175], v[212:215], v[52:55], v[244:247]
s_barrier
ds_read_b64_tr_b16 v[208:209], v26 offset:32768
ds_read_b64_tr_b16 v[210:211], v26 offset:36864
s_waitcnt lgkmcnt(4)
v_mfma_f32_16x16x32_bf16 v[160:163], v[216:219], v[56:59], v[160:163]
ds_read_b64_tr_b16 v[212:213], v27 offset:32768
ds_read_b64_tr_b16 v[214:215], v27 offset:36864
v_mfma_f32_16x16x32_bf16 v[168:171], v[216:219], v[60:63], v[168:171]
v_or3_b32 v200, v200, v179, v180
v_exp_f32 v196, v156
v_mfma_f32_16x16x32_bf16 v[164:167], v[220:223], v[56:59], v[164:167]
ds_read_b64_tr_b16 v[216:217], v28 offset:32768
ds_read_b64_tr_b16 v[218:219], v28 offset:36864
v_mfma_f32_16x16x32_bf16 v[172:175], v[220:223], v[60:63], v[172:175]
v_exp_f32 v197, v157
v_cvt_pk_bf16_f32 v181, v194, v195
v_mfma_f32_16x16x32_bf16 v[160:163], v[224:227], v[64:67], v[160:163]
ds_read_b64_tr_b16 v[220:221], v29 offset:32768
ds_read_b64_tr_b16 v[222:223], v29 offset:36864
v_mfma_f32_16x16x32_bf16 v[168:171], v[224:227], v[68:71], v[168:171]
v_exp_f32 v198, v158
v_mfma_f32_16x16x32_bf16 v[164:167], v[228:231], v[64:67], v[164:167]
ds_read_b64_tr_b16 v[224:225], v30 offset:32768
ds_read_b64_tr_b16 v[226:227], v30 offset:36864
v_mfma_f32_16x16x32_bf16 v[172:175], v[228:231], v[68:71], v[172:175]
v_exp_f32 v199, v159
s_waitcnt lgkmcnt(6)
v_mfma_f32_16x16x32_bf16 v[160:163], v[232:235], v[72:75], v[160:163]
ds_read_b64_tr_b16 v[228:229], v31 offset:32768
ds_read_b64_tr_b16 v[230:231], v31 offset:36864
v_mfma_f32_16x16x32_bf16 v[168:171], v[232:235], v[76:79], v[168:171]
v_cvt_pk_bf16_f32 v182, v196, v197
v_or3_b32 v200, v200, v181, v182
v_and_b32 v200, s55, v200
v_mfma_f32_16x16x32_bf16 v[164:167], v[236:239], v[72:75], v[164:167]
ds_read_b64_tr_b16 v[232:233], v32 offset:32768
ds_read_b64_tr_b16 v[234:235], v32 offset:36864
v_cvt_pk_bf16_f32 v183, v198, v199
v_mfma_f32_16x16x32_bf16 v[172:175], v[236:239], v[76:79], v[172:175]
v_and_or_b32 v200, v183, s55, v200
v_cmp_ne_u32 vcc, 0, v200
s_nop 0
s_cbranch_vccnz L_slow10
L_back10:
v_mfma_f32_16x16x32_bf16 v[80:83], v[208:211], v[176:179], v[80:83]
ds_read_b64_tr_b16 v[236:237], v33 offset:32768
v_mfma_f32_16x16x32_bf16 v[84:87], v[208:211], v[180:183], v[84:87]
ds_read_b64_tr_b16 v[238:239], v33 offset:36864
v_mfma_f32_16x16x32_bf16 v[88:91], v[212:215], v[176:179], v[88:91]
v_exp_f32 v192, v160
v_mfma_f32_16x16x32_bf16 v[92:95], v[212:215], v[180:183], v[92:95]
v_exp_f32 v193, v161
s_waitcnt lgkmcnt(4)
v_mfma_f32_16x16x32_bf16 v[96:99], v[216:219], v[176:179], v[96:99]
v_mfma_f32_16x16x32_bf16 v[100:103], v[216:219], v[180:183], v[100:103]
s_barrier
v_add_u32 v22, 0x10000, v22
v_add_u32 v23, 0x10000, v23
v_add_u32 v24, 0x10000, v24
v_add_u32 v25, 0x10000, v25
ds_read_b128 v[208:211], v22 offset:0
v_mfma_f32_16x16x32_bf16 v[104:107], v[220:223], v[176:179], v[104:107]
ds_read_b128 v[212:215], v22 offset:4096
v_exp_f32 v194, v162
v_mfma_f32_16x16x32_bf16 v[108:111], v[220:223], v[180:183], v[108:111]
v_exp_f32 v195, v163
v_mfma_f32_16x16x32_bf16 v[112:115], v[224:227], v[176:179], v[112:115]
ds_read_b128 v[216:219], v23 offset:0
v_cvt_pk_bf16_f32 v184, v192, v193
v_mfma_f32_16x16x32_bf16 v[116:119], v[224:227], v[180:183], v[116:119]
v_exp_f32 v196, v164
v_mfma_f32_16x16x32_bf16 v[120:123], v[228:231], v[176:179], v[120:123]
ds_read_b128 v[220:223], v23 offset:4096
v_exp_f32 v197, v165
v_mfma_f32_16x16x32_bf16 v[124:127], v[228:231], v[180:183], v[124:127]
v_cvt_pk_bf16_f32 v185, v194, v195
s_waitcnt lgkmcnt(3)
v_mfma_f32_16x16x32_bf16 v[128:131], v[232:235], v[176:179], v[128:131]
ds_read_b128 v[224:227], v24 offset:0
v_exp_f32 v198, v166
v_mfma_f32_16x16x32_bf16 v[132:135], v[232:235], v[180:183], v[132:135]
v_exp_f32 v199, v167
v_mfma_f32_16x16x32_bf16 v[136:139], v[236:239], v[176:179], v[136:139]
ds_read_b128 v[228:231], v24 offset:4096
v_cvt_pk_bf16_f32 v186, v196, v197
v_mfma_f32_16x16x32_bf16 v[140:143], v[236:239], v[180:183], v[140:143]
v_or3_b32 v201, v184, v185, v186
v_exp_f32 v192, v168
v_mfma_f32_16x16x32_bf16 v[204:207], v[4:7], v[176:179], v[204:207]
v_exp_f32 v193, v169
v_mfma_f32_16x16x32_bf16 v[252:255], v[4:7], v[180:183], v[252:255]
ds_read_b128 v[232:235], v25 offset:0
v_cvt_pk_bf16_f32 v187, v198, v199
v_mfma_f32_16x16x32_bf16 v[144:147], v[208:211], v[48:51], v[240:243]
v_exp_f32 v194, v170
v_mfma_f32_16x16x32_bf16 v[152:155], v[208:211], v[52:55], v[244:247]
ds_read_b128 v[236:239], v25 offset:4096
s_waitcnt lgkmcnt(3)
v_mfma_f32_16x16x32_bf16 v[148:151], v[212:215], v[48:51], v[240:243]
ds_read_b64_tr_b16 v[208:209], v26 offset:40960
ds_read_b64_tr_b16 v[210:211], v26 offset:45056
v_mfma_f32_16x16x32_bf16 v[156:159], v[212:215], v[52:55], v[244:247]
v_exp_f32 v195, v171
v_cvt_pk_bf16_f32 v188, v192, v193
v_mfma_f32_16x16x32_bf16 v[144:147], v[216:219], v[56:59], v[144:147]
ds_read_b64_tr_b16 v[212:213], v27 offset:40960
ds_read_b64_tr_b16 v[214:215], v27 offset:45056
v_mfma_f32_16x16x32_bf16 v[152:155], v[216:219], v[60:63], v[152:155]
v_or3_b32 v201, v201, v187, v188
v_exp_f32 v196, v172
v_mfma_f32_16x16x32_bf16 v[148:151], v[220:223], v[56:59], v[148:151]
ds_read_b64_tr_b16 v[216:217], v28 offset:40960
ds_read_b64_tr_b16 v[218:219], v28 offset:45056
v_mfma_f32_16x16x32_bf16 v[156:159], v[220:223], v[60:63], v[156:159]
v_exp_f32 v197, v173
v_cvt_pk_bf16_f32 v189, v194, v195
v_mfma_f32_16x16x32_bf16 v[144:147], v[224:227], v[64:67], v[144:147]
ds_read_b64_tr_b16 v[220:221], v29 offset:40960
ds_read_b64_tr_b16 v[222:223], v29 offset:45056
v_mfma_f32_16x16x32_bf16 v[152:155], v[224:227], v[68:71], v[152:155]
v_exp_f32 v198, v174
s_waitcnt lgkmcnt(6)
v_mfma_f32_16x16x32_bf16 v[148:151], v[228:231], v[64:67], v[148:151]
ds_read_b64_tr_b16 v[224:225], v30 offset:40960
ds_read_b64_tr_b16 v[226:227], v30 offset:45056
v_mfma_f32_16x16x32_bf16 v[156:159], v[228:231], v[68:71], v[156:159]
v_exp_f32 v199, v175
v_cvt_pk_bf16_f32 v190, v196, v197
v_mfma_f32_16x16x32_bf16 v[144:147], v[232:235], v[72:75], v[144:147]
ds_read_b64_tr_b16 v[228:229], v31 offset:40960
ds_read_b64_tr_b16 v[230:231], v31 offset:45056
v_mfma_f32_16x16x32_bf16 v[152:155], v[232:235], v[76:79], v[152:155]
v_or3_b32 v201, v201, v189, v190
v_and_b32 v201, s55, v201
v_cvt_pk_bf16_f32 v191, v198, v199
v_mfma_f32_16x16x32_bf16 v[148:151], v[236:239], v[72:75], v[148:151]
ds_read_b64_tr_b16 v[232:233], v32 offset:40960
ds_read_b64_tr_b16 v[234:235], v32 offset:45056
v_and_or_b32 v201, v191, s55, v201
v_mfma_f32_16x16x32_bf16 v[156:159], v[236:239], v[76:79], v[156:159]
v_cmp_ne_u32 vcc, 0, v201
s_nop 0
s_cbranch_vccnz L_slow11
L_back11:
v_mfma_f32_16x16x32_bf16 v[80:83], v[208:211], v[184:187], v[80:83]
ds_read_b64_tr_b16 v[236:237], v33 offset:40960
ds_read_b64_tr_b16 v[238:239], v33 offset:45056
v_mfma_f32_16x16x32_bf16 v[84:87], v[208:211], v[188:191], v[84:87]
s_waitcnt lgkmcnt(6)
v_mfma_f32_16x16x32_bf16 v[88:91], v[212:215], v[184:187], v[88:91]
v_exp_f32 v192, v144
v_mfma_f32_16x16x32_bf16 v[92:95], v[212:215], v[188:191], v[92:95]
v_exp_f32 v193, v145
v_mfma_f32_16x16x32_bf16 v[96:99], v[216:219], v[184:187], v[96:99]
ds_read_b128 v[208:211], v22 offset:8192
v_exp_f32 v194, v146
v_mfma_f32_16x16x32_bf16 v[100:103], v[216:219], v[188:191], v[100:103]
v_exp_f32 v195, v147
v_mfma_f32_16x16x32_bf16 v[104:107], v[220:223], v[184:187], v[104:107]
ds_read_b128 v[212:215], v22 offset:12288
v_cvt_pk_bf16_f32 v176, v192, v193
v_mfma_f32_16x16x32_bf16 v[108:111], v[220:223], v[188:191], v[108:111]
v_exp_f32 v196, v148
v_mfma_f32_16x16x32_bf16 v[112:115], v[224:227], v[184:187], v[112:115]
ds_read_b128 v[216:219], v23 offset:8192
v_exp_f32 v197, v149
v_mfma_f32_16x16x32_bf16 v[116:119], v[224:227], v[188:191], v[116:119]
v_cvt_pk_bf16_f32 v177, v194, v195
s_waitcnt lgkmcnt(3)
v_mfma_f32_16x16x32_bf16 v[120:123], v[228:231], v[184:187], v[120:123]
ds_read_b128 v[220:223], v23 offset:12288
v_exp_f32 v198, v150
v_mfma_f32_16x16x32_bf16 v[124:127], v[228:231], v[188:191], v[124:127]
v_exp_f32 v199, v151
v_mfma_f32_16x16x32_bf16 v[128:131], v[232:235], v[184:187], v[128:131]
ds_read_b128 v[224:227], v24 offset:8192
v_cvt_pk_bf16_f32 v178, v196, v197
v_mfma_f32_16x16x32_bf16 v[132:135], v[232:235], v[188:191], v[132:135]
v_or3_b32 v200, v176, v177, v178
v_exp_f32 v192, v152
v_mfma_f32_16x16x32_bf16 v[136:139], v[236:239], v[184:187], v[136:139]
v_exp_f32 v193, v153
v_mfma_f32_16x16x32_bf16 v[140:143], v[236:239], v[188:191], v[140:143]
ds_read_b128 v[228:231], v24 offset:12288
v_cvt_pk_bf16_f32 v179, v198, v199
v_mfma_f32_16x16x32_bf16 v[204:207], v[4:7], v[184:187], v[204:207]
v_exp_f32 v194, v154
v_mfma_f32_16x16x32_bf16 v[252:255], v[4:7], v[188:191], v[252:255]
ds_read_b128 v[232:235], v25 offset:8192
s_waitcnt lgkmcnt(3)
v_mfma_f32_16x16x32_bf16 v[160:163], v[208:211], v[48:51], v[240:243]
ds_read_b128 v[236:239], v25 offset:12288
v_exp_f32 v195, v155
v_mfma_f32_16x16x32_bf16 v[168:171], v[208:211], v[52:55], v[244:247]
v_cvt_pk_bf16_f32 v180, v192, v193
v_or3_b32 v200, v200, v179, v180
v_mfma_f32_16x16x32_bf16 v[164:167], v[212:215], v[48:51], v[240:243]
v_mfma_f32_16x16x32_bf16 v[172:175], v[212:215], v[52:55], v[244:247]
s_barrier
v_add_u32 v26, 0x10000, v26
v_add_u32 v27, 0x10000, v27
v_add_u32 v28, 0x10000, v28
v_add_u32 v29, 0x10000, v29
v_add_u32 v30, 0x10000, v30
v_add_u32 v31, 0x10000, v31
v_add_u32 v32, 0x10000, v32
v_add_u32 v33, 0x10000, v33
ds_read_b64_tr_b16 v[208:209], v26 offset:0
ds_read_b64_tr_b16 v[210:211], v26 offset:4096
v_mfma_f32_16x16x32_bf16 v[160:163], v[216:219], v[56:59], v[160:163]
ds_read_b64_tr_b16 v[212:213], v27 offset:0
ds_read_b64_tr_b16 v[214:215], v27 offset:4096
v_mfma_f32_16x16x32_bf16 v[168:171], v[216:219], v[60:63], v[168:171]
v_exp_f32 v196, v156
v_mfma_f32_16x16x32_bf16 v[164:167], v[220:223], v[56:59], v[164:167]
ds_read_b64_tr_b16 v[216:217], v28 offset:0
ds_read_b64_tr_b16 v[218:219], v28 offset:4096
v_mfma_f32_16x16x32_bf16 v[172:175], v[220:223], v[60:63], v[172:175]
v_exp_f32 v197, v157
s_waitcnt lgkmcnt(6)
v_mfma_f32_16x16x32_bf16 v[160:163], v[224:227], v[64:67], v[160:163]
ds_read_b64_tr_b16 v[220:221], v29 offset:0
ds_read_b64_tr_b16 v[222:223], v29 offset:4096
v_mfma_f32_16x16x32_bf16 v[168:171], v[224:227], v[68:71], v[168:171]
v_cvt_pk_bf16_f32 v181, v194, v195
v_exp_f32 v198, v158
v_mfma_f32_16x16x32_bf16 v[164:167], v[228:231], v[64:67], v[164:167]
ds_read_b64_tr_b16 v[224:225], v30 offset:0
ds_read_b64_tr_b16 v[226:227], v30 offset:4096
v_mfma_f32_16x16x32_bf16 v[172:175], v[228:231], v[68:71], v[172:175]
v_exp_f32 v199, v159
v_cvt_pk_bf16_f32 v182, v196, v197
v_mfma_f32_16x16x32_bf16 v[160:163], v[232:235], v[72:75], v[160:163]
ds_read_b64_tr_b16 v[228:229], v31 offset:0
ds_read_b64_tr_b16 v[230:231], v31 offset:4096
v_mfma_f32_16x16x32_bf16 v[168:171], v[232:235], v[76:79], v[168:171]
v_or3_b32 v200, v200, v181, v182
v_and_b32 v200, s55, v200
v_cvt_pk_bf16_f32 v183, v198, v199
v_mfma_f32_16x16x32_bf16 v[164:167], v[236:239], v[72:75], v[164:167]
ds_read_b64_tr_b16 v[232:233], v32 offset:0
ds_read_b64_tr_b16 v[234:235], v32 offset:4096
v_and_or_b32 v200, v183, s55, v200
v_mfma_f32_16x16x32_bf16 v[172:175], v[236:239], v[76:79], v[172:175]
v_cmp_ne_u32 vcc, 0, v200
s_nop 0
s_cbranch_vccnz L_slow12
L_back12:
s_waitcnt lgkmcnt(6)
v_mfma_f32_16x16x32_bf16 v[80:83], v[208:211], v[176:179], v[80:83]
ds_read_b64_tr_b16 v[236:237], v33 offset:0
v_mfma_f32_16x16x32_bf16 v[84:87], v[208:211], v[180:183], v[84:87]
ds_read_b64_tr_b16 v[238:239], v33 offset:4096
v_mfma_f32_16x16x32_bf16 v[88:91], v[212:215], v[176:179], v[88:91]
v_exp_f32 v192, v160
v_mfma_f32_16x16x32_bf16 v[92:95], v[212:215], v[180:183], v[92:95]
v_exp_f32 v193, v161
v_mfma_f32_16x16x32_bf16 v[96:99], v[216:219], v[176:179], v[96:99]
v_mfma_f32_16x16x32_bf16 v[100:103], v[216:219], v[180:183], v[100:103]
s_barrier
v_add_u32 v22, 0xfffe0000, v22
v_add_u32 v23, 0xfffe0000, v23
v_add_u32 v24, 0xfffe0000, v24
v_add_u32 v25, 0xfffe0000, v25
ds_read_b128 v[208:211], v22 offset:0
v_mfma_f32_16x16x32_bf16 v[104:107], v[220:223], v[176:179], v[104:107]
v_exp_f32 v194, v162
v_mfma_f32_16x16x32_bf16 v[108:111], v[220:223], v[180:183], v[108:111]
ds_read_b128 v[212:215], v22 offset:4096
s_waitcnt lgkmcnt(2)
v_mfma_f32_16x16x32_bf16 v[112:115], v[224:227], v[176:179], v[112:115]
v_exp_f32 v195, v163
v_mfma_f32_16x16x32_bf16 v[116:119], v[224:227], v[180:183], v[116:119]
ds_read_b128 v[216:219], v23 offset:0
v_cvt_pk_bf16_f32 v184, v192, v193
v_mfma_f32_16x16x32_bf16 v[120:123], v[228:231], v[176:179], v[120:123]
ds_read_b128 v[220:223], v23 offset:4096
v_exp_f32 v196, v164
v_mfma_f32_16x16x32_bf16 v[124:127], v[228:231], v[180:183], v[124:127]
v_exp_f32 v197, v165
v_mfma_f32_16x16x32_bf16 v[128:131], v[232:235], v[176:179], v[128:131]
ds_read_b128 v[224:227], v24 offset:0
v_cvt_pk_bf16_f32 v185, v194, v195
v_mfma_f32_16x16x32_bf16 v[132:135], v[232:235], v[180:183], v[132:135]
v_exp_f32 v198, v166
v_mfma_f32_16x16x32_bf16 v[136:139], v[236:239], v[176:179], v[136:139]
ds_read_b128 v[228:231], v24 offset:4096
v_exp_f32 v199, v167
v_mfma_f32_16x16x32_bf16 v[140:143], v[236:239], v[180:183], v[140:143]
v_cvt_pk_bf16_f32 v186, v196, v197
s_waitcnt lgkmcnt(3)
v_mfma_f32_16x16x32_bf16 v[204:207], v[4:7], v[176:179], v[204:207]
ds_read_b128 v[232:235], v25 offset:0
v_or3_b32 v201, v184, v185, v186
v_mfma_f32_16x16x32_bf16 v[252:255], v[4:7], v[180:183], v[252:255]
v_exp_f32 v192, v168
v_mfma_f32_16x16x32_bf16 v[144:147], v[208:211], v[48:51], v[240:243]
v_exp_f32 v193, v169
v_mfma_f32_16x16x32_bf16 v[152:155], v[208:211], v[52:55], v[244:247]
ds_read_b128 v[236:239], v25 offset:4096
v_cvt_pk_bf16_f32 v187, v198, v199
v_mfma_f32_16x16x32_bf16 v[148:151], v[212:215], v[48:51], v[240:243]
ds_read_b64_tr_b16 v[208:209], v26 offset:8192
ds_read_b64_tr_b16 v[210:211], v26 offset:12288
v_mfma_f32_16x16x32_bf16 v[156:159], v[212:215], v[52:55], v[244:247]
v_exp_f32 v194, v170
v_mfma_f32_16x16x32_bf16 v[144:147], v[216:219], v[56:59], v[144:147]
ds_read_b64_tr_b16 v[212:213], v27 offset:8192
ds_read_b64_tr_b16 v[214:215], v27 offset:12288
v_mfma_f32_16x16x32_bf16 v[152:155], v[216:219], v[60:63], v[152:155]
v_exp_f32 v195, v171
s_waitcnt lgkmcnt(5)
v_mfma_f32_16x16x32_bf16 v[148:151], v[220:223], v[56:59], v[148:151]
ds_read_b64_tr_b16 v[216:217], v28 offset:8192
ds_read_b64_tr_b16 v[218:219], v28 offset:12288
v_mfma_f32_16x16x32_bf16 v[156:159], v[220:223], v[60:63], v[156:159]
v_cvt_pk_bf16_f32 v188, v192, v193
v_or3_b32 v201, v201, v187, v188
v_mfma_f32_16x16x32_bf16 v[144:147], v[224:227], v[64:67], v[144:147]
ds_read_b64_tr_b16 v[220:221], v29 offset:8192
ds_read_b64_tr_b16 v[222:223], v29 offset:12288
v_mfma_f32_16x16x32_bf16 v[152:155], v[224:227], v[68:71], v[152:155]
v_exp_f32 v196, v172
v_mfma_f32_16x16x32_bf16 v[148:151], v[228:231], v[64:67], v[148:151]
ds_read_b64_tr_b16 v[224:225], v30 offset:8192
ds_read_b64_tr_b16 v[226:227], v30 offset:12288
v_mfma_f32_16x16x32_bf16 v[156:159], v[228:231], v[68:71], v[156:159]
v_exp_f32 v197, v173
v_cvt_pk_bf16_f32 v189, v194, v195
v_mfma_f32_16x16x32_bf16 v[144:147], v[232:235], v[72:75], v[144:147]
ds_read_b64_tr_b16 v[228:229], v31 offset:8192
ds_read_b64_tr_b16 v[230:231], v31 offset:12288
v_mfma_f32_16x16x32_bf16 v[152:155], v[232:235], v[76:79], v[152:155]
v_exp_f32 v198, v174
s_waitcnt lgkmcnt(6)
v_mfma_f32_16x16x32_bf16 v[148:151], v[236:239], v[72:75], v[148:151]
ds_read_b64_tr_b16 v[232:233], v32 offset:8192
ds_read_b64_tr_b16 v[234:235], v32 offset:12288
v_exp_f32 v199, v175
v_cvt_pk_bf16_f32 v190, v196, v197
v_or3_b32 v201, v201, v189, v190
v_mfma_f32_16x16x32_bf16 v[156:159], v[236:239], v[76:79], v[156:159]
v_and_b32 v201, s55, v201
v_cvt_pk_bf16_f32 v191, v198, v199
v_and_or_b32 v201, v191, s55, v201
v_cmp_ne_u32 vcc, 0, v201
s_nop 0
s_cbranch_vccnz L_slow13
L_back13:
v_mfma_f32_16x16x32_bf16 v[80:83], v[208:211], v[184:187], v[80:83]
ds_read_b64_tr_b16 v[236:237], v33 offset:8192
v_mfma_f32_16x16x32_bf16 v[84:87], v[208:211], v[188:191], v[84:87]
ds_read_b64_tr_b16 v[238:239], v33 offset:12288
v_mfma_f32_16x16x32_bf16 v[88:91], v[212:215], v[184:187], v[88:91]
v_exp_f32 v192, v144
v_mfma_f32_16x16x32_bf16 v[92:95], v[212:215], v[188:191], v[92:95]
v_exp_f32 v193, v145
v_mfma_f32_16x16x32_bf16 v[96:99], v[216:219], v[184:187], v[96:99]
v_exp_f32 v194, v146
v_mfma_f32_16x16x32_bf16 v[100:103], v[216:219], v[188:191], v[100:103]
ds_read_b128 v[208:211], v22 offset:8192
s_waitcnt lgkmcnt(3)
v_mfma_f32_16x16x32_bf16 v[104:107], v[220:223], v[184:187], v[104:107]
v_exp_f32 v195, v147
v_mfma_f32_16x16x32_bf16 v[108:111], v[220:223], v[188:191], v[108:111]
ds_read_b128 v[212:215], v22 offset:12288
v_cvt_pk_bf16_f32 v176, v192, v193
v_mfma_f32_16x16x32_bf16 v[112:115], v[224:227], v[184:187], v[112:115]
ds_read_b128 v[216:219], v23 offset:8192
v_exp_f32 v196, v148
v_mfma_f32_16x16x32_bf16 v[116:119], v[224:227], v[188:191], v[116:119]
v_exp_f32 v197, v149
v_mfma_f32_16x16x32_bf16 v[120:123], v[228:231], v[184:187], v[120:123]
ds_read_b128 v[220:223], v23 offset:12288
v_cvt_pk_bf16_f32 v177, v194, v195
v_mfma_f32_16x16x32_bf16 v[124:127], v[228:231], v[188:191], v[124:127]
v_exp_f32 v198, v150
v_mfma_f32_16x16x32_bf16 v[128:131], v[232:235], v[184:187], v[128:131]
ds_read_b128 v[224:227], v24 offset:8192
v_exp_f32 v199, v151
v_mfma_f32_16x16x32_bf16 v[132:135], v[232:235], v[188:191], v[132:135]
v_cvt_pk_bf16_f32 v178, v196, v197
s_waitcnt lgkmcnt(3)
v_mfma_f32_16x16x32_bf16 v[136:139], v[236:239], v[184:187], v[136:139]
ds_read_b128 v[228:231], v24 offset:12288
v_or3_b32 v200, v176, v177, v178
v_mfma_f32_16x16x32_bf16 v[140:143], v[236:239], v[188:191], v[140:143]
v_exp_f32 v192, v152
v_mfma_f32_16x16x32_bf16 v[204:207], v[4:7], v[184:187], v[204:207]
v_exp_f32 v193, v153
v_mfma_f32_16x16x32_bf16 v[252:255], v[4:7], v[188:191], v[252:255]
ds_read_b128 v[232:235], v25 offset:8192
v_cvt_pk_bf16_f32 v179, v198, v199
v_mfma_f32_16x16x32_bf16 v[160:163], v[208:211], v[48:51], v[240:243]
ds_read_b128 v[236:239], v25 offset:12288
v_exp_f32 v194, v154
v_mfma_f32_16x16x32_bf16 v[168:171], v[208:211], v[52:55], v[244:247]
v_exp_f32 v195, v155
v_mfma_f32_16x16x32_bf16 v[164:167], v[212:215], v[48:51], v[240:243]
v_mfma_f32_16x16x32_bf16 v[172:175], v[212:215], v[52:55], v[244:247]
s_barrier
v_add_u32 v26, 0xfffe0000, v26
v_add_u32 v27, 0xfffe0000, v27
v_add_u32 v28, 0xfffe0000, v28
v_add_u32 v29, 0xfffe0000, v29
v_add_u32 v30, 0xfffe0000, v30
v_add_u32 v31, 0xfffe0000, v31
v_add_u32 v32, 0xfffe0000, v32
v_add_u32 v33, 0xfffe0000, v33
ds_read_b64_tr_b16 v[208:209], v26 offset:0
ds_read_b64_tr_b16 v[210:211], v26 offset:4096
s_waitcnt lgkmcnt(4)
v_mfma_f32_16x16x32_bf16 v[160:163], v[216:219], v[56:59], v[160:163]
ds_read_b64_tr_b16 v[212:213], v27 offset:0
ds_read_b64_tr_b16 v[214:215], v27 offset:4096
v_mfma_f32_16x16x32_bf16 v[168:171], v[216:219], v[60:63], v[168:171]
v_cvt_pk_bf16_f32 v180, v192, v193
v_or3_b32 v200, v200, v179, v180
v_mfma_f32_16x16x32_bf16 v[164:167], v[220:223], v[56:59], v[164:167]
ds_read_b64_tr_b16 v[216:217], v28 offset:0
ds_read_b64_tr_b16 v[218:219], v28 offset:4096
v_mfma_f32_16x16x32_bf16 v[172:175], v[220:223], v[60:63], v[172:175]
v_exp_f32 v196, v156
v_mfma_f32_16x16x32_bf16 v[160:163], v[224:227], v[64:67], v[160:163]
ds_read_b64_tr_b16 v[220:221], v29 offset:0
ds_read_b64_tr_b16 v[222:223], v29 offset:4096
v_mfma_f32_16x16x32_bf16 v[168:171], v[224:227], v[68:71], v[168:171]
v_exp_f32 v197, v157
v_cvt_pk_bf16_f32 v181, v194, v195
v_mfma_f32_16x16x32_bf16 v[164:167], v[228:231], v[64:67], v[164:167]
ds_read_b64_tr_b16 v[224:225], v30 offset:0
ds_read_b64_tr_b16 v[226:227], v30 offset:4096
v_mfma_f32_16x16x32_bf16 v[172:175], v[228:231], v[68:71], v[172:175]
v_exp_f32 v198, v158
s_waitcnt lgkmcnt(6)
v_mfma_f32_16x16x32_bf16 v[160:163], v[232:235], v[72:75], v[160:163]
ds_read_b64_tr_b16 v[228:229], v31 offset:0
ds_read_b64_tr_b16 v[230:231], v31 offset:4096
v_mfma_f32_16x16x32_bf16 v[168:171], v[232:235], v[76:79], v[168:171]
v_exp_f32 v199, v159
v_cvt_pk_bf16_f32 v182, v196, v197
v_mfma_f32_16x16x32_bf16 v[164:167], v[236:239], v[72:75], v[164:167]
ds_read_b64_tr_b16 v[232:233], v32 offset:0
ds_read_b64_tr_b16 v[234:235], v32 offset:4096
v_or3_b32 v200, v200, v181, v182
v_and_b32 v200, s55, v200
v_mfma_f32_16x16x32_bf16 v[172:175], v[236:239], v[76:79], v[172:175]
v_cvt_pk_bf16_f32 v183, v198, v199
v_and_or_b32 v200, v183, s55, v200
v_cmp_ne_u32 vcc, 0, v200
s_nop 0
s_cbranch_vccnz L_slow14
L_back14:
v_mfma_f32_16x16x32_bf16 v[80:83], v[208:211], v[176:179], v[80:83]
ds_read_b64_tr_b16 v[236:237], v33 offset:0
v_mfma_f32_16x16x32_bf16 v[84:87], v[208:211], v[180:183], v[84:87]
ds_read_b64_tr_b16 v[238:239], v33 offset:4096
v_mfma_f32_16x16x32_bf16 v[88:91], v[212:215], v[176:179], v[88:91]
v_exp_f32 v192, v160
v_mfma_f32_16x16x32_bf16 v[92:95], v[212:215], v[180:183], v[92:95]
v_exp_f32 v193, v161
s_waitcnt lgkmcnt(4)
v_mfma_f32_16x16x32_bf16 v[96:99], v[216:219], v[176:179], v[96:99]
v_exp_f32 v194, v162
v_mfma_f32_16x16x32_bf16 v[100:103], v[216:219], v[180:183], v[100:103]
v_exp_f32 v195, v163
v_cvt_pk_bf16_f32 v184, v192, v193
v_mfma_f32_16x16x32_bf16 v[104:107], v[220:223], v[176:179], v[104:107]
ds_read_b64_tr_b16 v[208:209], v26 offset:8192
v_exp_f32 v196, v164
v_mfma_f32_16x16x32_bf16 v[108:111], v[220:223], v[180:183], v[108:111]
ds_read_b64_tr_b16 v[210:211], v26 offset:12288
v_exp_f32 v197, v165
v_mfma_f32_16x16x32_bf16 v[112:115], v[224:227], v[176:179], v[112:115]
ds_read_b64_tr_b16 v[212:213], v27 offset:8192
ds_read_b64_tr_b16 v[214:215], v27 offset:12288
v_mfma_f32_16x16x32_bf16 v[116:119], v[224:227], v[180:183], v[116:119]
v_cvt_pk_bf16_f32 v185, v194, v195
v_exp_f32 v198, v166
v_mfma_f32_16x16x32_bf16 v[120:123], v[228:231], v[176:179], v[120:123]
ds_read_b64_tr_b16 v[216:217], v28 offset:8192
v_exp_f32 v199, v167
v_mfma_f32_16x16x32_bf16 v[124:127], v[228:231], v[180:183], v[124:127]
ds_read_b64_tr_b16 v[218:219], v28 offset:12288
v_cvt_pk_bf16_f32 v186, v196, v197
s_waitcnt lgkmcnt(6)
v_mfma_f32_16x16x32_bf16 v[128:131], v[232:235], v[176:179], v[128:131]
ds_read_b64_tr_b16 v[220:221], v29 offset:8192
ds_read_b64_tr_b16 v[222:223], v29 offset:12288
v_mfma_f32_16x16x32_bf16 v[132:135], v[232:235], v[180:183], v[132:135]
v_or3_b32 v201, v184, v185, v186
v_exp_f32 v192, v168
v_mfma_f32_16x16x32_bf16 v[136:139], v[236:239], v[176:179], v[136:139]
ds_read_b64_tr_b16 v[224:225], v30 offset:8192
ds_read_b64_tr_b16 v[226:227], v30 offset:12288
v_mfma_f32_16x16x32_bf16 v[140:143], v[236:239], v[180:183], v[140:143]
v_exp_f32 v193, v169
v_cvt_pk_bf16_f32 v187, v198, v199
v_mfma_f32_16x16x32_bf16 v[204:207], v[4:7], v[176:179], v[204:207]
ds_read_b64_tr_b16 v[228:229], v31 offset:8192
ds_read_b64_tr_b16 v[230:231], v31 offset:12288
v_exp_f32 v194, v170
v_exp_f32 v195, v171
v_cvt_pk_bf16_f32 v188, v192, v193
v_or3_b32 v201, v201, v187, v188
v_exp_f32 v196, v172
v_exp_f32 v197, v173
v_mfma_f32_16x16x32_bf16 v[252:255], v[4:7], v[180:183], v[252:255]
v_cvt_pk_bf16_f32 v189, v194, v195
v_exp_f32 v198, v174
v_exp_f32 v199, v175
v_cvt_pk_bf16_f32 v190, v196, v197
v_or3_b32 v201, v201, v189, v190
v_and_b32 v201, s55, v201
v_cvt_pk_bf16_f32 v191, v198, v199
v_and_or_b32 v201, v191, s55, v201
v_cmp_ne_u32 vcc, 0, v201
s_nop 0
s_cbranch_vccnz L_slow15
L_back15:
v_mfma_f32_16x16x32_bf16 v[204:207], v[4:7], v[184:187], v[204:207]
ds_read_b64_tr_b16 v[232:233], v32 offset:8192
ds_read_b64_tr_b16 v[234:235], v32 offset:12288
v_mfma_f32_16x16x32_bf16 v[252:255], v[4:7], v[188:191], v[252:255]
s_waitcnt lgkmcnt(6)
v_mfma_f32_16x16x32_bf16 v[80:83], v[208:211], v[184:187], v[80:83]
ds_read_b64_tr_b16 v[236:237], v33 offset:8192
ds_read_b64_tr_b16 v[238:239], v33 offset:12288
v_mfma_f32_16x16x32_bf16 v[84:87], v[208:211], v[188:191], v[84:87]
v_rcp_f32 v41, v204
s_nop 1
v_rcp_f32 v248, v252
v_mfma_f32_16x16x32_bf16 v[88:91], v[212:215], v[184:187], v[88:91]
v_mfma_f32_16x16x32_bf16 v[92:95], v[212:215], v[188:191], v[92:95]
s_barrier
ds_read_b64_tr_b16 v[208:209], v34 offset:0
ds_read_b64_tr_b16 v[210:211], v34 offset:1024
v_mfma_f32_16x16x32_bf16 v[96:99], v[216:219], v[184:187], v[96:99]
ds_read_b64_tr_b16 v[212:213], v34 offset:2048
ds_read_b64_tr_b16 v[214:215], v34 offset:3072
v_mul_f32 v80, v80, v41
v_mfma_f32_16x16x32_bf16 v[100:103], v[216:219], v[188:191], v[100:103]
v_mul_f32 v81, v81, v41
v_mul_f32 v82, v82, v41
v_mul_f32 v83, v83, v41
v_mfma_f32_16x16x32_bf16 v[104:107], v[220:223], v[184:187], v[104:107]
ds_read_b64_tr_b16 v[216:217], v34 offset:4096
ds_read_b64_tr_b16 v[218:219], v34 offset:5120
v_mul_f32 v84, v84, v248
v_mfma_f32_16x16x32_bf16 v[108:111], v[220:223], v[188:191], v[108:111]
v_mul_f32 v85, v85, v248
v_mul_f32 v86, v86, v248
s_waitcnt lgkmcnt(6)
v_mfma_f32_16x16x32_bf16 v[112:115], v[224:227], v[184:187], v[112:115]
ds_read_b64_tr_b16 v[220:221], v34 offset:6144
ds_read_b64_tr_b16 v[222:223], v34 offset:7168
v_mul_f32 v87, v87, v248
v_mfma_f32_16x16x32_bf16 v[116:119], v[224:227], v[188:191], v[116:119]
v_cvt_pk_bf16_f32 v48, v80, v81
v_cvt_pk_bf16_f32 v49, v82, v83
v_cvt_pk_bf16_f32 v50, v84, v85
v_mfma_f32_16x16x32_bf16 v[120:123], v[228:231], v[184:187], v[120:123]
ds_read_b64_tr_b16 v[224:225], v34 offset:8192
ds_read_b64_tr_b16 v[226:227], v34 offset:9216
v_cvt_pk_bf16_f32 v51, v86, v87
v_mfma_f32_16x16x32_bf16 v[124:127], v[228:231], v[188:191], v[124:127]
v_permlane16_swap_b32 v48, v50
v_permlane16_swap_b32 v49, v51
ds_write_b128 v36, v[48:51] offset:0
v_mfma_f32_16x16x32_bf16 v[128:131], v[232:235], v[184:187], v[128:131]
ds_read_b64_tr_b16 v[228:229], v34 offset:10240
ds_read_b64_tr_b16 v[230:231], v34 offset:11264
v_mfma_f32_16x16x32_bf16 v[132:135], v[232:235], v[188:191], v[132:135]
buffer_store_dwordx4 v[48:51], v36, s[48:51], s12 offen sc1
v_mul_f32 v88, v88, v41
v_mul_f32 v89, v89, v41
v_mul_f32 v90, v90, v41
v_mfma_f32_16x16x32_bf16 v[136:139], v[236:239], v[184:187], v[136:139]
ds_read_b64_tr_b16 v[232:233], v34 offset:12288
ds_read_b64_tr_b16 v[234:235], v34 offset:13312
v_mul_f32 v91, v91, v41
v_mul_f32 v92, v92, v248
v_mul_f32 v93, v93, v248
v_mul_f32 v94, v94, v248
v_mul_f32 v95, v95, v248
v_cvt_pk_bf16_f32 v52, v88, v89
v_cvt_pk_bf16_f32 v53, v90, v91
v_cvt_pk_bf16_f32 v54, v92, v93
v_cvt_pk_bf16_f32 v55, v94, v95
s_nop 0
v_permlane16_swap_b32 v52, v54
v_permlane16_swap_b32 v53, v55
v_mfma_f32_16x16x32_bf16 v[140:143], v[236:239], v[188:191], v[140:143]
ds_write_b128 v36, v[52:55] offset:1024
buffer_store_dwordx4 v[52:55], v36, s[48:51], s12 offen offset:1024 sc1
v_mul_f32 v96, v96, v41
v_mul_f32 v97, v97, v41
v_mul_f32 v98, v98, v41
v_mul_f32 v99, v99, v41
v_mul_f32 v100, v100, v248
v_mul_f32 v101, v101, v248
v_mul_f32 v102, v102, v248
v_mul_f32 v103, v103, v248
v_cvt_pk_bf16_f32 v56, v96, v97
v_cvt_pk_bf16_f32 v57, v98, v99
v_cvt_pk_bf16_f32 v58, v100, v101
v_cvt_pk_bf16_f32 v59, v102, v103
s_nop 0
v_permlane16_swap_b32 v56, v58
v_permlane16_swap_b32 v57, v59
ds_write_b128 v36, v[56:59] offset:2048
buffer_store_dwordx4 v[56:59], v36, s[48:51], s12 offen offset:2048 sc1
s_waitcnt lgkmcnt(9)
v_mfma_f32_32x32x16_bf16 v[176:191], v[208:211], v[48:51], 0
ds_read_b64_tr_b16 v[236:237], v34 offset:14336
ds_read_b64_tr_b16 v[238:239], v34 offset:15360
v_mul_f32 v104, v104, v41
v_mul_f32 v105, v105, v41
v_mul_f32 v106, v106, v41
v_mul_f32 v107, v107, v41
v_mul_f32 v108, v108, v248
v_mul_f32 v109, v109, v248
v_mul_f32 v110, v110, v248
v_mul_f32 v111, v111, v248
v_cvt_pk_bf16_f32 v60, v104, v105
v_cvt_pk_bf16_f32 v61, v106, v107
v_cvt_pk_bf16_f32 v62, v108, v109
v_cvt_pk_bf16_f32 v63, v110, v111
s_nop 0
v_permlane16_swap_b32 v60, v62
v_permlane16_swap_b32 v61, v63
ds_write_b128 v36, v[60:63] offset:3072
buffer_store_dwordx4 v[60:63], v36, s[48:51], s12 offen offset:3072 sc1
v_mfma_f32_32x32x16_bf16 v[176:191], v[212:215], v[52:55], v[176:191]
ds_read_b64_tr_b16 v[208:209], v35 offset:0
ds_read_b64_tr_b16 v[210:211], v35 offset:1024
v_mul_f32 v112, v112, v41
v_mul_f32 v113, v113, v41
v_mul_f32 v114, v114, v41
v_mul_f32 v115, v115, v41
v_mul_f32 v116, v116, v248
v_mul_f32 v117, v117, v248
v_mul_f32 v118, v118, v248
v_mul_f32 v119, v119, v248
v_cvt_pk_bf16_f32 v64, v112, v113
v_cvt_pk_bf16_f32 v65, v114, v115
v_cvt_pk_bf16_f32 v66, v116, v117
v_cvt_pk_bf16_f32 v67, v118, v119
s_nop 0
v_permlane16_swap_b32 v64, v66
v_permlane16_swap_b32 v65, v67
ds_write_b128 v36, v[64:67] offset:4096
buffer_store_dwordx4 v[64:67], v36, s[48:51], s13 offen sc1
v_mfma_f32_32x32x16_bf16 v[176:191], v[216:219], v[56:59], v[176:191]
ds_read_b64_tr_b16 v[212:213], v35 offset:2048
ds_read_b64_tr_b16 v[214:215], v35 offset:3072
v_mul_f32 v120, v120, v41
v_mul_f32 v121, v121, v41
v_mul_f32 v122, v122, v41
v_mul_f32 v123, v123, v41
v_mul_f32 v124, v124, v248
v_mul_f32 v125, v125, v248
v_mul_f32 v126, v126, v248
v_mul_f32 v127, v127, v248
v_cvt_pk_bf16_f32 v68, v120, v121
v_cvt_pk_bf16_f32 v69, v122, v123
v_cvt_pk_bf16_f32 v70, v124, v125
v_cvt_pk_bf16_f32 v71, v126, v127
s_nop 0
v_permlane16_swap_b32 v68, v70
v_permlane16_swap_b32 v69, v71
ds_write_b128 v36, v[68:71] offset:5120
buffer_store_dwordx4 v[68:71], v36, s[48:51], s13 offen offset:1024 sc1
v_mfma_f32_32x32x16_bf16 v[176:191], v[220:223], v[60:63], v[176:191]
ds_read_b64_tr_b16 v[216:217], v35 offset:4096
ds_read_b64_tr_b16 v[218:219], v35 offset:5120
v_mul_f32 v128, v128, v41
v_mul_f32 v129, v129, v41
v_mul_f32 v130, v130, v41
v_mul_f32 v131, v131, v41
v_mul_f32 v132, v132, v248
v_mul_f32 v133, v133, v248
v_mul_f32 v134, v134, v248
v_mul_f32 v135, v135, v248
v_cvt_pk_bf16_f32 v72, v128, v129
v_cvt_pk_bf16_f32 v73, v130, v131
v_cvt_pk_bf16_f32 v74, v132, v133
v_cvt_pk_bf16_f32 v75, v134, v135
s_nop 0
v_permlane16_swap_b32 v72, v74
v_permlane16_swap_b32 v73, v75
ds_write_b128 v36, v[72:75] offset:6144
buffer_store_dwordx4 v[72:75], v36, s[48:51], s13 offen offset:2048 sc1
s_waitcnt lgkmcnt(10)
v_mfma_f32_32x32x16_bf16 v[176:191], v[224:227], v[64:67], v[176:191]
ds_read_b64_tr_b16 v[220:221], v35 offset:6144
ds_read_b64_tr_b16 v[222:223], v35 offset:7168
v_mul_f32 v136, v136, v41
v_mul_f32 v137, v137, v41
v_mul_f32 v138, v138, v41
v_mul_f32 v139, v139, v41
v_mul_f32 v140, v140, v248
v_mul_f32 v141, v141, v248
v_mul_f32 v142, v142, v248
v_mul_f32 v143, v143, v248
v_cvt_pk_bf16_f32 v76, v136, v137
v_cvt_pk_bf16_f32 v77, v138, v139
v_cvt_pk_bf16_f32 v78, v140, v141
v_cvt_pk_bf16_f32 v79, v142, v143
s_nop 0
v_permlane16_swap_b32 v76, v78
v_permlane16_swap_b32 v77, v79
ds_write_b128 v36, v[76:79] offset:7168
buffer_store_dwordx4 v[76:79], v36, s[48:51], s13 offen offset:3072 sc1
v_mfma_f32_32x32x16_bf16 v[176:191], v[228:231], v[68:71], v[176:191]
ds_read_b64_tr_b16 v[224:225], v35 offset:8192
ds_read_b64_tr_b16 v[226:227], v35 offset:9216
s_waitcnt lgkmcnt(2)
s_barrier
ds_read_b128 v[144:147], v37 offset:0
ds_read_b128 v[148:151], v37 offset:1024
v_mfma_f32_32x32x16_bf16 v[176:191], v[232:235], v[72:75], v[176:191]
ds_read_b64_tr_b16 v[228:229], v35 offset:10240
ds_read_b64_tr_b16 v[230:231], v35 offset:11264
ds_read_b128 v[152:155], v37 offset:2048
ds_read_b128 v[156:159], v37 offset:3072
ds_read_b128 v[160:163], v37 offset:4096
ds_read_b128 v[164:167], v37 offset:5120
ds_read_b128 v[168:171], v37 offset:6144
ds_read_b128 v[172:175], v37 offset:7168
v_mfma_f32_32x32x16_bf16 v[176:191], v[236:239], v[76:79], v[176:191]
ds_read_b64_tr_b16 v[232:233], v35 offset:12288
ds_read_b64_tr_b16 v[234:235], v35 offset:13312
s_waitcnt lgkmcnt(11)
v_mfma_f32_32x32x16_bf16 v[176:191], v[208:211], v[144:147], v[176:191]
ds_read_b64_tr_b16 v[236:237], v35 offset:14336
ds_read_b64_tr_b16 v[238:239], v35 offset:15360
s_waitcnt lgkmcnt(12)
v_mfma_f32_32x32x16_bf16 v[176:191], v[212:215], v[148:151], v[176:191]
s_waitcnt lgkmcnt(0)
s_barrier
ds_read_b64_tr_b16 v[208:209], v34 offset:32768
ds_read_b64_tr_b16 v[210:211], v34 offset:33792
v_mfma_f32_32x32x16_bf16 v[176:191], v[216:219], v[152:155], v[176:191]
ds_read_b64_tr_b16 v[212:213], v34 offset:34816
ds_read_b64_tr_b16 v[214:215], v34 offset:35840
v_mfma_f32_32x32x16_bf16 v[176:191], v[220:223], v[156:159], v[176:191]
ds_read_b64_tr_b16 v[216:217], v34 offset:36864
ds_read_b64_tr_b16 v[218:219], v34 offset:37888
v_mfma_f32_32x32x16_bf16 v[176:191], v[224:227], v[160:163], v[176:191]
ds_read_b64_tr_b16 v[220:221], v34 offset:38912
ds_read_b64_tr_b16 v[222:223], v34 offset:39936
v_mfma_f32_32x32x16_bf16 v[176:191], v[228:231], v[164:167], v[176:191]
ds_read_b64_tr_b16 v[224:225], v34 offset:40960
ds_read_b64_tr_b16 v[226:227], v34 offset:41984
v_mfma_f32_32x32x16_bf16 v[176:191], v[232:235], v[168:171], v[176:191]
ds_read_b64_tr_b16 v[228:229], v34 offset:43008
ds_read_b64_tr_b16 v[230:231], v34 offset:44032
v_mfma_f32_32x32x16_bf16 v[176:191], v[236:239], v[172:175], v[176:191]
ds_read_b64_tr_b16 v[232:233], v34 offset:45056
ds_read_b64_tr_b16 v[234:235], v34 offset:46080
s_waitcnt lgkmcnt(6)
v_mfma_f32_32x32x16_bf16 v[80:95], v[208:211], v[48:51], 0
ds_read_b64_tr_b16 v[236:237], v34 offset:47104
ds_read_b64_tr_b16 v[238:239], v34 offset:48128
v_mfma_f32_32x32x16_bf16 v[80:95], v[212:215], v[52:55], v[80:95]
ds_read_b64_tr_b16 v[208:209], v35 offset:32768
ds_read_b64_tr_b16 v[210:211], v35 offset:33792
s_nop 2
v_cvt_pk_bf16_f32 v240, v176, v177
v_cvt_pk_bf16_f32 v241, v178, v179
v_cvt_pk_bf16_f32 v242, v180, v181
v_cvt_pk_bf16_f32 v243, v182, v183
v_mfma_f32_32x32x16_bf16 v[80:95], v[216:219], v[56:59], v[80:95]
ds_read_b64_tr_b16 v[212:213], v35 offset:34816
ds_read_b64_tr_b16 v[214:215], v35 offset:35840
v_cvt_pk_bf16_f32 v244, v184, v185
v_cvt_pk_bf16_f32 v245, v186, v187
v_cvt_pk_bf16_f32 v246, v188, v189
v_cvt_pk_bf16_f32 v247, v190, v191
v_mfma_f32_32x32x16_bf16 v[80:95], v[220:223], v[60:63], v[80:95]
ds_read_b64_tr_b16 v[216:217], v35 offset:36864
ds_read_b64_tr_b16 v[218:219], v35 offset:37888
s_waitcnt lgkmcnt(6)
v_mfma_f32_32x32x16_bf16 v[80:95], v[224:227], v[64:67], v[80:95]
ds_read_b64_tr_b16 v[220:221], v35 offset:38912
ds_read_b64_tr_b16 v[222:223], v35 offset:39936
s_waitcnt vmcnt(0)
buffer_store_dword v46, v12, s[48:51], s14 offen sc1
v_mfma_f32_32x32x16_bf16 v[80:95], v[228:231], v[68:71], v[80:95]
ds_read_b64_tr_b16 v[224:225], v35 offset:40960
ds_read_b64_tr_b16 v[226:227], v35 offset:41984
v_mfma_f32_32x32x16_bf16 v[80:95], v[232:235], v[72:75], v[80:95]
ds_read_b64_tr_b16 v[228:229], v35 offset:43008
ds_read_b64_tr_b16 v[230:231], v35 offset:44032
v_mfma_f32_32x32x16_bf16 v[80:95], v[236:239], v[76:79], v[80:95]
ds_read_b64_tr_b16 v[232:233], v35 offset:45056
ds_read_b64_tr_b16 v[234:235], v35 offset:46080
s_waitcnt lgkmcnt(6)
v_mfma_f32_32x32x16_bf16 v[80:95], v[208:211], v[144:147], v[80:95]
ds_read_b64_tr_b16 v[236:237], v35 offset:47104
ds_read_b64_tr_b16 v[238:239], v35 offset:48128
v_mfma_f32_32x32x16_bf16 v[80:95], v[212:215], v[148:151], v[80:95]
s_waitcnt lgkmcnt(0)
s_barrier
v_add_u32 v34, 0x10000, v34
v_add_u32 v35, 0x10000, v35
ds_read_b64_tr_b16 v[208:209], v34 offset:0
ds_read_b64_tr_b16 v[210:211], v34 offset:1024
v_mfma_f32_32x32x16_bf16 v[80:95], v[216:219], v[152:155], v[80:95]
ds_read_b64_tr_b16 v[212:213], v34 offset:2048
ds_read_b64_tr_b16 v[214:215], v34 offset:3072
v_mfma_f32_32x32x16_bf16 v[80:95], v[220:223], v[156:159], v[80:95]
ds_read_b64_tr_b16 v[216:217], v34 offset:4096
ds_read_b64_tr_b16 v[218:219], v34 offset:5120
v_mfma_f32_32x32x16_bf16 v[80:95], v[224:227], v[160:163], v[80:95]
ds_read_b64_tr_b16 v[220:221], v34 offset:6144
ds_read_b64_tr_b16 v[222:223], v34 offset:7168
v_mfma_f32_32x32x16_bf16 v[80:95], v[228:231], v[164:167], v[80:95]
ds_read_b64_tr_b16 v[224:225], v34 offset:8192
ds_read_b64_tr_b16 v[226:227], v34 offset:9216
v_mfma_f32_32x32x16_bf16 v[80:95], v[232:235], v[168:171], v[80:95]
ds_read_b64_tr_b16 v[228:229], v34 offset:10240
ds_read_b64_tr_b16 v[230:231], v34 offset:11264
v_mfma_f32_32x32x16_bf16 v[80:95], v[236:239], v[172:175], v[80:95]
ds_read_b64_tr_b16 v[232:233], v34 offset:12288
ds_read_b64_tr_b16 v[234:235], v34 offset:13312
s_waitcnt lgkmcnt(6)
v_mfma_f32_32x32x16_bf16 v[96:111], v[208:211], v[48:51], 0
ds_read_b64_tr_b16 v[236:237], v34 offset:14336
ds_read_b64_tr_b16 v[238:239], v34 offset:15360
v_mfma_f32_32x32x16_bf16 v[96:111], v[212:215], v[52:55], v[96:111]
ds_read_b64_tr_b16 v[208:209], v35 offset:0
ds_read_b64_tr_b16 v[210:211], v35 offset:1024
v_mfma_f32_32x32x16_bf16 v[96:111], v[216:219], v[56:59], v[96:111]
ds_read_b64_tr_b16 v[212:213], v35 offset:2048
ds_read_b64_tr_b16 v[214:215], v35 offset:3072
v_mfma_f32_32x32x16_bf16 v[96:111], v[220:223], v[60:63], v[96:111]
ds_read_b64_tr_b16 v[216:217], v35 offset:4096
ds_read_b64_tr_b16 v[218:219], v35 offset:5120
s_waitcnt lgkmcnt(6)
v_mfma_f32_32x32x16_bf16 v[96:111], v[224:227], v[64:67], v[96:111]
ds_read_b64_tr_b16 v[220:221], v35 offset:6144
ds_read_b64_tr_b16 v[222:223], v35 offset:7168
v_mfma_f32_32x32x16_bf16 v[96:111], v[228:231], v[68:71], v[96:111]
ds_read_b64_tr_b16 v[224:225], v35 offset:8192
ds_read_b64_tr_b16 v[226:227], v35 offset:9216
v_mfma_f32_32x32x16_bf16 v[96:111], v[232:235], v[72:75], v[96:111]
ds_read_b64_tr_b16 v[228:229], v35 offset:10240
ds_read_b64_tr_b16 v[230:231], v35 offset:11264
v_mfma_f32_32x32x16_bf16 v[96:111], v[236:239], v[76:79], v[96:111]
ds_read_b64_tr_b16 v[232:233], v35 offset:12288
ds_read_b64_tr_b16 v[234:235], v35 offset:13312
s_waitcnt lgkmcnt(6)
v_mfma_f32_32x32x16_bf16 v[96:111], v[208:211], v[144:147], v[96:111]
ds_read_b64_tr_b16 v[236:237], v35 offset:14336
ds_read_b64_tr_b16 v[238:239], v35 offset:15360
v_mfma_f32_32x32x16_bf16 v[96:111], v[212:215], v[148:151], v[96:111]
s_waitcnt lgkmcnt(0)
s_barrier
v_add_u32 v34, 0xfffe8000, v34
v_add_u32 v35, 0xfffe8000, v35
ds_read_b64_tr_b16 v[208:209], v34 offset:0
ds_read_b64_tr_b16 v[210:211], v34 offset:1024
v_mfma_f32_32x32x16_bf16 v[96:111], v[216:219], v[152:155], v[96:111]
ds_read_b64_tr_b16 v[212:213], v34 offset:2048
ds_read_b64_tr_b16 v[214:215], v34 offset:3072
v_mfma_f32_32x32x16_bf16 v[96:111], v[220:223], v[156:159], v[96:111]
ds_read_b64_tr_b16 v[216:217], v34 offset:4096
ds_read_b64_tr_b16 v[218:219], v34 offset:5120
v_mfma_f32_32x32x16_bf16 v[96:111], v[224:227], v[160:163], v[96:111]
ds_read_b64_tr_b16 v[220:221], v34 offset:6144
ds_read_b64_tr_b16 v[222:223], v34 offset:7168
v_mfma_f32_32x32x16_bf16 v[96:111], v[228:231], v[164:167], v[96:111]
ds_read_b64_tr_b16 v[224:225], v34 offset:8192
ds_read_b64_tr_b16 v[226:227], v34 offset:9216
v_mfma_f32_32x32x16_bf16 v[96:111], v[232:235], v[168:171], v[96:111]
ds_read_b64_tr_b16 v[228:229], v34 offset:10240
ds_read_b64_tr_b16 v[230:231], v34 offset:11264
v_mfma_f32_32x32x16_bf16 v[96:111], v[236:239], v[172:175], v[96:111]
ds_read_b64_tr_b16 v[232:233], v34 offset:12288
ds_read_b64_tr_b16 v[234:235], v34 offset:13312
s_waitcnt lgkmcnt(6)
v_mfma_f32_32x32x16_bf16 v[112:127], v[208:211], v[48:51], 0
ds_read_b64_tr_b16 v[236:237], v34 offset:14336
ds_read_b64_tr_b16 v[238:239], v34 offset:15360
v_mfma_f32_32x32x16_bf16 v[112:127], v[212:215], v[52:55], v[112:127]
ds_read_b64_tr_b16 v[208:209], v35 offset:0
ds_read_b64_tr_b16 v[210:211], v35 offset:1024
v_mfma_f32_32x32x16_bf16 v[112:127], v[216:219], v[56:59], v[112:127]
ds_read_b64_tr_b16 v[212:213], v35 offset:2048
ds_read_b64_tr_b16 v[214:215], v35 offset:3072
v_mfma_f32_32x32x16_bf16 v[112:127], v[220:223], v[60:63], v[112:127]
ds_read_b64_tr_b16 v[216:217], v35 offset:4096
ds_read_b64_tr_b16 v[218:219], v35 offset:5120
s_waitcnt lgkmcnt(6)
v_mfma_f32_32x32x16_bf16 v[112:127], v[224:227], v[64:67], v[112:127]
ds_read_b64_tr_b16 v[220:221], v35 offset:6144
ds_read_b64_tr_b16 v[222:223], v35 offset:7168
v_mfma_f32_32x32x16_bf16 v[112:127], v[228:231], v[68:71], v[112:127]
ds_read_b64_tr_b16 v[224:225], v35 offset:8192
ds_read_b64_tr_b16 v[226:227], v35 offset:9216
v_mfma_f32_32x32x16_bf16 v[112:127], v[232:235], v[72:75], v[112:127]
ds_read_b64_tr_b16 v[228:229], v35 offset:10240
ds_read_b64_tr_b16 v[230:231], v35 offset:11264
v_mfma_f32_32x32x16_bf16 v[112:127], v[236:239], v[76:79], v[112:127]
ds_read_b64_tr_b16 v[232:233], v35 offset:12288
ds_read_b64_tr_b16 v[234:235], v35 offset:13312
s_waitcnt lgkmcnt(6)
v_mfma_f32_32x32x16_bf16 v[112:127], v[208:211], v[144:147], v[112:127]
ds_read_b64_tr_b16 v[236:237], v35 offset:14336
ds_read_b64_tr_b16 v[238:239], v35 offset:15360
v_mfma_f32_32x32x16_bf16 v[112:127], v[212:215], v[148:151], v[112:127]
s_waitcnt lgkmcnt(0)
s_barrier
ds_read_b64_tr_b16 v[208:209], v34 offset:32768
ds_read_b64_tr_b16 v[210:211], v34 offset:33792
v_mfma_f32_32x32x16_bf16 v[112:127], v[216:219], v[152:155], v[112:127]
ds_read_b64_tr_b16 v[212:213], v34 offset:34816
ds_read_b64_tr_b16 v[214:215], v34 offset:35840
v_mfma_f32_32x32x16_bf16 v[112:127], v[220:223], v[156:159], v[112:127]
ds_read_b64_tr_b16 v[216:217], v34 offset:36864
ds_read_b64_tr_b16 v[218:219], v34 offset:37888
v_mfma_f32_32x32x16_bf16 v[112:127], v[224:227], v[160:163], v[112:127]
ds_read_b64_tr_b16 v[220:221], v34 offset:38912
ds_read_b64_tr_b16 v[222:223], v34 offset:39936
v_mfma_f32_32x32x16_bf16 v[112:127], v[228:231], v[164:167], v[112:127]
ds_read_b64_tr_b16 v[224:225], v34 offset:40960
ds_read_b64_tr_b16 v[226:227], v34 offset:41984
v_mfma_f32_32x32x16_bf16 v[112:127], v[232:235], v[168:171], v[112:127]
ds_read_b64_tr_b16 v[228:229], v34 offset:43008
ds_read_b64_tr_b16 v[230:231], v34 offset:44032
v_mfma_f32_32x32x16_bf16 v[112:127], v[236:239], v[172:175], v[112:127]
ds_read_b64_tr_b16 v[232:233], v34 offset:45056
ds_read_b64_tr_b16 v[234:235], v34 offset:46080
s_waitcnt lgkmcnt(6)
v_mfma_f32_32x32x16_bf16 v[128:143], v[208:211], v[48:51], 0
ds_read_b64_tr_b16 v[236:237], v34 offset:47104
ds_read_b64_tr_b16 v[238:239], v34 offset:48128
v_mfma_f32_32x32x16_bf16 v[128:143], v[212:215], v[52:55], v[128:143]
ds_read_b64_tr_b16 v[208:209], v35 offset:32768
ds_read_b64_tr_b16 v[210:211], v35 offset:33792
v_mfma_f32_32x32x16_bf16 v[128:143], v[216:219], v[56:59], v[128:143]
ds_read_b64_tr_b16 v[212:213], v35 offset:34816
ds_read_b64_tr_b16 v[214:215], v35 offset:35840
v_mfma_f32_32x32x16_bf16 v[128:143], v[220:223], v[60:63], v[128:143]
ds_read_b64_tr_b16 v[216:217], v35 offset:36864
ds_read_b64_tr_b16 v[218:219], v35 offset:37888
s_waitcnt lgkmcnt(6)
v_mfma_f32_32x32x16_bf16 v[128:143], v[224:227], v[64:67], v[128:143]
ds_read_b64_tr_b16 v[220:221], v35 offset:38912
ds_read_b64_tr_b16 v[222:223], v35 offset:39936
v_mfma_f32_32x32x16_bf16 v[128:143], v[228:231], v[68:71], v[128:143]
ds_read_b64_tr_b16 v[224:225], v35 offset:40960
ds_read_b64_tr_b16 v[226:227], v35 offset:41984
v_mfma_f32_32x32x16_bf16 v[128:143], v[232:235], v[72:75], v[128:143]
ds_read_b64_tr_b16 v[228:229], v35 offset:43008
ds_read_b64_tr_b16 v[230:231], v35 offset:44032
v_mfma_f32_32x32x16_bf16 v[128:143], v[236:239], v[76:79], v[128:143]
ds_read_b64_tr_b16 v[232:233], v35 offset:45056
ds_read_b64_tr_b16 v[234:235], v35 offset:46080
s_waitcnt lgkmcnt(6)
v_mfma_f32_32x32x16_bf16 v[128:143], v[208:211], v[144:147], v[128:143]
ds_read_b64_tr_b16 v[236:237], v35 offset:47104
ds_read_b64_tr_b16 v[238:239], v35 offset:48128
v_mfma_f32_32x32x16_bf16 v[128:143], v[212:215], v[148:151], v[128:143]
s_waitcnt lgkmcnt(0)
s_barrier
v_add_u32 v34, 0x10000, v34
v_add_u32 v35, 0x10000, v35
v_add_u32 v36, 0x0, v36
v_add_u32 v37, 0x0, v37
ds_read_b128 v[48:51], v36 offset:0
ds_read_b64_tr_b16 v[208:209], v34 offset:0
ds_read_b64_tr_b16 v[210:211], v34 offset:1024
v_mfma_f32_32x32x16_bf16 v[128:143], v[216:219], v[152:155], v[128:143]
ds_read_b128 v[52:55], v36 offset:1024
ds_read_b64_tr_b16 v[212:213], v34 offset:2048
ds_read_b64_tr_b16 v[214:215], v34 offset:3072
v_mfma_f32_32x32x16_bf16 v[128:143], v[220:223], v[156:159], v[128:143]
ds_read_b128 v[56:59], v36 offset:2048
ds_read_b64_tr_b16 v[216:217], v34 offset:4096
ds_read_b64_tr_b16 v[218:219], v34 offset:5120
v_mfma_f32_32x32x16_bf16 v[128:143], v[224:227], v[160:163], v[128:143]
ds_read_b128 v[60:63], v36 offset:3072
ds_read_b64_tr_b16 v[220:221], v34 offset:6144
ds_read_b64_tr_b16 v[222:223], v34 offset:7168
v_mfma_f32_32x32x16_bf16 v[128:143], v[228:231], v[164:167], v[128:143]
ds_read_b128 v[64:67], v36 offset:4096
ds_read_b64_tr_b16 v[224:225], v34 offset:8192
ds_read_b64_tr_b16 v[226:227], v34 offset:9216
v_mfma_f32_32x32x16_bf16 v[128:143], v[232:235], v[168:171], v[128:143]
ds_read_b128 v[68:71], v36 offset:5120
ds_read_b64_tr_b16 v[228:229], v34 offset:10240
ds_read_b64_tr_b16 v[230:231], v34 offset:11264
v_mfma_f32_32x32x16_bf16 v[128:143], v[236:239], v[172:175], v[128:143]
ds_read_b128 v[72:75], v36 offset:6144
ds_read_b64_tr_b16 v[232:233], v34 offset:12288
ds_read_b64_tr_b16 v[234:235], v34 offset:13312
s_waitcnt lgkmcnt(9)
v_mfma_f32_32x32x16_bf16 v[80:95], v[208:211], v[48:51], v[80:95]
ds_read_b128 v[76:79], v36 offset:7168
ds_read_b64_tr_b16 v[236:237], v34 offset:14336
ds_read_b64_tr_b16 v[238:239], v34 offset:15360
v_mfma_f32_32x32x16_bf16 v[80:95], v[212:215], v[52:55], v[80:95]
ds_read_b128 v[144:147], v37 offset:0
ds_read_b64_tr_b16 v[208:209], v35 offset:0
ds_read_b64_tr_b16 v[210:211], v35 offset:1024
v_mfma_f32_32x32x16_bf16 v[80:95], v[216:219], v[56:59], v[80:95]
ds_read_b128 v[148:151], v37 offset:1024
ds_read_b64_tr_b16 v[212:213], v35 offset:2048
ds_read_b64_tr_b16 v[214:215], v35 offset:3072
v_mfma_f32_32x32x16_bf16 v[80:95], v[220:223], v[60:63], v[80:95]
ds_read_b128 v[152:155], v37 offset:2048
ds_read_b64_tr_b16 v[216:217], v35 offset:4096
ds_read_b64_tr_b16 v[218:219], v35 offset:5120
s_waitcnt lgkmcnt(9)
v_mfma_f32_32x32x16_bf16 v[80:95], v[224:227], v[64:67], v[80:95]
ds_read_b128 v[156:159], v37 offset:3072
ds_read_b64_tr_b16 v[220:221], v35 offset:6144
ds_read_b64_tr_b16 v[222:223], v35 offset:7168
v_mfma_f32_32x32x16_bf16 v[80:95], v[228:231], v[68:71], v[80:95]
ds_read_b128 v[160:163], v37 offset:4096
ds_read_b64_tr_b16 v[224:225], v35 offset:8192
ds_read_b64_tr_b16 v[226:227], v35 offset:9216
s_lshl_b32 s52, s15, 17
s_add_u32 s52, s52, s56
v_mfma_f32_32x32x16_bf16 v[80:95], v[232:235], v[72:75], v[80:95]
ds_read_b128 v[164:167], v37 offset:5120
ds_read_b64_tr_b16 v[228:229], v35 offset:10240
ds_read_b64_tr_b16 v[230:231], v35 offset:11264
v_mfma_f32_32x32x16_bf16 v[80:95], v[236:239], v[76:79], v[80:95]
ds_read_b128 v[168:171], v37 offset:6144
ds_read_b64_tr_b16 v[232:233], v35 offset:12288
ds_read_b64_tr_b16 v[234:235], v35 offset:13312
s_waitcnt lgkmcnt(9)
v_mfma_f32_32x32x16_bf16 v[80:95], v[208:211], v[144:147], v[80:95]
ds_read_b128 v[172:175], v37 offset:7168
ds_read_b64_tr_b16 v[236:237], v35 offset:14336
ds_read_b64_tr_b16 v[238:239], v35 offset:15360
buffer_store_dwordx4 v[240:243], v38, s[48:51], s52 offen sc1
v_mfma_f32_32x32x16_bf16 v[80:95], v[212:215], v[148:151], v[80:95]
s_barrier
ds_read_b64_tr_b16 v[208:209], v34 offset:32768
ds_read_b64_tr_b16 v[210:211], v34 offset:33792
v_mfma_f32_32x32x16_bf16 v[80:95], v[216:219], v[152:155], v[80:95]
ds_read_b64_tr_b16 v[212:213], v34 offset:34816
ds_read_b64_tr_b16 v[214:215], v34 offset:35840
v_mfma_f32_32x32x16_bf16 v[80:95], v[220:223], v[156:159], v[80:95]
ds_read_b64_tr_b16 v[216:217], v34 offset:36864
ds_read_b64_tr_b16 v[218:219], v34 offset:37888
s_waitcnt lgkmcnt(6)
v_mfma_f32_32x32x16_bf16 v[80:95], v[224:227], v[160:163], v[80:95]
ds_read_b64_tr_b16 v[220:221], v34 offset:38912
ds_read_b64_tr_b16 v[222:223], v34 offset:39936
buffer_store_dwordx4 v[244:247], v38, s[48:51], s52 offen offset:256 sc1
v_mfma_f32_32x32x16_bf16 v[80:95], v[228:231], v[164:167], v[80:95]
ds_read_b64_tr_b16 v[224:225], v34 offset:40960
ds_read_b64_tr_b16 v[226:227], v34 offset:41984
v_mfma_f32_32x32x16_bf16 v[80:95], v[232:235], v[168:171], v[80:95]
ds_read_b64_tr_b16 v[228:229], v34 offset:43008
ds_read_b64_tr_b16 v[230:231], v34 offset:44032
v_mfma_f32_32x32x16_bf16 v[80:95], v[236:239], v[172:175], v[80:95]
ds_read_b64_tr_b16 v[232:233], v34 offset:45056
ds_read_b64_tr_b16 v[234:235], v34 offset:46080
s_waitcnt lgkmcnt(6)
v_mfma_f32_32x32x16_bf16 v[96:111], v[208:211], v[48:51], v[96:111]
ds_read_b64_tr_b16 v[236:237], v34 offset:47104
ds_read_b64_tr_b16 v[238:239], v34 offset:48128
v_mfma_f32_32x32x16_bf16 v[96:111], v[212:215], v[52:55], v[96:111]
ds_read_b64_tr_b16 v[208:209], v35 offset:32768
ds_read_b64_tr_b16 v[210:211], v35 offset:33792
s_nop 2
v_cvt_pk_bf16_f32 v192, v80, v81
v_cvt_pk_bf16_f32 v193, v82, v83
v_cvt_pk_bf16_f32 v194, v84, v85
v_cvt_pk_bf16_f32 v195, v86, v87
v_mfma_f32_32x32x16_bf16 v[96:111], v[216:219], v[56:59], v[96:111]
ds_read_b64_tr_b16 v[212:213], v35 offset:34816
ds_read_b64_tr_b16 v[214:215], v35 offset:35840
v_cvt_pk_bf16_f32 v196, v88, v89
v_cvt_pk_bf16_f32 v197, v90, v91
v_cvt_pk_bf16_f32 v198, v92, v93
v_cvt_pk_bf16_f32 v199, v94, v95
v_mfma_f32_32x32x16_bf16 v[96:111], v[220:223], v[60:63], v[96:111]
ds_read_b64_tr_b16 v[216:217], v35 offset:36864
ds_read_b64_tr_b16 v[218:219], v35 offset:37888
s_lshl_b32 s52, s57, 17
s_add_u32 s52, s52, s56
s_add_u32 s57, s57, 1
s_waitcnt lgkmcnt(6)
v_mfma_f32_32x32x16_bf16 v[96:111], v[224:227], v[64:67], v[96:111]
ds_read_b64_tr_b16 v[220:221], v35 offset:38912
ds_read_b64_tr_b16 v[222:223], v35 offset:39936
s_cmp_eq_u32 s57, 9
s_cselect_b32 s57, 0, s57
v_mfma_f32_32x32x16_bf16 v[96:111], v[228:231], v[68:71], v[96:111]
ds_read_b64_tr_b16 v[224:225], v35 offset:40960
ds_read_b64_tr_b16 v[226:227], v35 offset:41984
v_mfma_f32_32x32x16_bf16 v[96:111], v[232:235], v[72:75], v[96:111]
ds_read_b64_tr_b16 v[228:229], v35 offset:43008
ds_read_b64_tr_b16 v[230:231], v35 offset:44032
buffer_store_dwordx4 v[192:195], v38, s[48:51], s52 offen sc1
v_mfma_f32_32x32x16_bf16 v[96:111], v[236:239], v[76:79], v[96:111]
ds_read_b64_tr_b16 v[232:233], v35 offset:45056
ds_read_b64_tr_b16 v[234:235], v35 offset:46080
s_waitcnt lgkmcnt(6)
v_mfma_f32_32x32x16_bf16 v[96:111], v[208:211], v[144:147], v[96:111]
ds_read_b64_tr_b16 v[236:237], v35 offset:47104
ds_read_b64_tr_b16 v[238:239], v35 offset:48128
v_mfma_f32_32x32x16_bf16 v[96:111], v[212:215], v[148:151], v[96:111]
s_barrier
v_add_u32 v34, 0xffff0000, v34
v_add_u32 v35, 0xffff0000, v35
ds_read_b64_tr_b16 v[208:209], v34 offset:0
ds_read_b64_tr_b16 v[210:211], v34 offset:1024
v_mfma_f32_32x32x16_bf16 v[96:111], v[216:219], v[152:155], v[96:111]
ds_read_b64_tr_b16 v[212:213], v34 offset:2048
ds_read_b64_tr_b16 v[214:215], v34 offset:3072
buffer_store_dwordx4 v[196:199], v38, s[48:51], s52 offen offset:256 sc1
v_mfma_f32_32x32x16_bf16 v[96:111], v[220:223], v[156:159], v[96:111]
ds_read_b64_tr_b16 v[216:217], v34 offset:4096
ds_read_b64_tr_b16 v[218:219], v34 offset:5120
s_waitcnt lgkmcnt(6)
v_mfma_f32_32x32x16_bf16 v[96:111], v[224:227], v[160:163], v[96:111]
ds_read_b64_tr_b16 v[220:221], v34 offset:6144
ds_read_b64_tr_b16 v[222:223], v34 offset:7168
v_mfma_f32_32x32x16_bf16 v[96:111], v[228:231], v[164:167], v[96:111]
ds_read_b64_tr_b16 v[224:225], v34 offset:8192
ds_read_b64_tr_b16 v[226:227], v34 offset:9216
v_mfma_f32_32x32x16_bf16 v[96:111], v[232:235], v[168:171], v[96:111]
ds_read_b64_tr_b16 v[228:229], v34 offset:10240
ds_read_b64_tr_b16 v[230:231], v34 offset:11264
v_mfma_f32_32x32x16_bf16 v[96:111], v[236:239], v[172:175], v[96:111]
ds_read_b64_tr_b16 v[232:233], v34 offset:12288
ds_read_b64_tr_b16 v[234:235], v34 offset:13312
s_waitcnt lgkmcnt(6)
v_mfma_f32_32x32x16_bf16 v[112:127], v[208:211], v[48:51], v[112:127]
ds_read_b64_tr_b16 v[236:237], v34 offset:14336
ds_read_b64_tr_b16 v[238:239], v34 offset:15360
v_mfma_f32_32x32x16_bf16 v[112:127], v[212:215], v[52:55], v[112:127]
ds_read_b64_tr_b16 v[208:209], v35 offset:0
ds_read_b64_tr_b16 v[210:211], v35 offset:1024
s_nop 2
v_cvt_pk_bf16_f32 v200, v96, v97
v_cvt_pk_bf16_f32 v201, v98, v99
v_cvt_pk_bf16_f32 v202, v100, v101
v_cvt_pk_bf16_f32 v203, v102, v103
v_mfma_f32_32x32x16_bf16 v[112:127], v[216:219], v[56:59], v[112:127]
ds_read_b64_tr_b16 v[212:213], v35 offset:2048
ds_read_b64_tr_b16 v[214:215], v35 offset:3072
v_cvt_pk_bf16_f32 v204, v104, v105
v_cvt_pk_bf16_f32 v205, v106, v107
v_cvt_pk_bf16_f32 v206, v108, v109
v_cvt_pk_bf16_f32 v207, v110, v111
v_mfma_f32_32x32x16_bf16 v[112:127], v[220:223], v[60:63], v[112:127]
ds_read_b64_tr_b16 v[216:217], v35 offset:4096
ds_read_b64_tr_b16 v[218:219], v35 offset:5120
s_lshl_b32 s52, s57, 17
s_add_u32 s52, s52, s56
s_add_u32 s57, s57, 1
s_waitcnt lgkmcnt(6)
v_mfma_f32_32x32x16_bf16 v[112:127], v[224:227], v[64:67], v[112:127]
ds_read_b64_tr_b16 v[220:221], v35 offset:6144
ds_read_b64_tr_b16 v[222:223], v35 offset:7168
s_cmp_eq_u32 s57, 9
s_cselect_b32 s57, 0, s57
v_mfma_f32_32x32x16_bf16 v[112:127], v[228:231], v[68:71], v[112:127]
ds_read_b64_tr_b16 v[224:225], v35 offset:8192
ds_read_b64_tr_b16 v[226:227], v35 offset:9216
v_mfma_f32_32x32x16_bf16 v[112:127], v[232:235], v[72:75], v[112:127]
ds_read_b64_tr_b16 v[228:229], v35 offset:10240
ds_read_b64_tr_b16 v[230:231], v35 offset:11264
buffer_store_dwordx4 v[200:203], v38, s[48:51], s52 offen sc1
v_mfma_f32_32x32x16_bf16 v[112:127], v[236:239], v[76:79], v[112:127]
ds_read_b64_tr_b16 v[232:233], v35 offset:12288
ds_read_b64_tr_b16 v[234:235], v35 offset:13312
s_waitcnt lgkmcnt(6)
v_mfma_f32_32x32x16_bf16 v[112:127], v[208:211], v[144:147], v[112:127]
ds_read_b64_tr_b16 v[236:237], v35 offset:14336
ds_read_b64_tr_b16 v[238:239], v35 offset:15360
v_mfma_f32_32x32x16_bf16 v[112:127], v[212:215], v[148:151], v[112:127]
s_barrier
ds_read_b64_tr_b16 v[208:209], v34 offset:32768
ds_read_b64_tr_b16 v[210:211], v34 offset:33792
v_mfma_f32_32x32x16_bf16 v[112:127], v[216:219], v[152:155], v[112:127]
ds_read_b64_tr_b16 v[212:213], v34 offset:34816
ds_read_b64_tr_b16 v[214:215], v34 offset:35840
buffer_store_dwordx4 v[204:207], v38, s[48:51], s52 offen offset:256 sc1
v_mfma_f32_32x32x16_bf16 v[112:127], v[220:223], v[156:159], v[112:127]
ds_read_b64_tr_b16 v[216:217], v34 offset:36864
ds_read_b64_tr_b16 v[218:219], v34 offset:37888
s_waitcnt lgkmcnt(6)
v_mfma_f32_32x32x16_bf16 v[112:127], v[224:227], v[160:163], v[112:127]
ds_read_b64_tr_b16 v[220:221], v34 offset:38912
ds_read_b64_tr_b16 v[222:223], v34 offset:39936
v_mfma_f32_32x32x16_bf16 v[112:127], v[228:231], v[164:167], v[112:127]
ds_read_b64_tr_b16 v[224:225], v34 offset:40960
ds_read_b64_tr_b16 v[226:227], v34 offset:41984
v_mfma_f32_32x32x16_bf16 v[112:127], v[232:235], v[168:171], v[112:127]
ds_read_b64_tr_b16 v[228:229], v34 offset:43008
ds_read_b64_tr_b16 v[230:231], v34 offset:44032
v_mfma_f32_32x32x16_bf16 v[112:127], v[236:239], v[172:175], v[112:127]
ds_read_b64_tr_b16 v[232:233], v34 offset:45056
ds_read_b64_tr_b16 v[234:235], v34 offset:46080
s_waitcnt lgkmcnt(6)
v_mfma_f32_32x32x16_bf16 v[128:143], v[208:211], v[48:51], v[128:143]
ds_read_b64_tr_b16 v[236:237], v34 offset:47104
ds_read_b64_tr_b16 v[238:239], v34 offset:48128
v_mfma_f32_32x32x16_bf16 v[128:143], v[212:215], v[52:55], v[128:143]
ds_read_b64_tr_b16 v[208:209], v35 offset:32768
ds_read_b64_tr_b16 v[210:211], v35 offset:33792
s_nop 2
v_cvt_pk_bf16_f32 v176, v112, v113
v_cvt_pk_bf16_f32 v177, v114, v115
v_cvt_pk_bf16_f32 v178, v116, v117
v_cvt_pk_bf16_f32 v179, v118, v119
v_mfma_f32_32x32x16_bf16 v[128:143], v[216:219], v[56:59], v[128:143]
ds_read_b64_tr_b16 v[212:213], v35 offset:34816
ds_read_b64_tr_b16 v[214:215], v35 offset:35840
v_cvt_pk_bf16_f32 v180, v120, v121
v_cvt_pk_bf16_f32 v181, v122, v123
v_cvt_pk_bf16_f32 v182, v124, v125
v_cvt_pk_bf16_f32 v183, v126, v127
v_mfma_f32_32x32x16_bf16 v[128:143], v[220:223], v[60:63], v[128:143]
ds_read_b64_tr_b16 v[216:217], v35 offset:36864
ds_read_b64_tr_b16 v[218:219], v35 offset:37888
s_lshl_b32 s52, s57, 17
s_add_u32 s52, s52, s56
s_add_u32 s57, s57, 1
s_waitcnt lgkmcnt(6)
v_mfma_f32_32x32x16_bf16 v[128:143], v[224:227], v[64:67], v[128:143]
ds_read_b64_tr_b16 v[220:221], v35 offset:38912
ds_read_b64_tr_b16 v[222:223], v35 offset:39936
s_cmp_eq_u32 s57, 9
s_cselect_b32 s57, 0, s57
v_mfma_f32_32x32x16_bf16 v[128:143], v[228:231], v[68:71], v[128:143]
ds_read_b64_tr_b16 v[224:225], v35 offset:40960
ds_read_b64_tr_b16 v[226:227], v35 offset:41984
v_mfma_f32_32x32x16_bf16 v[128:143], v[232:235], v[72:75], v[128:143]
ds_read_b64_tr_b16 v[228:229], v35 offset:43008
ds_read_b64_tr_b16 v[230:231], v35 offset:44032
buffer_store_dwordx4 v[176:179], v38, s[48:51], s52 offen sc1
v_mfma_f32_32x32x16_bf16 v[128:143], v[236:239], v[76:79], v[128:143]
ds_read_b64_tr_b16 v[232:233], v35 offset:45056
ds_read_b64_tr_b16 v[234:235], v35 offset:46080
s_waitcnt lgkmcnt(6)
v_mfma_f32_32x32x16_bf16 v[128:143], v[208:211], v[144:147], v[128:143]
ds_read_b64_tr_b16 v[236:237], v35 offset:47104
ds_read_b64_tr_b16 v[238:239], v35 offset:48128
v_mfma_f32_32x32x16_bf16 v[128:143], v[212:215], v[148:151], v[128:143]
v_mfma_f32_32x32x16_bf16 v[128:143], v[216:219], v[152:155], v[128:143]
buffer_store_dwordx4 v[180:183], v38, s[48:51], s52 offen offset:256 sc1
v_mfma_f32_32x32x16_bf16 v[128:143], v[220:223], v[156:159], v[128:143]
s_waitcnt lgkmcnt(0)
v_mfma_f32_32x32x16_bf16 v[128:143], v[224:227], v[160:163], v[128:143]
s_lshl_b32 s52, s57, 17
s_add_u32 s52, s52, s56
s_add_u32 s57, s57, 1
s_cmp_eq_u32 s57, 9
s_cselect_b32 s57, 0, s57
v_mfma_f32_32x32x16_bf16 v[128:143], v[228:231], v[164:167], v[128:143]
v_mfma_f32_32x32x16_bf16 v[128:143], v[232:235], v[168:171], v[128:143]
v_mfma_f32_32x32x16_bf16 v[128:143], v[236:239], v[172:175], v[128:143]
s_nop 11
v_cvt_pk_bf16_f32 v184, v128, v129
v_cvt_pk_bf16_f32 v185, v130, v131
v_cvt_pk_bf16_f32 v186, v132, v133
v_cvt_pk_bf16_f32 v187, v134, v135
buffer_store_dwordx4 v[184:187], v38, s[48:51], s52 offen sc1
v_cvt_pk_bf16_f32 v188, v136, v137
v_cvt_pk_bf16_f32 v189, v138, v139
v_cvt_pk_bf16_f32 v190, v140, v141
v_cvt_pk_bf16_f32 v191, v142, v143
buffer_store_dwordx4 v[188:191], v38, s[48:51], s52 offen offset:256 sc1
s_barrier
s_mov_b32 s9, 0
v_mov_b32 v216, 131136
s_mov_b64 exec, 15
s_cmp_lg_u32 s24, s44
s_cbranch_scc1 L_nops
s_buffer_load_dwordx8 s[28:35], s[48:51], s4 glc
L_nops:
s_waitcnt vmcnt(0)
buffer_store_short v40, v39, s[48:51], s11 offen sc1
s_cmp_lg_u32 s24, s44
s_cbranch_scc1 L_cpdone
L_cpoll:
s_add_u32 s9, s9, 1
s_waitcnt lgkmcnt(0)
s_or_b64 s[28:29], s[28:29], s[36:37]
s_or_b64 s[30:31], s[30:31], s[38:39]
s_or_b64 s[32:33], s[32:33], s[40:41]
s_or_b64 s[34:35], s[34:35], s[42:43]
v_mov_b32 v208, s28
v_mov_b32 v209, s29
v_mov_b32 v210, s30
v_mov_b32 v211, s31
v_mov_b32 v212, s32
v_mov_b32 v213, s33
v_mov_b32 v214, s34
v_mov_b32 v215, s35
s_and_b64 s[52:53], s[28:29], s[30:31]
s_and_b64 s[54:55], s[32:33], s[34:35]
s_buffer_load_dwordx8 s[28:35], s[48:51], s4 glc
ds_write_b128 v216, v[208:211]
ds_write_b128 v216, v[212:215] offset:16
s_and_b64 s[52:53], s[52:53], s[54:55]
s_cmp_eq_u64 s[52:53], -1
s_cbranch_scc1 L_cpdone
s_cmp_lt_u32 s9, 64
s_cbranch_scc1 L_cpoll
s_branch L_cvec
L_cpdone:
s_waitcnt lgkmcnt(0)
s_mov_b64 exec, -1
L_end:
s_endpgm
L_hotend:
L_slow1:
s_nop 15
v_max3_f32 v42, v160, v161, v162
v_max3_f32 v42, v42, v163, v164
v_max3_f32 v42, v42, v165, v166
v_max_f32 v42, v42, v167
v_max3_f32 v249, v168, v169, v170
v_max3_f32 v249, v249, v171, v172
v_max3_f32 v249, v249, v173, v174
v_max_f32 v249, v249, v175
s_nop 1
v_permlane16_swap_b32 v42, v249
v_max_f32 v42, v42, v249
v_mov_b32 v249, v42
s_nop 1
v_permlane32_swap_b32 v42, v249
v_max_f32 v42, v42, v249
v_add_f32 v42, 0x42000000, v42
v_max_f32 v42, 0, v42
v_mov_b32 v249, v42
s_nop 1
v_permlane16_swap_b32 v42, v249
v_sub_f32 v43, 0, v42
v_exp_f32 v43, v43
v_sub_f32 v44, 0, v249
v_exp_f32 v44, v44
v_sub_f32 v240, v240, v42
v_sub_f32 v241, v241, v42
v_sub_f32 v242, v242, v42
v_sub_f32 v243, v243, v42
v_sub_f32 v244, v244, v249
v_sub_f32 v245, v245, v249
v_sub_f32 v246, v246, v249
v_sub_f32 v247, v247, v249
v_mul_f32 v204, v204, v43
v_mul_f32 v252, v252, v44
v_mul_f32 v80, v80, v43
v_mul_f32 v81, v81, v43
v_mul_f32 v82, v82, v43
v_mul_f32 v83, v83, v43
v_mul_f32 v84, v84, v44
v_mul_f32 v85, v85, v44
v_mul_f32 v86, v86, v44
v_mul_f32 v87, v87, v44
v_mul_f32 v88, v88, v43
v_mul_f32 v89, v89, v43
v_mul_f32 v90, v90, v43
v_mul_f32 v91, v91, v43
v_mul_f32 v92, v92, v44
v_mul_f32 v93, v93, v44
v_mul_f32 v94, v94, v44
v_mul_f32 v95, v95, v44
v_mul_f32 v96, v96, v43
v_mul_f32 v97, v97, v43
v_mul_f32 v98, v98, v43
v_mul_f32 v99, v99, v43
v_mul_f32 v100, v100, v44
v_mul_f32 v101, v101, v44
v_mul_f32 v102, v102, v44
v_mul_f32 v103, v103, v44
v_mul_f32 v104, v104, v43
v_mul_f32 v105, v105, v43
v_mul_f32 v106, v106, v43
v_mul_f32 v107, v107, v43
v_mul_f32 v108, v108, v44
v_mul_f32 v109, v109, v44
v_mul_f32 v110, v110, v44
v_mul_f32 v111, v111, v44
v_mul_f32 v112, v112, v43
v_mul_f32 v113, v113, v43
v_mul_f32 v114, v114, v43
v_mul_f32 v115, v115, v43
v_mul_f32 v116, v116, v44
v_mul_f32 v117, v117, v44
v_mul_f32 v118, v118, v44
v_mul_f32 v119, v119, v44
v_mul_f32 v120, v120, v43
v_mul_f32 v121, v121, v43
v_mul_f32 v122, v122, v43
v_mul_f32 v123, v123, v43
v_mul_f32 v124, v124, v44
v_mul_f32 v125, v125, v44
v_mul_f32 v126, v126, v44
v_mul_f32 v127, v127, v44
v_mul_f32 v128, v128, v43
v_mul_f32 v129, v129, v43
v_mul_f32 v130, v130, v43
v_mul_f32 v131, v131, v43
v_mul_f32 v132, v132, v44
v_mul_f32 v133, v133, v44
v_mul_f32 v134, v134, v44
v_mul_f32 v135, v135, v44
v_mul_f32 v136, v136, v43
v_mul_f32 v137, v137, v43
v_mul_f32 v138, v138, v43
v_mul_f32 v139, v139, v43
v_mul_f32 v140, v140, v44
v_mul_f32 v141, v141, v44
v_mul_f32 v142, v142, v44
v_mul_f32 v143, v143, v44
v_sub_f32 v192, v160, v42
v_exp_f32 v192, v192
v_sub_f32 v193, v161, v42
v_exp_f32 v193, v193
v_sub_f32 v194, v162, v42
v_exp_f32 v194, v194
v_sub_f32 v195, v163, v42
v_exp_f32 v195, v195
v_cvt_pk_bf16_f32 v184, v192, v193
v_sub_f32 v196, v164, v42
v_exp_f32 v196, v196
v_sub_f32 v197, v165, v42
v_exp_f32 v197, v197
v_cvt_pk_bf16_f32 v185, v194, v195
v_sub_f32 v198, v166, v42
v_exp_f32 v198, v198
v_sub_f32 v199, v167, v42
v_exp_f32 v199, v199
v_cvt_pk_bf16_f32 v186, v196, v197
v_sub_f32 v192, v168, v249
v_exp_f32 v192, v192
v_sub_f32 v193, v169, v249
v_exp_f32 v193, v193
v_cvt_pk_bf16_f32 v187, v198, v199
v_sub_f32 v194, v170, v249
v_exp_f32 v194, v194
v_sub_f32 v195, v171, v249
v_exp_f32 v195, v195
v_cvt_pk_bf16_f32 v188, v192, v193
v_sub_f32 v196, v172, v249
v_exp_f32 v196, v196
v_sub_f32 v197, v173, v249
v_exp_f32 v197, v197
v_cvt_pk_bf16_f32 v189, v194, v195
v_sub_f32 v198, v174, v249
v_exp_f32 v198, v198
v_sub_f32 v199, v175, v249
v_exp_f32 v199, v199
v_cvt_pk_bf16_f32 v190, v196, v197
v_cvt_pk_bf16_f32 v191, v198, v199
v_sub_f32 v144, v144, v42
v_sub_f32 v145, v145, v42
v_sub_f32 v146, v146, v42
v_sub_f32 v147, v147, v42
v_sub_f32 v148, v148, v42
v_sub_f32 v149, v149, v42
v_sub_f32 v150, v150, v42
v_sub_f32 v151, v151, v42
v_sub_f32 v152, v152, v249
v_sub_f32 v153, v153, v249
v_sub_f32 v154, v154, v249
v_sub_f32 v155, v155, v249
v_sub_f32 v156, v156, v249
v_sub_f32 v157, v157, v249
v_sub_f32 v158, v158, v249
v_sub_f32 v159, v159, v249
s_nop 1
s_branch L_back1
L_slow2:
s_nop 15
v_max3_f32 v42, v144, v145, v146
v_max3_f32 v42, v42, v147, v148
v_max3_f32 v42, v42, v149, v150
v_max_f32 v42, v42, v151
v_max3_f32 v249, v152, v153, v154
v_max3_f32 v249, v249, v155, v156
v_max3_f32 v249, v249, v157, v158
v_max_f32 v249, v249, v159
s_nop 1
v_permlane16_swap_b32 v42, v249
v_max_f32 v42, v42, v249
v_mov_b32 v249, v42
s_nop 1
v_permlane32_swap_b32 v42, v249
v_max_f32 v42, v42, v249
v_add_f32 v42, 0x42000000, v42
v_max_f32 v42, 0, v42
v_mov_b32 v249, v42
s_nop 1
v_permlane16_swap_b32 v42, v249
v_sub_f32 v43, 0, v42
v_exp_f32 v43, v43
v_sub_f32 v44, 0, v249
v_exp_f32 v44, v44
v_sub_f32 v240, v240, v42
v_sub_f32 v241, v241, v42
v_sub_f32 v242, v242, v42
v_sub_f32 v243, v243, v42
v_sub_f32 v244, v244, v249
v_sub_f32 v245, v245, v249
v_sub_f32 v246, v246, v249
v_sub_f32 v247, v247, v249
v_mul_f32 v204, v204, v43
v_mul_f32 v252, v252, v44
v_mul_f32 v80, v80, v43
v_mul_f32 v81, v81, v43
v_mul_f32 v82, v82, v43
v_mul_f32 v83, v83, v43
v_mul_f32 v84, v84, v44
v_mul_f32 v85, v85, v44
v_mul_f32 v86, v86, v44
v_mul_f32 v87, v87, v44
v_mul_f32 v88, v88, v43
v_mul_f32 v89, v89, v43
v_mul_f32 v90, v90, v43
v_mul_f32 v91, v91, v43
v_mul_f32 v92, v92, v44
v_mul_f32 v93, v93, v44
v_mul_f32 v94, v94, v44
v_mul_f32 v95, v95, v44
v_mul_f32 v96, v96, v43
v_mul_f32 v97, v97, v43
v_mul_f32 v98, v98, v43
v_mul_f32 v99, v99, v43
v_mul_f32 v100, v100, v44
v_mul_f32 v101, v101, v44
v_mul_f32 v102, v102, v44
v_mul_f32 v103, v103, v44
v_mul_f32 v104, v104, v43
v_mul_f32 v105, v105, v43
v_mul_f32 v106, v106, v43
v_mul_f32 v107, v107, v43
v_mul_f32 v108, v108, v44
v_mul_f32 v109, v109, v44
v_mul_f32 v110, v110, v44
v_mul_f32 v111, v111, v44
v_mul_f32 v112, v112, v43
v_mul_f32 v113, v113, v43
v_mul_f32 v114, v114, v43
v_mul_f32 v115, v115, v43
v_mul_f32 v116, v116, v44
v_mul_f32 v117, v117, v44
v_mul_f32 v118, v118, v44
v_mul_f32 v119, v119, v44
v_mul_f32 v120, v120, v43
v_mul_f32 v121, v121, v43
v_mul_f32 v122, v122, v43
v_mul_f32 v123, v123, v43
v_mul_f32 v124, v124, v44
v_mul_f32 v125, v125, v44
v_mul_f32 v126, v126, v44
v_mul_f32 v127, v127, v44
v_mul_f32 v128, v128, v43
v_mul_f32 v129, v129, v43
v_mul_f32 v130, v130, v43
v_mul_f32 v131, v131, v43
v_mul_f32 v132, v132, v44
v_mul_f32 v133, v133, v44
v_mul_f32 v134, v134, v44
v_mul_f32 v135, v135, v44
v_mul_f32 v136, v136, v43
v_mul_f32 v137, v137, v43
v_mul_f32 v138, v138, v43
v_mul_f32 v139, v139, v43
v_mul_f32 v140, v140, v44
v_mul_f32 v141, v141, v44
v_mul_f32 v142, v142, v44
v_mul_f32 v143, v143, v44
v_sub_f32 v192, v144, v42
v_exp_f32 v192, v192
v_sub_f32 v193, v145, v42
v_exp_f32 v193, v193
v_sub_f32 v194, v146, v42
v_exp_f32 v194, v194
v_sub_f32 v195, v147, v42
v_exp_f32 v195, v195
v_cvt_pk_bf16_f32 v176, v192, v193
v_sub_f32 v196, v148, v42
v_exp_f32 v196, v196
v_sub_f32 v197, v149, v42
v_exp_f32 v197, v197
v_cvt_pk_bf16_f32 v177, v194, v195
v_sub_f32 v198, v150, v42
v_exp_f32 v198, v198
v_sub_f32 v199, v151, v42
v_exp_f32 v199, v199
v_cvt_pk_bf16_f32 v178, v196, v197
v_sub_f32 v192, v152, v249
v_exp_f32 v192, v192
v_sub_f32 v193, v153, v249
v_exp_f32 v193, v193
v_cvt_pk_bf16_f32 v179, v198, v199
v_sub_f32 v194, v154, v249
v_exp_f32 v194, v194
v_sub_f32 v195, v155, v249
v_exp_f32 v195, v195
v_cvt_pk_bf16_f32 v180, v192, v193
v_sub_f32 v196, v156, v249
v_exp_f32 v196, v196
v_sub_f32 v197, v157, v249
v_exp_f32 v197, v197
v_cvt_pk_bf16_f32 v181, v194, v195
v_sub_f32 v198, v158, v249
v_exp_f32 v198, v198
v_sub_f32 v199, v159, v249
v_exp_f32 v199, v199
v_cvt_pk_bf16_f32 v182, v196, v197
v_cvt_pk_bf16_f32 v183, v198, v199
v_sub_f32 v160, v160, v42
v_sub_f32 v161, v161, v42
v_sub_f32 v162, v162, v42
v_sub_f32 v163, v163, v42
v_sub_f32 v164, v164, v42
v_sub_f32 v165, v165, v42
v_sub_f32 v166, v166, v42
v_sub_f32 v167, v167, v42
v_sub_f32 v168, v168, v249
v_sub_f32 v169, v169, v249
v_sub_f32 v170, v170, v249
v_sub_f32 v171, v171, v249
v_sub_f32 v172, v172, v249
v_sub_f32 v173, v173, v249
v_sub_f32 v174, v174, v249
v_sub_f32 v175, v175, v249
s_nop 1
s_branch L_back2
L_slow3:
s_nop 15
v_max3_f32 v42, v160, v161, v162
v_max3_f32 v42, v42, v163, v164
v_max3_f32 v42, v42, v165, v166
v_max_f32 v42, v42, v167
v_max3_f32 v249, v168, v169, v170
v_max3_f32 v249, v249, v171, v172
v_max3_f32 v249, v249, v173, v174
v_max_f32 v249, v249, v175
s_nop 1
v_permlane16_swap_b32 v42, v249
v_max_f32 v42, v42, v249
v_mov_b32 v249, v42
s_nop 1
v_permlane32_swap_b32 v42, v249
v_max_f32 v42, v42, v249
v_add_f32 v42, 0x42000000, v42
v_max_f32 v42, 0, v42
v_mov_b32 v249, v42
s_nop 1
v_permlane16_swap_b32 v42, v249
v_sub_f32 v43, 0, v42
v_exp_f32 v43, v43
v_sub_f32 v44, 0, v249
v_exp_f32 v44, v44
v_sub_f32 v240, v240, v42
v_sub_f32 v241, v241, v42
v_sub_f32 v242, v242, v42
v_sub_f32 v243, v243, v42
v_sub_f32 v244, v244, v249
v_sub_f32 v245, v245, v249
v_sub_f32 v246, v246, v249
v_sub_f32 v247, v247, v249
v_mul_f32 v204, v204, v43
v_mul_f32 v252, v252, v44
v_mul_f32 v80, v80, v43
v_mul_f32 v81, v81, v43
v_mul_f32 v82, v82, v43
v_mul_f32 v83, v83, v43
v_mul_f32 v84, v84, v44
v_mul_f32 v85, v85, v44
v_mul_f32 v86, v86, v44
v_mul_f32 v87, v87, v44
v_mul_f32 v88, v88, v43
v_mul_f32 v89, v89, v43
v_mul_f32 v90, v90, v43
v_mul_f32 v91, v91, v43
v_mul_f32 v92, v92, v44
v_mul_f32 v93, v93, v44
v_mul_f32 v94, v94, v44
v_mul_f32 v95, v95, v44
v_mul_f32 v96, v96, v43
v_mul_f32 v97, v97, v43
v_mul_f32 v98, v98, v43
v_mul_f32 v99, v99, v43
v_mul_f32 v100, v100, v44
v_mul_f32 v101, v101, v44
v_mul_f32 v102, v102, v44
v_mul_f32 v103, v103, v44
v_mul_f32 v104, v104, v43
v_mul_f32 v105, v105, v43
v_mul_f32 v106, v106, v43
v_mul_f32 v107, v107, v43
v_mul_f32 v108, v108, v44
v_mul_f32 v109, v109, v44
v_mul_f32 v110, v110, v44
v_mul_f32 v111, v111, v44
v_mul_f32 v112, v112, v43
v_mul_f32 v113, v113, v43
v_mul_f32 v114, v114, v43
v_mul_f32 v115, v115, v43
v_mul_f32 v116, v116, v44
v_mul_f32 v117, v117, v44
v_mul_f32 v118, v118, v44
v_mul_f32 v119, v119, v44
v_mul_f32 v120, v120, v43
v_mul_f32 v121, v121, v43
v_mul_f32 v122, v122, v43
v_mul_f32 v123, v123, v43
v_mul_f32 v124, v124, v44
v_mul_f32 v125, v125, v44
v_mul_f32 v126, v126, v44
v_mul_f32 v127, v127, v44
v_mul_f32 v128, v128, v43
v_mul_f32 v129, v129, v43
v_mul_f32 v130, v130, v43
v_mul_f32 v131, v131, v43
v_mul_f32 v132, v132, v44
v_mul_f32 v133, v133, v44
v_mul_f32 v134, v134, v44
v_mul_f32 v135, v135, v44
v_mul_f32 v136, v136, v43
v_mul_f32 v137, v137, v43
v_mul_f32 v138, v138, v43
v_mul_f32 v139, v139, v43
v_mul_f32 v140, v140, v44
v_mul_f32 v141, v141, v44
v_mul_f32 v142, v142, v44
v_mul_f32 v143, v143, v44
v_sub_f32 v192, v160, v42
v_exp_f32 v192, v192
v_sub_f32 v193, v161, v42
v_exp_f32 v193, v193
v_sub_f32 v194, v162, v42
v_exp_f32 v194, v194
v_sub_f32 v195, v163, v42
v_exp_f32 v195, v195
v_cvt_pk_bf16_f32 v184, v192, v193
v_sub_f32 v196, v164, v42
v_exp_f32 v196, v196
v_sub_f32 v197, v165, v42
v_exp_f32 v197, v197
v_cvt_pk_bf16_f32 v185, v194, v195
v_sub_f32 v198, v166, v42
v_exp_f32 v198, v198
v_sub_f32 v199, v167, v42
v_exp_f32 v199, v199
v_cvt_pk_bf16_f32 v186, v196, v197
v_sub_f32 v192, v168, v249
v_exp_f32 v192, v192
v_sub_f32 v193, v169, v249
v_exp_f32 v193, v193
v_cvt_pk_bf16_f32 v187, v198, v199
v_sub_f32 v194, v170, v249
v_exp_f32 v194, v194
v_sub_f32 v195, v171, v249
v_exp_f32 v195, v195
v_cvt_pk_bf16_f32 v188, v192, v193
v_sub_f32 v196, v172, v249
v_exp_f32 v196, v196
v_sub_f32 v197, v173, v249
v_exp_f32 v197, v197
v_cvt_pk_bf16_f32 v189, v194, v195
v_sub_f32 v198, v174, v249
v_exp_f32 v198, v198
v_sub_f32 v199, v175, v249
v_exp_f32 v199, v199
v_cvt_pk_bf16_f32 v190, v196, v197
v_cvt_pk_bf16_f32 v191, v198, v199
v_sub_f32 v144, v144, v42
v_sub_f32 v145, v145, v42
v_sub_f32 v146, v146, v42
v_sub_f32 v147, v147, v42
v_sub_f32 v148, v148, v42
v_sub_f32 v149, v149, v42
v_sub_f32 v150, v150, v42
v_sub_f32 v151, v151, v42
v_sub_f32 v152, v152, v249
v_sub_f32 v153, v153, v249
v_sub_f32 v154, v154, v249
v_sub_f32 v155, v155, v249
v_sub_f32 v156, v156, v249
v_sub_f32 v157, v157, v249
v_sub_f32 v158, v158, v249
v_sub_f32 v159, v159, v249
s_nop 1
s_branch L_back3
L_slow4:
s_nop 15
v_max3_f32 v42, v144, v145, v146
v_max3_f32 v42, v42, v147, v148
v_max3_f32 v42, v42, v149, v150
v_max_f32 v42, v42, v151
v_max3_f32 v249, v152, v153, v154
v_max3_f32 v249, v249, v155, v156
v_max3_f32 v249, v249, v157, v158
v_max_f32 v249, v249, v159
s_nop 1
v_permlane16_swap_b32 v42, v249
v_max_f32 v42, v42, v249
v_mov_b32 v249, v42
s_nop 1
v_permlane32_swap_b32 v42, v249
v_max_f32 v42, v42, v249
v_add_f32 v42, 0x42000000, v42
v_max_f32 v42, 0, v42
v_mov_b32 v249, v42
s_nop 1
v_permlane16_swap_b32 v42, v249
v_sub_f32 v43, 0, v42
v_exp_f32 v43, v43
v_sub_f32 v44, 0, v249
v_exp_f32 v44, v44
v_sub_f32 v240, v240, v42
v_sub_f32 v241, v241, v42
v_sub_f32 v242, v242, v42
v_sub_f32 v243, v243, v42
v_sub_f32 v244, v244, v249
v_sub_f32 v245, v245, v249
v_sub_f32 v246, v246, v249
v_sub_f32 v247, v247, v249
v_mul_f32 v204, v204, v43
v_mul_f32 v252, v252, v44
v_mul_f32 v80, v80, v43
v_mul_f32 v81, v81, v43
v_mul_f32 v82, v82, v43
v_mul_f32 v83, v83, v43
v_mul_f32 v84, v84, v44
v_mul_f32 v85, v85, v44
v_mul_f32 v86, v86, v44
v_mul_f32 v87, v87, v44
v_mul_f32 v88, v88, v43
v_mul_f32 v89, v89, v43
v_mul_f32 v90, v90, v43
v_mul_f32 v91, v91, v43
v_mul_f32 v92, v92, v44
v_mul_f32 v93, v93, v44
v_mul_f32 v94, v94, v44
v_mul_f32 v95, v95, v44
v_mul_f32 v96, v96, v43
v_mul_f32 v97, v97, v43
v_mul_f32 v98, v98, v43
v_mul_f32 v99, v99, v43
v_mul_f32 v100, v100, v44
v_mul_f32 v101, v101, v44
v_mul_f32 v102, v102, v44
v_mul_f32 v103, v103, v44
v_mul_f32 v104, v104, v43
v_mul_f32 v105, v105, v43
v_mul_f32 v106, v106, v43
v_mul_f32 v107, v107, v43
v_mul_f32 v108, v108, v44
v_mul_f32 v109, v109, v44
v_mul_f32 v110, v110, v44
v_mul_f32 v111, v111, v44
v_mul_f32 v112, v112, v43
v_mul_f32 v113, v113, v43
v_mul_f32 v114, v114, v43
v_mul_f32 v115, v115, v43
v_mul_f32 v116, v116, v44
v_mul_f32 v117, v117, v44
v_mul_f32 v118, v118, v44
v_mul_f32 v119, v119, v44
v_mul_f32 v120, v120, v43
v_mul_f32 v121, v121, v43
v_mul_f32 v122, v122, v43
v_mul_f32 v123, v123, v43
v_mul_f32 v124, v124, v44
v_mul_f32 v125, v125, v44
v_mul_f32 v126, v126, v44
v_mul_f32 v127, v127, v44
v_mul_f32 v128, v128, v43
v_mul_f32 v129, v129, v43
v_mul_f32 v130, v130, v43
v_mul_f32 v131, v131, v43
v_mul_f32 v132, v132, v44
v_mul_f32 v133, v133, v44
v_mul_f32 v134, v134, v44
v_mul_f32 v135, v135, v44
v_mul_f32 v136, v136, v43
v_mul_f32 v137, v137, v43
v_mul_f32 v138, v138, v43
v_mul_f32 v139, v139, v43
v_mul_f32 v140, v140, v44
v_mul_f32 v141, v141, v44
v_mul_f32 v142, v142, v44
v_mul_f32 v143, v143, v44
v_sub_f32 v192, v144, v42
v_exp_f32 v192, v192
v_sub_f32 v193, v145, v42
v_exp_f32 v193, v193
v_sub_f32 v194, v146, v42
v_exp_f32 v194, v194
v_sub_f32 v195, v147, v42
v_exp_f32 v195, v195
v_cvt_pk_bf16_f32 v176, v192, v193
v_sub_f32 v196, v148, v42
v_exp_f32 v196, v196
v_sub_f32 v197, v149, v42
v_exp_f32 v197, v197
v_cvt_pk_bf16_f32 v177, v194, v195
v_sub_f32 v198, v150, v42
v_exp_f32 v198, v198
v_sub_f32 v199, v151, v42
v_exp_f32 v199, v199
v_cvt_pk_bf16_f32 v178, v196, v197
v_sub_f32 v192, v152, v249
v_exp_f32 v192, v192
v_sub_f32 v193, v153, v249
v_exp_f32 v193, v193
v_cvt_pk_bf16_f32 v179, v198, v199
v_sub_f32 v194, v154, v249
v_exp_f32 v194, v194
v_sub_f32 v195, v155, v249
v_exp_f32 v195, v195
v_cvt_pk_bf16_f32 v180, v192, v193
v_sub_f32 v196, v156, v249
v_exp_f32 v196, v196
v_sub_f32 v197, v157, v249
v_exp_f32 v197, v197
v_cvt_pk_bf16_f32 v181, v194, v195
v_sub_f32 v198, v158, v249
v_exp_f32 v198, v198
v_sub_f32 v199, v159, v249
v_exp_f32 v199, v199
v_cvt_pk_bf16_f32 v182, v196, v197
v_cvt_pk_bf16_f32 v183, v198, v199
v_sub_f32 v160, v160, v42
v_sub_f32 v161, v161, v42
v_sub_f32 v162, v162, v42
v_sub_f32 v163, v163, v42
v_sub_f32 v164, v164, v42
v_sub_f32 v165, v165, v42
v_sub_f32 v166, v166, v42
v_sub_f32 v167, v167, v42
v_sub_f32 v168, v168, v249
v_sub_f32 v169, v169, v249
v_sub_f32 v170, v170, v249
v_sub_f32 v171, v171, v249
v_sub_f32 v172, v172, v249
v_sub_f32 v173, v173, v249
v_sub_f32 v174, v174, v249
v_sub_f32 v175, v175, v249
s_nop 1
s_branch L_back4
L_slow5:
s_nop 15
v_max3_f32 v42, v160, v161, v162
v_max3_f32 v42, v42, v163, v164
v_max3_f32 v42, v42, v165, v166
v_max_f32 v42, v42, v167
v_max3_f32 v249, v168, v169, v170
v_max3_f32 v249, v249, v171, v172
v_max3_f32 v249, v249, v173, v174
v_max_f32 v249, v249, v175
s_nop 1
v_permlane16_swap_b32 v42, v249
v_max_f32 v42, v42, v249
v_mov_b32 v249, v42
s_nop 1
v_permlane32_swap_b32 v42, v249
v_max_f32 v42, v42, v249
v_add_f32 v42, 0x42000000, v42
v_max_f32 v42, 0, v42
v_mov_b32 v249, v42
s_nop 1
v_permlane16_swap_b32 v42, v249
v_sub_f32 v43, 0, v42
v_exp_f32 v43, v43
v_sub_f32 v44, 0, v249
v_exp_f32 v44, v44
v_sub_f32 v240, v240, v42
v_sub_f32 v241, v241, v42
v_sub_f32 v242, v242, v42
v_sub_f32 v243, v243, v42
v_sub_f32 v244, v244, v249
v_sub_f32 v245, v245, v249
v_sub_f32 v246, v246, v249
v_sub_f32 v247, v247, v249
v_mul_f32 v204, v204, v43
v_mul_f32 v252, v252, v44
v_mul_f32 v80, v80, v43
v_mul_f32 v81, v81, v43
v_mul_f32 v82, v82, v43
v_mul_f32 v83, v83, v43
v_mul_f32 v84, v84, v44
v_mul_f32 v85, v85, v44
v_mul_f32 v86, v86, v44
v_mul_f32 v87, v87, v44
v_mul_f32 v88, v88, v43
v_mul_f32 v89, v89, v43
v_mul_f32 v90, v90, v43
v_mul_f32 v91, v91, v43
v_mul_f32 v92, v92, v44
v_mul_f32 v93, v93, v44
v_mul_f32 v94, v94, v44
v_mul_f32 v95, v95, v44
v_mul_f32 v96, v96, v43
v_mul_f32 v97, v97, v43
v_mul_f32 v98, v98, v43
v_mul_f32 v99, v99, v43
v_mul_f32 v100, v100, v44
v_mul_f32 v101, v101, v44
v_mul_f32 v102, v102, v44
v_mul_f32 v103, v103, v44
v_mul_f32 v104, v104, v43
v_mul_f32 v105, v105, v43
v_mul_f32 v106, v106, v43
v_mul_f32 v107, v107, v43
v_mul_f32 v108, v108, v44
v_mul_f32 v109, v109, v44
v_mul_f32 v110, v110, v44
v_mul_f32 v111, v111, v44
v_mul_f32 v112, v112, v43
v_mul_f32 v113, v113, v43
v_mul_f32 v114, v114, v43
v_mul_f32 v115, v115, v43
v_mul_f32 v116, v116, v44
v_mul_f32 v117, v117, v44
v_mul_f32 v118, v118, v44
v_mul_f32 v119, v119, v44
v_mul_f32 v120, v120, v43
v_mul_f32 v121, v121, v43
v_mul_f32 v122, v122, v43
v_mul_f32 v123, v123, v43
v_mul_f32 v124, v124, v44
v_mul_f32 v125, v125, v44
v_mul_f32 v126, v126, v44
v_mul_f32 v127, v127, v44
v_mul_f32 v128, v128, v43
v_mul_f32 v129, v129, v43
v_mul_f32 v130, v130, v43
v_mul_f32 v131, v131, v43
v_mul_f32 v132, v132, v44
v_mul_f32 v133, v133, v44
v_mul_f32 v134, v134, v44
v_mul_f32 v135, v135, v44
v_mul_f32 v136, v136, v43
v_mul_f32 v137, v137, v43
v_mul_f32 v138, v138, v43
v_mul_f32 v139, v139, v43
v_mul_f32 v140, v140, v44
v_mul_f32 v141, v141, v44
v_mul_f32 v142, v142, v44
v_mul_f32 v143, v143, v44
v_sub_f32 v192, v160, v42
v_exp_f32 v192, v192
v_sub_f32 v193, v161, v42
v_exp_f32 v193, v193
v_sub_f32 v194, v162, v42
v_exp_f32 v194, v194
v_sub_f32 v195, v163, v42
v_exp_f32 v195, v195
v_cvt_pk_bf16_f32 v184, v192, v193
v_sub_f32 v196, v164, v42
v_exp_f32 v196, v196
v_sub_f32 v197, v165, v42
v_exp_f32 v197, v197
v_cvt_pk_bf16_f32 v185, v194, v195
v_sub_f32 v198, v166, v42
v_exp_f32 v198, v198
v_sub_f32 v199, v167, v42
v_exp_f32 v199, v199
v_cvt_pk_bf16_f32 v186, v196, v197
v_sub_f32 v192, v168, v249
v_exp_f32 v192, v192
v_sub_f32 v193, v169, v249
v_exp_f32 v193, v193
v_cvt_pk_bf16_f32 v187, v198, v199
v_sub_f32 v194, v170, v249
v_exp_f32 v194, v194
v_sub_f32 v195, v171, v249
v_exp_f32 v195, v195
v_cvt_pk_bf16_f32 v188, v192, v193
v_sub_f32 v196, v172, v249
v_exp_f32 v196, v196
v_sub_f32 v197, v173, v249
v_exp_f32 v197, v197
v_cvt_pk_bf16_f32 v189, v194, v195
v_sub_f32 v198, v174, v249
v_exp_f32 v198, v198
v_sub_f32 v199, v175, v249
v_exp_f32 v199, v199
v_cvt_pk_bf16_f32 v190, v196, v197
v_cvt_pk_bf16_f32 v191, v198, v199
v_sub_f32 v144, v144, v42
v_sub_f32 v145, v145, v42
v_sub_f32 v146, v146, v42
v_sub_f32 v147, v147, v42
v_sub_f32 v148, v148, v42
v_sub_f32 v149, v149, v42
v_sub_f32 v150, v150, v42
v_sub_f32 v151, v151, v42
v_sub_f32 v152, v152, v249
v_sub_f32 v153, v153, v249
v_sub_f32 v154, v154, v249
v_sub_f32 v155, v155, v249
v_sub_f32 v156, v156, v249
v_sub_f32 v157, v157, v249
v_sub_f32 v158, v158, v249
v_sub_f32 v159, v159, v249
s_nop 1
s_branch L_back5
L_slow6:
s_nop 15
v_max3_f32 v42, v144, v145, v146
v_max3_f32 v42, v42, v147, v148
v_max3_f32 v42, v42, v149, v150
v_max_f32 v42, v42, v151
v_max3_f32 v249, v152, v153, v154
v_max3_f32 v249, v249, v155, v156
v_max3_f32 v249, v249, v157, v158
v_max_f32 v249, v249, v159
s_nop 1
v_permlane16_swap_b32 v42, v249
v_max_f32 v42, v42, v249
v_mov_b32 v249, v42
s_nop 1
v_permlane32_swap_b32 v42, v249
v_max_f32 v42, v42, v249
v_add_f32 v42, 0x42000000, v42
v_max_f32 v42, 0, v42
v_mov_b32 v249, v42
s_nop 1
v_permlane16_swap_b32 v42, v249
v_sub_f32 v43, 0, v42
v_exp_f32 v43, v43
v_sub_f32 v44, 0, v249
v_exp_f32 v44, v44
v_sub_f32 v240, v240, v42
v_sub_f32 v241, v241, v42
v_sub_f32 v242, v242, v42
v_sub_f32 v243, v243, v42
v_sub_f32 v244, v244, v249
v_sub_f32 v245, v245, v249
v_sub_f32 v246, v246, v249
v_sub_f32 v247, v247, v249
v_mul_f32 v204, v204, v43
v_mul_f32 v252, v252, v44
v_mul_f32 v80, v80, v43
v_mul_f32 v81, v81, v43
v_mul_f32 v82, v82, v43
v_mul_f32 v83, v83, v43
v_mul_f32 v84, v84, v44
v_mul_f32 v85, v85, v44
v_mul_f32 v86, v86, v44
v_mul_f32 v87, v87, v44
v_mul_f32 v88, v88, v43
v_mul_f32 v89, v89, v43
v_mul_f32 v90, v90, v43
v_mul_f32 v91, v91, v43
v_mul_f32 v92, v92, v44
v_mul_f32 v93, v93, v44
v_mul_f32 v94, v94, v44
v_mul_f32 v95, v95, v44
v_mul_f32 v96, v96, v43
v_mul_f32 v97, v97, v43
v_mul_f32 v98, v98, v43
v_mul_f32 v99, v99, v43
v_mul_f32 v100, v100, v44
v_mul_f32 v101, v101, v44
v_mul_f32 v102, v102, v44
v_mul_f32 v103, v103, v44
v_mul_f32 v104, v104, v43
v_mul_f32 v105, v105, v43
v_mul_f32 v106, v106, v43
v_mul_f32 v107, v107, v43
v_mul_f32 v108, v108, v44
v_mul_f32 v109, v109, v44
v_mul_f32 v110, v110, v44
v_mul_f32 v111, v111, v44
v_mul_f32 v112, v112, v43
v_mul_f32 v113, v113, v43
v_mul_f32 v114, v114, v43
v_mul_f32 v115, v115, v43
v_mul_f32 v116, v116, v44
v_mul_f32 v117, v117, v44
v_mul_f32 v118, v118, v44
v_mul_f32 v119, v119, v44
v_mul_f32 v120, v120, v43
v_mul_f32 v121, v121, v43
v_mul_f32 v122, v122, v43
v_mul_f32 v123, v123, v43
v_mul_f32 v124, v124, v44
v_mul_f32 v125, v125, v44
v_mul_f32 v126, v126, v44
v_mul_f32 v127, v127, v44
v_mul_f32 v128, v128, v43
v_mul_f32 v129, v129, v43
v_mul_f32 v130, v130, v43
v_mul_f32 v131, v131, v43
v_mul_f32 v132, v132, v44
v_mul_f32 v133, v133, v44
v_mul_f32 v134, v134, v44
v_mul_f32 v135, v135, v44
v_mul_f32 v136, v136, v43
v_mul_f32 v137, v137, v43
v_mul_f32 v138, v138, v43
v_mul_f32 v139, v139, v43
v_mul_f32 v140, v140, v44
v_mul_f32 v141, v141, v44
v_mul_f32 v142, v142, v44
v_mul_f32 v143, v143, v44
v_sub_f32 v192, v144, v42
v_exp_f32 v192, v192
v_sub_f32 v193, v145, v42
v_exp_f32 v193, v193
v_sub_f32 v194, v146, v42
v_exp_f32 v194, v194
v_sub_f32 v195, v147, v42
v_exp_f32 v195, v195
v_cvt_pk_bf16_f32 v176, v192, v193
v_sub_f32 v196, v148, v42
v_exp_f32 v196, v196
v_sub_f32 v197, v149, v42
v_exp_f32 v197, v197
v_cvt_pk_bf16_f32 v177, v194, v195
v_sub_f32 v198, v150, v42
v_exp_f32 v198, v198
v_sub_f32 v199, v151, v42
v_exp_f32 v199, v199
v_cvt_pk_bf16_f32 v178, v196, v197
v_sub_f32 v192, v152, v249
v_exp_f32 v192, v192
v_sub_f32 v193, v153, v249
v_exp_f32 v193, v193
v_cvt_pk_bf16_f32 v179, v198, v199
v_sub_f32 v194, v154, v249
v_exp_f32 v194, v194
v_sub_f32 v195, v155, v249
v_exp_f32 v195, v195
v_cvt_pk_bf16_f32 v180, v192, v193
v_sub_f32 v196, v156, v249
v_exp_f32 v196, v196
v_sub_f32 v197, v157, v249
v_exp_f32 v197, v197
v_cvt_pk_bf16_f32 v181, v194, v195
v_sub_f32 v198, v158, v249
v_exp_f32 v198, v198
v_sub_f32 v199, v159, v249
v_exp_f32 v199, v199
v_cvt_pk_bf16_f32 v182, v196, v197
v_cvt_pk_bf16_f32 v183, v198, v199
v_sub_f32 v160, v160, v42
v_sub_f32 v161, v161, v42
v_sub_f32 v162, v162, v42
v_sub_f32 v163, v163, v42
v_sub_f32 v164, v164, v42
v_sub_f32 v165, v165, v42
v_sub_f32 v166, v166, v42
v_sub_f32 v167, v167, v42
v_sub_f32 v168, v168, v249
v_sub_f32 v169, v169, v249
v_sub_f32 v170, v170, v249
v_sub_f32 v171, v171, v249
v_sub_f32 v172, v172, v249
v_sub_f32 v173, v173, v249
v_sub_f32 v174, v174, v249
v_sub_f32 v175, v175, v249
s_nop 1
s_branch L_back6
L_slow7:
s_nop 15
v_max3_f32 v42, v160, v161, v162
v_max3_f32 v42, v42, v163, v164
v_max3_f32 v42, v42, v165, v166
v_max_f32 v42, v42, v167
v_max3_f32 v249, v168, v169, v170
v_max3_f32 v249, v249, v171, v172
v_max3_f32 v249, v249, v173, v174
v_max_f32 v249, v249, v175
s_nop 1
v_permlane16_swap_b32 v42, v249
v_max_f32 v42, v42, v249
v_mov_b32 v249, v42
s_nop 1
v_permlane32_swap_b32 v42, v249
v_max_f32 v42, v42, v249
v_add_f32 v42, 0x42000000, v42
v_max_f32 v42, 0, v42
v_mov_b32 v249, v42
s_nop 1
v_permlane16_swap_b32 v42, v249
v_sub_f32 v43, 0, v42
v_exp_f32 v43, v43
v_sub_f32 v44, 0, v249
v_exp_f32 v44, v44
v_sub_f32 v240, v240, v42
v_sub_f32 v241, v241, v42
v_sub_f32 v242, v242, v42
v_sub_f32 v243, v243, v42
v_sub_f32 v244, v244, v249
v_sub_f32 v245, v245, v249
v_sub_f32 v246, v246, v249
v_sub_f32 v247, v247, v249
v_mul_f32 v204, v204, v43
v_mul_f32 v252, v252, v44
v_mul_f32 v80, v80, v43
v_mul_f32 v81, v81, v43
v_mul_f32 v82, v82, v43
v_mul_f32 v83, v83, v43
v_mul_f32 v84, v84, v44
v_mul_f32 v85, v85, v44
v_mul_f32 v86, v86, v44
v_mul_f32 v87, v87, v44
v_mul_f32 v88, v88, v43
v_mul_f32 v89, v89, v43
v_mul_f32 v90, v90, v43
v_mul_f32 v91, v91, v43
v_mul_f32 v92, v92, v44
v_mul_f32 v93, v93, v44
v_mul_f32 v94, v94, v44
v_mul_f32 v95, v95, v44
v_mul_f32 v96, v96, v43
v_mul_f32 v97, v97, v43
v_mul_f32 v98, v98, v43
v_mul_f32 v99, v99, v43
v_mul_f32 v100, v100, v44
v_mul_f32 v101, v101, v44
v_mul_f32 v102, v102, v44
v_mul_f32 v103, v103, v44
v_mul_f32 v104, v104, v43
v_mul_f32 v105, v105, v43
v_mul_f32 v106, v106, v43
v_mul_f32 v107, v107, v43
v_mul_f32 v108, v108, v44
v_mul_f32 v109, v109, v44
v_mul_f32 v110, v110, v44
v_mul_f32 v111, v111, v44
v_mul_f32 v112, v112, v43
v_mul_f32 v113, v113, v43
v_mul_f32 v114, v114, v43
v_mul_f32 v115, v115, v43
v_mul_f32 v116, v116, v44
v_mul_f32 v117, v117, v44
v_mul_f32 v118, v118, v44
v_mul_f32 v119, v119, v44
v_mul_f32 v120, v120, v43
v_mul_f32 v121, v121, v43
v_mul_f32 v122, v122, v43
v_mul_f32 v123, v123, v43
v_mul_f32 v124, v124, v44
v_mul_f32 v125, v125, v44
v_mul_f32 v126, v126, v44
v_mul_f32 v127, v127, v44
v_mul_f32 v128, v128, v43
v_mul_f32 v129, v129, v43
v_mul_f32 v130, v130, v43
v_mul_f32 v131, v131, v43
v_mul_f32 v132, v132, v44
v_mul_f32 v133, v133, v44
v_mul_f32 v134, v134, v44
v_mul_f32 v135, v135, v44
v_mul_f32 v136, v136, v43
v_mul_f32 v137, v137, v43
v_mul_f32 v138, v138, v43
v_mul_f32 v139, v139, v43
v_mul_f32 v140, v140, v44
v_mul_f32 v141, v141, v44
v_mul_f32 v142, v142, v44
v_mul_f32 v143, v143, v44
v_sub_f32 v192, v160, v42
v_exp_f32 v192, v192
v_sub_f32 v193, v161, v42
v_exp_f32 v193, v193
v_sub_f32 v194, v162, v42
v_exp_f32 v194, v194
v_sub_f32 v195, v163, v42
v_exp_f32 v195, v195
v_cvt_pk_bf16_f32 v184, v192, v193
v_sub_f32 v196, v164, v42
v_exp_f32 v196, v196
v_sub_f32 v197, v165, v42
v_exp_f32 v197, v197
v_cvt_pk_bf16_f32 v185, v194, v195
v_sub_f32 v198, v166, v42
v_exp_f32 v198, v198
v_sub_f32 v199, v167, v42
v_exp_f32 v199, v199
v_cvt_pk_bf16_f32 v186, v196, v197
v_sub_f32 v192, v168, v249
v_exp_f32 v192, v192
v_sub_f32 v193, v169, v249
v_exp_f32 v193, v193
v_cvt_pk_bf16_f32 v187, v198, v199
v_sub_f32 v194, v170, v249
v_exp_f32 v194, v194
v_sub_f32 v195, v171, v249
v_exp_f32 v195, v195
v_cvt_pk_bf16_f32 v188, v192, v193
v_sub_f32 v196, v172, v249
v_exp_f32 v196, v196
v_sub_f32 v197, v173, v249
v_exp_f32 v197, v197
v_cvt_pk_bf16_f32 v189, v194, v195
v_sub_f32 v198, v174, v249
v_exp_f32 v198, v198
v_sub_f32 v199, v175, v249
v_exp_f32 v199, v199
v_cvt_pk_bf16_f32 v190, v196, v197
v_cvt_pk_bf16_f32 v191, v198, v199
v_sub_f32 v144, v144, v42
v_sub_f32 v145, v145, v42
v_sub_f32 v146, v146, v42
v_sub_f32 v147, v147, v42
v_sub_f32 v148, v148, v42
v_sub_f32 v149, v149, v42
v_sub_f32 v150, v150, v42
v_sub_f32 v151, v151, v42
v_sub_f32 v152, v152, v249
v_sub_f32 v153, v153, v249
v_sub_f32 v154, v154, v249
v_sub_f32 v155, v155, v249
v_sub_f32 v156, v156, v249
v_sub_f32 v157, v157, v249
v_sub_f32 v158, v158, v249
v_sub_f32 v159, v159, v249
s_nop 1
s_branch L_back7
L_slow8:
s_nop 15
v_max3_f32 v42, v144, v145, v146
v_max3_f32 v42, v42, v147, v148
v_max3_f32 v42, v42, v149, v150
v_max_f32 v42, v42, v151
v_max3_f32 v249, v152, v153, v154
v_max3_f32 v249, v249, v155, v156
v_max3_f32 v249, v249, v157, v158
v_max_f32 v249, v249, v159
s_nop 1
v_permlane16_swap_b32 v42, v249
v_max_f32 v42, v42, v249
v_mov_b32 v249, v42
s_nop 1
v_permlane32_swap_b32 v42, v249
v_max_f32 v42, v42, v249
v_add_f32 v42, 0x42000000, v42
v_max_f32 v42, 0, v42
v_mov_b32 v249, v42
s_nop 1
v_permlane16_swap_b32 v42, v249
v_sub_f32 v43, 0, v42
v_exp_f32 v43, v43
v_sub_f32 v44, 0, v249
v_exp_f32 v44, v44
v_sub_f32 v240, v240, v42
v_sub_f32 v241, v241, v42
v_sub_f32 v242, v242, v42
v_sub_f32 v243, v243, v42
v_sub_f32 v244, v244, v249
v_sub_f32 v245, v245, v249
v_sub_f32 v246, v246, v249
v_sub_f32 v247, v247, v249
v_mul_f32 v204, v204, v43
v_mul_f32 v252, v252, v44
v_mul_f32 v80, v80, v43
v_mul_f32 v81, v81, v43
v_mul_f32 v82, v82, v43
v_mul_f32 v83, v83, v43
v_mul_f32 v84, v84, v44
v_mul_f32 v85, v85, v44
v_mul_f32 v86, v86, v44
v_mul_f32 v87, v87, v44
v_mul_f32 v88, v88, v43
v_mul_f32 v89, v89, v43
v_mul_f32 v90, v90, v43
v_mul_f32 v91, v91, v43
v_mul_f32 v92, v92, v44
v_mul_f32 v93, v93, v44
v_mul_f32 v94, v94, v44
v_mul_f32 v95, v95, v44
v_mul_f32 v96, v96, v43
v_mul_f32 v97, v97, v43
v_mul_f32 v98, v98, v43
v_mul_f32 v99, v99, v43
v_mul_f32 v100, v100, v44
v_mul_f32 v101, v101, v44
v_mul_f32 v102, v102, v44
v_mul_f32 v103, v103, v44
v_mul_f32 v104, v104, v43
v_mul_f32 v105, v105, v43
v_mul_f32 v106, v106, v43
v_mul_f32 v107, v107, v43
v_mul_f32 v108, v108, v44
v_mul_f32 v109, v109, v44
v_mul_f32 v110, v110, v44
v_mul_f32 v111, v111, v44
v_mul_f32 v112, v112, v43
v_mul_f32 v113, v113, v43
v_mul_f32 v114, v114, v43
v_mul_f32 v115, v115, v43
v_mul_f32 v116, v116, v44
v_mul_f32 v117, v117, v44
v_mul_f32 v118, v118, v44
v_mul_f32 v119, v119, v44
v_mul_f32 v120, v120, v43
v_mul_f32 v121, v121, v43
v_mul_f32 v122, v122, v43
v_mul_f32 v123, v123, v43
v_mul_f32 v124, v124, v44
v_mul_f32 v125, v125, v44
v_mul_f32 v126, v126, v44
v_mul_f32 v127, v127, v44
v_mul_f32 v128, v128, v43
v_mul_f32 v129, v129, v43
v_mul_f32 v130, v130, v43
v_mul_f32 v131, v131, v43
v_mul_f32 v132, v132, v44
v_mul_f32 v133, v133, v44
v_mul_f32 v134, v134, v44
v_mul_f32 v135, v135, v44
v_mul_f32 v136, v136, v43
v_mul_f32 v137, v137, v43
v_mul_f32 v138, v138, v43
v_mul_f32 v139, v139, v43
v_mul_f32 v140, v140, v44
v_mul_f32 v141, v141, v44
v_mul_f32 v142, v142, v44
v_mul_f32 v143, v143, v44
v_sub_f32 v192, v144, v42
v_exp_f32 v192, v192
v_sub_f32 v193, v145, v42
v_exp_f32 v193, v193
v_sub_f32 v194, v146, v42
v_exp_f32 v194, v194
v_sub_f32 v195, v147, v42
v_exp_f32 v195, v195
v_cvt_pk_bf16_f32 v176, v192, v193
v_sub_f32 v196, v148, v42
v_exp_f32 v196, v196
v_sub_f32 v197, v149, v42
v_exp_f32 v197, v197
v_cvt_pk_bf16_f32 v177, v194, v195
v_sub_f32 v198, v150, v42
v_exp_f32 v198, v198
v_sub_f32 v199, v151, v42
v_exp_f32 v199, v199
v_cvt_pk_bf16_f32 v178, v196, v197
v_sub_f32 v192, v152, v249
v_exp_f32 v192, v192
v_sub_f32 v193, v153, v249
v_exp_f32 v193, v193
v_cvt_pk_bf16_f32 v179, v198, v199
v_sub_f32 v194, v154, v249
v_exp_f32 v194, v194
v_sub_f32 v195, v155, v249
v_exp_f32 v195, v195
v_cvt_pk_bf16_f32 v180, v192, v193
v_sub_f32 v196, v156, v249
v_exp_f32 v196, v196
v_sub_f32 v197, v157, v249
v_exp_f32 v197, v197
v_cvt_pk_bf16_f32 v181, v194, v195
v_sub_f32 v198, v158, v249
v_exp_f32 v198, v198
v_sub_f32 v199, v159, v249
v_exp_f32 v199, v199
v_cvt_pk_bf16_f32 v182, v196, v197
v_cvt_pk_bf16_f32 v183, v198, v199
v_sub_f32 v160, v160, v42
v_sub_f32 v161, v161, v42
v_sub_f32 v162, v162, v42
v_sub_f32 v163, v163, v42
v_sub_f32 v164, v164, v42
v_sub_f32 v165, v165, v42
v_sub_f32 v166, v166, v42
v_sub_f32 v167, v167, v42
v_sub_f32 v168, v168, v249
v_sub_f32 v169, v169, v249
v_sub_f32 v170, v170, v249
v_sub_f32 v171, v171, v249
v_sub_f32 v172, v172, v249
v_sub_f32 v173, v173, v249
v_sub_f32 v174, v174, v249
v_sub_f32 v175, v175, v249
s_nop 1
s_branch L_back8
L_slow9:
s_nop 15
v_max3_f32 v42, v160, v161, v162
v_max3_f32 v42, v42, v163, v164
v_max3_f32 v42, v42, v165, v166
v_max_f32 v42, v42, v167
v_max3_f32 v249, v168, v169, v170
v_max3_f32 v249, v249, v171, v172
v_max3_f32 v249, v249, v173, v174
v_max_f32 v249, v249, v175
s_nop 1
v_permlane16_swap_b32 v42, v249
v_max_f32 v42, v42, v249
v_mov_b32 v249, v42
s_nop 1
v_permlane32_swap_b32 v42, v249
v_max_f32 v42, v42, v249
v_add_f32 v42, 0x42000000, v42
v_max_f32 v42, 0, v42
v_mov_b32 v249, v42
s_nop 1
v_permlane16_swap_b32 v42, v249
v_sub_f32 v43, 0, v42
v_exp_f32 v43, v43
v_sub_f32 v44, 0, v249
v_exp_f32 v44, v44
v_sub_f32 v240, v240, v42
v_sub_f32 v241, v241, v42
v_sub_f32 v242, v242, v42
v_sub_f32 v243, v243, v42
v_sub_f32 v244, v244, v249
v_sub_f32 v245, v245, v249
v_sub_f32 v246, v246, v249
v_sub_f32 v247, v247, v249
v_mul_f32 v204, v204, v43
v_mul_f32 v252, v252, v44
v_mul_f32 v80, v80, v43
v_mul_f32 v81, v81, v43
v_mul_f32 v82, v82, v43
v_mul_f32 v83, v83, v43
v_mul_f32 v84, v84, v44
v_mul_f32 v85, v85, v44
v_mul_f32 v86, v86, v44
v_mul_f32 v87, v87, v44
v_mul_f32 v88, v88, v43
v_mul_f32 v89, v89, v43
v_mul_f32 v90, v90, v43
v_mul_f32 v91, v91, v43
v_mul_f32 v92, v92, v44
v_mul_f32 v93, v93, v44
v_mul_f32 v94, v94, v44
v_mul_f32 v95, v95, v44
v_mul_f32 v96, v96, v43
v_mul_f32 v97, v97, v43
v_mul_f32 v98, v98, v43
v_mul_f32 v99, v99, v43
v_mul_f32 v100, v100, v44
v_mul_f32 v101, v101, v44
v_mul_f32 v102, v102, v44
v_mul_f32 v103, v103, v44
v_mul_f32 v104, v104, v43
v_mul_f32 v105, v105, v43
v_mul_f32 v106, v106, v43
v_mul_f32 v107, v107, v43
v_mul_f32 v108, v108, v44
v_mul_f32 v109, v109, v44
v_mul_f32 v110, v110, v44
v_mul_f32 v111, v111, v44
v_mul_f32 v112, v112, v43
v_mul_f32 v113, v113, v43
v_mul_f32 v114, v114, v43
v_mul_f32 v115, v115, v43
v_mul_f32 v116, v116, v44
v_mul_f32 v117, v117, v44
v_mul_f32 v118, v118, v44
v_mul_f32 v119, v119, v44
v_mul_f32 v120, v120, v43
v_mul_f32 v121, v121, v43
v_mul_f32 v122, v122, v43
v_mul_f32 v123, v123, v43
v_mul_f32 v124, v124, v44
v_mul_f32 v125, v125, v44
v_mul_f32 v126, v126, v44
v_mul_f32 v127, v127, v44
v_mul_f32 v128, v128, v43
v_mul_f32 v129, v129, v43
v_mul_f32 v130, v130, v43
v_mul_f32 v131, v131, v43
v_mul_f32 v132, v132, v44
v_mul_f32 v133, v133, v44
v_mul_f32 v134, v134, v44
v_mul_f32 v135, v135, v44
v_mul_f32 v136, v136, v43
v_mul_f32 v137, v137, v43
v_mul_f32 v138, v138, v43
v_mul_f32 v139, v139, v43
v_mul_f32 v140, v140, v44
v_mul_f32 v141, v141, v44
v_mul_f32 v142, v142, v44
v_mul_f32 v143, v143, v44
v_sub_f32 v192, v160, v42
v_exp_f32 v192, v192
v_sub_f32 v193, v161, v42
v_exp_f32 v193, v193
v_sub_f32 v194, v162, v42
v_exp_f32 v194, v194
v_sub_f32 v195, v163, v42
v_exp_f32 v195, v195
v_cvt_pk_bf16_f32 v184, v192, v193
v_sub_f32 v196, v164, v42
v_exp_f32 v196, v196
v_sub_f32 v197, v165, v42
v_exp_f32 v197, v197
v_cvt_pk_bf16_f32 v185, v194, v195
v_sub_f32 v198, v166, v42
v_exp_f32 v198, v198
v_sub_f32 v199, v167, v42
v_exp_f32 v199, v199
v_cvt_pk_bf16_f32 v186, v196, v197
v_sub_f32 v192, v168, v249
v_exp_f32 v192, v192
v_sub_f32 v193, v169, v249
v_exp_f32 v193, v193
v_cvt_pk_bf16_f32 v187, v198, v199
v_sub_f32 v194, v170, v249
v_exp_f32 v194, v194
v_sub_f32 v195, v171, v249
v_exp_f32 v195, v195
v_cvt_pk_bf16_f32 v188, v192, v193
v_sub_f32 v196, v172, v249
v_exp_f32 v196, v196
v_sub_f32 v197, v173, v249
v_exp_f32 v197, v197
v_cvt_pk_bf16_f32 v189, v194, v195
v_sub_f32 v198, v174, v249
v_exp_f32 v198, v198
v_sub_f32 v199, v175, v249
v_exp_f32 v199, v199
v_cvt_pk_bf16_f32 v190, v196, v197
v_cvt_pk_bf16_f32 v191, v198, v199
v_sub_f32 v144, v144, v42
v_sub_f32 v145, v145, v42
v_sub_f32 v146, v146, v42
v_sub_f32 v147, v147, v42
v_sub_f32 v148, v148, v42
v_sub_f32 v149, v149, v42
v_sub_f32 v150, v150, v42
v_sub_f32 v151, v151, v42
v_sub_f32 v152, v152, v249
v_sub_f32 v153, v153, v249
v_sub_f32 v154, v154, v249
v_sub_f32 v155, v155, v249
v_sub_f32 v156, v156, v249
v_sub_f32 v157, v157, v249
v_sub_f32 v158, v158, v249
v_sub_f32 v159, v159, v249
s_nop 1
s_branch L_back9
L_slow10:
s_nop 15
v_max3_f32 v42, v144, v145, v146
v_max3_f32 v42, v42, v147, v148
v_max3_f32 v42, v42, v149, v150
v_max_f32 v42, v42, v151
v_max3_f32 v249, v152, v153, v154
v_max3_f32 v249, v249, v155, v156
v_max3_f32 v249, v249, v157, v158
v_max_f32 v249, v249, v159
s_nop 1
v_permlane16_swap_b32 v42, v249
v_max_f32 v42, v42, v249
v_mov_b32 v249, v42
s_nop 1
v_permlane32_swap_b32 v42, v249
v_max_f32 v42, v42, v249
v_add_f32 v42, 0x42000000, v42
v_max_f32 v42, 0, v42
v_mov_b32 v249, v42
s_nop 1
v_permlane16_swap_b32 v42, v249
v_sub_f32 v43, 0, v42
v_exp_f32 v43, v43
v_sub_f32 v44, 0, v249
v_exp_f32 v44, v44
v_sub_f32 v240, v240, v42
v_sub_f32 v241, v241, v42
v_sub_f32 v242, v242, v42
v_sub_f32 v243, v243, v42
v_sub_f32 v244, v244, v249
v_sub_f32 v245, v245, v249
v_sub_f32 v246, v246, v249
v_sub_f32 v247, v247, v249
v_mul_f32 v204, v204, v43
v_mul_f32 v252, v252, v44
v_mul_f32 v80, v80, v43
v_mul_f32 v81, v81, v43
v_mul_f32 v82, v82, v43
v_mul_f32 v83, v83, v43
v_mul_f32 v84, v84, v44
v_mul_f32 v85, v85, v44
v_mul_f32 v86, v86, v44
v_mul_f32 v87, v87, v44
v_mul_f32 v88, v88, v43
v_mul_f32 v89, v89, v43
v_mul_f32 v90, v90, v43
v_mul_f32 v91, v91, v43
v_mul_f32 v92, v92, v44
v_mul_f32 v93, v93, v44
v_mul_f32 v94, v94, v44
v_mul_f32 v95, v95, v44
v_mul_f32 v96, v96, v43
v_mul_f32 v97, v97, v43
v_mul_f32 v98, v98, v43
v_mul_f32 v99, v99, v43
v_mul_f32 v100, v100, v44
v_mul_f32 v101, v101, v44
v_mul_f32 v102, v102, v44
v_mul_f32 v103, v103, v44
v_mul_f32 v104, v104, v43
v_mul_f32 v105, v105, v43
v_mul_f32 v106, v106, v43
v_mul_f32 v107, v107, v43
v_mul_f32 v108, v108, v44
v_mul_f32 v109, v109, v44
v_mul_f32 v110, v110, v44
v_mul_f32 v111, v111, v44
v_mul_f32 v112, v112, v43
v_mul_f32 v113, v113, v43
v_mul_f32 v114, v114, v43
v_mul_f32 v115, v115, v43
v_mul_f32 v116, v116, v44
v_mul_f32 v117, v117, v44
v_mul_f32 v118, v118, v44
v_mul_f32 v119, v119, v44
v_mul_f32 v120, v120, v43
v_mul_f32 v121, v121, v43
v_mul_f32 v122, v122, v43
v_mul_f32 v123, v123, v43
v_mul_f32 v124, v124, v44
v_mul_f32 v125, v125, v44
v_mul_f32 v126, v126, v44
v_mul_f32 v127, v127, v44
v_mul_f32 v128, v128, v43
v_mul_f32 v129, v129, v43
v_mul_f32 v130, v130, v43
v_mul_f32 v131, v131, v43
v_mul_f32 v132, v132, v44
v_mul_f32 v133, v133, v44
v_mul_f32 v134, v134, v44
v_mul_f32 v135, v135, v44
v_mul_f32 v136, v136, v43
v_mul_f32 v137, v137, v43
v_mul_f32 v138, v138, v43
v_mul_f32 v139, v139, v43
v_mul_f32 v140, v140, v44
v_mul_f32 v141, v141, v44
v_mul_f32 v142, v142, v44
v_mul_f32 v143, v143, v44
v_sub_f32 v192, v144, v42
v_exp_f32 v192, v192
v_sub_f32 v193, v145, v42
v_exp_f32 v193, v193
v_sub_f32 v194, v146, v42
v_exp_f32 v194, v194
v_sub_f32 v195, v147, v42
v_exp_f32 v195, v195
v_cvt_pk_bf16_f32 v176, v192, v193
v_sub_f32 v196, v148, v42
v_exp_f32 v196, v196
v_sub_f32 v197, v149, v42
v_exp_f32 v197, v197
v_cvt_pk_bf16_f32 v177, v194, v195
v_sub_f32 v198, v150, v42
v_exp_f32 v198, v198
v_sub_f32 v199, v151, v42
v_exp_f32 v199, v199
v_cvt_pk_bf16_f32 v178, v196, v197
v_sub_f32 v192, v152, v249
v_exp_f32 v192, v192
v_sub_f32 v193, v153, v249
v_exp_f32 v193, v193
v_cvt_pk_bf16_f32 v179, v198, v199
v_sub_f32 v194, v154, v249
v_exp_f32 v194, v194
v_sub_f32 v195, v155, v249
v_exp_f32 v195, v195
v_cvt_pk_bf16_f32 v180, v192, v193
v_sub_f32 v196, v156, v249
v_exp_f32 v196, v196
v_sub_f32 v197, v157, v249
v_exp_f32 v197, v197
v_cvt_pk_bf16_f32 v181, v194, v195
v_sub_f32 v198, v158, v249
v_exp_f32 v198, v198
v_sub_f32 v199, v159, v249
v_exp_f32 v199, v199
v_cvt_pk_bf16_f32 v182, v196, v197
v_cvt_pk_bf16_f32 v183, v198, v199
v_sub_f32 v160, v160, v42
v_sub_f32 v161, v161, v42
v_sub_f32 v162, v162, v42
v_sub_f32 v163, v163, v42
v_sub_f32 v164, v164, v42
v_sub_f32 v165, v165, v42
v_sub_f32 v166, v166, v42
v_sub_f32 v167, v167, v42
v_sub_f32 v168, v168, v249
v_sub_f32 v169, v169, v249
v_sub_f32 v170, v170, v249
v_sub_f32 v171, v171, v249
v_sub_f32 v172, v172, v249
v_sub_f32 v173, v173, v249
v_sub_f32 v174, v174, v249
v_sub_f32 v175, v175, v249
s_nop 1
s_branch L_back10
L_slow11:
s_nop 15
v_max3_f32 v42, v160, v161, v162
v_max3_f32 v42, v42, v163, v164
v_max3_f32 v42, v42, v165, v166
v_max_f32 v42, v42, v167
v_max3_f32 v249, v168, v169, v170
v_max3_f32 v249, v249, v171, v172
v_max3_f32 v249, v249, v173, v174
v_max_f32 v249, v249, v175
s_nop 1
v_permlane16_swap_b32 v42, v249
v_max_f32 v42, v42, v249
v_mov_b32 v249, v42
s_nop 1
v_permlane32_swap_b32 v42, v249
v_max_f32 v42, v42, v249
v_add_f32 v42, 0x42000000, v42
v_max_f32 v42, 0, v42
v_mov_b32 v249, v42
s_nop 1
v_permlane16_swap_b32 v42, v249
v_sub_f32 v43, 0, v42
v_exp_f32 v43, v43
v_sub_f32 v44, 0, v249
v_exp_f32 v44, v44
v_sub_f32 v240, v240, v42
v_sub_f32 v241, v241, v42
v_sub_f32 v242, v242, v42
v_sub_f32 v243, v243, v42
v_sub_f32 v244, v244, v249
v_sub_f32 v245, v245, v249
v_sub_f32 v246, v246, v249
v_sub_f32 v247, v247, v249
v_mul_f32 v204, v204, v43
v_mul_f32 v252, v252, v44
v_mul_f32 v80, v80, v43
v_mul_f32 v81, v81, v43
v_mul_f32 v82, v82, v43
v_mul_f32 v83, v83, v43
v_mul_f32 v84, v84, v44
v_mul_f32 v85, v85, v44
v_mul_f32 v86, v86, v44
v_mul_f32 v87, v87, v44
v_mul_f32 v88, v88, v43
v_mul_f32 v89, v89, v43
v_mul_f32 v90, v90, v43
v_mul_f32 v91, v91, v43
v_mul_f32 v92, v92, v44
v_mul_f32 v93, v93, v44
v_mul_f32 v94, v94, v44
v_mul_f32 v95, v95, v44
v_mul_f32 v96, v96, v43
v_mul_f32 v97, v97, v43
v_mul_f32 v98, v98, v43
v_mul_f32 v99, v99, v43
v_mul_f32 v100, v100, v44
v_mul_f32 v101, v101, v44
v_mul_f32 v102, v102, v44
v_mul_f32 v103, v103, v44
v_mul_f32 v104, v104, v43
v_mul_f32 v105, v105, v43
v_mul_f32 v106, v106, v43
v_mul_f32 v107, v107, v43
v_mul_f32 v108, v108, v44
v_mul_f32 v109, v109, v44
v_mul_f32 v110, v110, v44
v_mul_f32 v111, v111, v44
v_mul_f32 v112, v112, v43
v_mul_f32 v113, v113, v43
v_mul_f32 v114, v114, v43
v_mul_f32 v115, v115, v43
v_mul_f32 v116, v116, v44
v_mul_f32 v117, v117, v44
v_mul_f32 v118, v118, v44
v_mul_f32 v119, v119, v44
v_mul_f32 v120, v120, v43
v_mul_f32 v121, v121, v43
v_mul_f32 v122, v122, v43
v_mul_f32 v123, v123, v43
v_mul_f32 v124, v124, v44
v_mul_f32 v125, v125, v44
v_mul_f32 v126, v126, v44
v_mul_f32 v127, v127, v44
v_mul_f32 v128, v128, v43
v_mul_f32 v129, v129, v43
v_mul_f32 v130, v130, v43
v_mul_f32 v131, v131, v43
v_mul_f32 v132, v132, v44
v_mul_f32 v133, v133, v44
v_mul_f32 v134, v134, v44
v_mul_f32 v135, v135, v44
v_mul_f32 v136, v136, v43
v_mul_f32 v137, v137, v43
v_mul_f32 v138, v138, v43
v_mul_f32 v139, v139, v43
v_mul_f32 v140, v140, v44
v_mul_f32 v141, v141, v44
v_mul_f32 v142, v142, v44
v_mul_f32 v143, v143, v44
v_sub_f32 v192, v160, v42
v_exp_f32 v192, v192
v_sub_f32 v193, v161, v42
v_exp_f32 v193, v193
v_sub_f32 v194, v162, v42
v_exp_f32 v194, v194
v_sub_f32 v195, v163, v42
v_exp_f32 v195, v195
v_cvt_pk_bf16_f32 v184, v192, v193
v_sub_f32 v196, v164, v42
v_exp_f32 v196, v196
v_sub_f32 v197, v165, v42
v_exp_f32 v197, v197
v_cvt_pk_bf16_f32 v185, v194, v195
v_sub_f32 v198, v166, v42
v_exp_f32 v198, v198
v_sub_f32 v199, v167, v42
v_exp_f32 v199, v199
v_cvt_pk_bf16_f32 v186, v196, v197
v_sub_f32 v192, v168, v249
v_exp_f32 v192, v192
v_sub_f32 v193, v169, v249
v_exp_f32 v193, v193
v_cvt_pk_bf16_f32 v187, v198, v199
v_sub_f32 v194, v170, v249
v_exp_f32 v194, v194
v_sub_f32 v195, v171, v249
v_exp_f32 v195, v195
v_cvt_pk_bf16_f32 v188, v192, v193
v_sub_f32 v196, v172, v249
v_exp_f32 v196, v196
v_sub_f32 v197, v173, v249
v_exp_f32 v197, v197
v_cvt_pk_bf16_f32 v189, v194, v195
v_sub_f32 v198, v174, v249
v_exp_f32 v198, v198
v_sub_f32 v199, v175, v249
v_exp_f32 v199, v199
v_cvt_pk_bf16_f32 v190, v196, v197
v_cvt_pk_bf16_f32 v191, v198, v199
v_sub_f32 v144, v144, v42
v_sub_f32 v145, v145, v42
v_sub_f32 v146, v146, v42
v_sub_f32 v147, v147, v42
v_sub_f32 v148, v148, v42
v_sub_f32 v149, v149, v42
v_sub_f32 v150, v150, v42
v_sub_f32 v151, v151, v42
v_sub_f32 v152, v152, v249
v_sub_f32 v153, v153, v249
v_sub_f32 v154, v154, v249
v_sub_f32 v155, v155, v249
v_sub_f32 v156, v156, v249
v_sub_f32 v157, v157, v249
v_sub_f32 v158, v158, v249
v_sub_f32 v159, v159, v249
s_nop 1
s_branch L_back11
L_slow12:
s_nop 15
v_max3_f32 v42, v144, v145, v146
v_max3_f32 v42, v42, v147, v148
v_max3_f32 v42, v42, v149, v150
v_max_f32 v42, v42, v151
v_max3_f32 v249, v152, v153, v154
v_max3_f32 v249, v249, v155, v156
v_max3_f32 v249, v249, v157, v158
v_max_f32 v249, v249, v159
s_nop 1
v_permlane16_swap_b32 v42, v249
v_max_f32 v42, v42, v249
v_mov_b32 v249, v42
s_nop 1
v_permlane32_swap_b32 v42, v249
v_max_f32 v42, v42, v249
v_add_f32 v42, 0x42000000, v42
v_max_f32 v42, 0, v42
v_mov_b32 v249, v42
s_nop 1
v_permlane16_swap_b32 v42, v249
v_sub_f32 v43, 0, v42
v_exp_f32 v43, v43
v_sub_f32 v44, 0, v249
v_exp_f32 v44, v44
v_sub_f32 v240, v240, v42
v_sub_f32 v241, v241, v42
v_sub_f32 v242, v242, v42
v_sub_f32 v243, v243, v42
v_sub_f32 v244, v244, v249
v_sub_f32 v245, v245, v249
v_sub_f32 v246, v246, v249
v_sub_f32 v247, v247, v249
v_mul_f32 v204, v204, v43
v_mul_f32 v252, v252, v44
v_mul_f32 v80, v80, v43
v_mul_f32 v81, v81, v43
v_mul_f32 v82, v82, v43
v_mul_f32 v83, v83, v43
v_mul_f32 v84, v84, v44
v_mul_f32 v85, v85, v44
v_mul_f32 v86, v86, v44
v_mul_f32 v87, v87, v44
v_mul_f32 v88, v88, v43
v_mul_f32 v89, v89, v43
v_mul_f32 v90, v90, v43
v_mul_f32 v91, v91, v43
v_mul_f32 v92, v92, v44
v_mul_f32 v93, v93, v44
v_mul_f32 v94, v94, v44
v_mul_f32 v95, v95, v44
v_mul_f32 v96, v96, v43
v_mul_f32 v97, v97, v43
v_mul_f32 v98, v98, v43
v_mul_f32 v99, v99, v43
v_mul_f32 v100, v100, v44
v_mul_f32 v101, v101, v44
v_mul_f32 v102, v102, v44
v_mul_f32 v103, v103, v44
v_mul_f32 v104, v104, v43
v_mul_f32 v105, v105, v43
v_mul_f32 v106, v106, v43
v_mul_f32 v107, v107, v43
v_mul_f32 v108, v108, v44
v_mul_f32 v109, v109, v44
v_mul_f32 v110, v110, v44
v_mul_f32 v111, v111, v44
v_mul_f32 v112, v112, v43
v_mul_f32 v113, v113, v43
v_mul_f32 v114, v114, v43
v_mul_f32 v115, v115, v43
v_mul_f32 v116, v116, v44
v_mul_f32 v117, v117, v44
v_mul_f32 v118, v118, v44
v_mul_f32 v119, v119, v44
v_mul_f32 v120, v120, v43
v_mul_f32 v121, v121, v43
v_mul_f32 v122, v122, v43
v_mul_f32 v123, v123, v43
v_mul_f32 v124, v124, v44
v_mul_f32 v125, v125, v44
v_mul_f32 v126, v126, v44
v_mul_f32 v127, v127, v44
v_mul_f32 v128, v128, v43
v_mul_f32 v129, v129, v43
v_mul_f32 v130, v130, v43
v_mul_f32 v131, v131, v43
v_mul_f32 v132, v132, v44
v_mul_f32 v133, v133, v44
v_mul_f32 v134, v134, v44
v_mul_f32 v135, v135, v44
v_mul_f32 v136, v136, v43
v_mul_f32 v137, v137, v43
v_mul_f32 v138, v138, v43
v_mul_f32 v139, v139, v43
v_mul_f32 v140, v140, v44
v_mul_f32 v141, v141, v44
v_mul_f32 v142, v142, v44
v_mul_f32 v143, v143, v44
v_sub_f32 v192, v144, v42
v_exp_f32 v192, v192
v_sub_f32 v193, v145, v42
v_exp_f32 v193, v193
v_sub_f32 v194, v146, v42
v_exp_f32 v194, v194
v_sub_f32 v195, v147, v42
v_exp_f32 v195, v195
v_cvt_pk_bf16_f32 v176, v192, v193
v_sub_f32 v196, v148, v42
v_exp_f32 v196, v196
v_sub_f32 v197, v149, v42
v_exp_f32 v197, v197
v_cvt_pk_bf16_f32 v177, v194, v195
v_sub_f32 v198, v150, v42
v_exp_f32 v198, v198
v_sub_f32 v199, v151, v42
v_exp_f32 v199, v199
v_cvt_pk_bf16_f32 v178, v196, v197
v_sub_f32 v192, v152, v249
v_exp_f32 v192, v192
v_sub_f32 v193, v153, v249
v_exp_f32 v193, v193
v_cvt_pk_bf16_f32 v179, v198, v199
v_sub_f32 v194, v154, v249
v_exp_f32 v194, v194
v_sub_f32 v195, v155, v249
v_exp_f32 v195, v195
v_cvt_pk_bf16_f32 v180, v192, v193
v_sub_f32 v196, v156, v249
v_exp_f32 v196, v196
v_sub_f32 v197, v157, v249
v_exp_f32 v197, v197
v_cvt_pk_bf16_f32 v181, v194, v195
v_sub_f32 v198, v158, v249
v_exp_f32 v198, v198
v_sub_f32 v199, v159, v249
v_exp_f32 v199, v199
v_cvt_pk_bf16_f32 v182, v196, v197
v_cvt_pk_bf16_f32 v183, v198, v199
v_sub_f32 v160, v160, v42
v_sub_f32 v161, v161, v42
v_sub_f32 v162, v162, v42
v_sub_f32 v163, v163, v42
v_sub_f32 v164, v164, v42
v_sub_f32 v165, v165, v42
v_sub_f32 v166, v166, v42
v_sub_f32 v167, v167, v42
v_sub_f32 v168, v168, v249
v_sub_f32 v169, v169, v249
v_sub_f32 v170, v170, v249
v_sub_f32 v171, v171, v249
v_sub_f32 v172, v172, v249
v_sub_f32 v173, v173, v249
v_sub_f32 v174, v174, v249
v_sub_f32 v175, v175, v249
s_nop 1
s_branch L_back12
L_slow13:
s_nop 15
v_max3_f32 v42, v160, v161, v162
v_max3_f32 v42, v42, v163, v164
v_max3_f32 v42, v42, v165, v166
v_max_f32 v42, v42, v167
v_max3_f32 v249, v168, v169, v170
v_max3_f32 v249, v249, v171, v172
v_max3_f32 v249, v249, v173, v174
v_max_f32 v249, v249, v175
s_nop 1
v_permlane16_swap_b32 v42, v249
v_max_f32 v42, v42, v249
v_mov_b32 v249, v42
s_nop 1
v_permlane32_swap_b32 v42, v249
v_max_f32 v42, v42, v249
v_add_f32 v42, 0x42000000, v42
v_max_f32 v42, 0, v42
v_mov_b32 v249, v42
s_nop 1
v_permlane16_swap_b32 v42, v249
v_sub_f32 v43, 0, v42
v_exp_f32 v43, v43
v_sub_f32 v44, 0, v249
v_exp_f32 v44, v44
v_sub_f32 v240, v240, v42
v_sub_f32 v241, v241, v42
v_sub_f32 v242, v242, v42
v_sub_f32 v243, v243, v42
v_sub_f32 v244, v244, v249
v_sub_f32 v245, v245, v249
v_sub_f32 v246, v246, v249
v_sub_f32 v247, v247, v249
v_mul_f32 v204, v204, v43
v_mul_f32 v252, v252, v44
v_mul_f32 v80, v80, v43
v_mul_f32 v81, v81, v43
v_mul_f32 v82, v82, v43
v_mul_f32 v83, v83, v43
v_mul_f32 v84, v84, v44
v_mul_f32 v85, v85, v44
v_mul_f32 v86, v86, v44
v_mul_f32 v87, v87, v44
v_mul_f32 v88, v88, v43
v_mul_f32 v89, v89, v43
v_mul_f32 v90, v90, v43
v_mul_f32 v91, v91, v43
v_mul_f32 v92, v92, v44
v_mul_f32 v93, v93, v44
v_mul_f32 v94, v94, v44
v_mul_f32 v95, v95, v44
v_mul_f32 v96, v96, v43
v_mul_f32 v97, v97, v43
v_mul_f32 v98, v98, v43
v_mul_f32 v99, v99, v43
v_mul_f32 v100, v100, v44
v_mul_f32 v101, v101, v44
v_mul_f32 v102, v102, v44
v_mul_f32 v103, v103, v44
v_mul_f32 v104, v104, v43
v_mul_f32 v105, v105, v43
v_mul_f32 v106, v106, v43
v_mul_f32 v107, v107, v43
v_mul_f32 v108, v108, v44
v_mul_f32 v109, v109, v44
v_mul_f32 v110, v110, v44
v_mul_f32 v111, v111, v44
v_mul_f32 v112, v112, v43
v_mul_f32 v113, v113, v43
v_mul_f32 v114, v114, v43
v_mul_f32 v115, v115, v43
v_mul_f32 v116, v116, v44
v_mul_f32 v117, v117, v44
v_mul_f32 v118, v118, v44
v_mul_f32 v119, v119, v44
v_mul_f32 v120, v120, v43
v_mul_f32 v121, v121, v43
v_mul_f32 v122, v122, v43
v_mul_f32 v123, v123, v43
v_mul_f32 v124, v124, v44
v_mul_f32 v125, v125, v44
v_mul_f32 v126, v126, v44
v_mul_f32 v127, v127, v44
v_mul_f32 v128, v128, v43
v_mul_f32 v129, v129, v43
v_mul_f32 v130, v130, v43
v_mul_f32 v131, v131, v43
v_mul_f32 v132, v132, v44
v_mul_f32 v133, v133, v44
v_mul_f32 v134, v134, v44
v_mul_f32 v135, v135, v44
v_mul_f32 v136, v136, v43
v_mul_f32 v137, v137, v43
v_mul_f32 v138, v138, v43
v_mul_f32 v139, v139, v43
v_mul_f32 v140, v140, v44
v_mul_f32 v141, v141, v44
v_mul_f32 v142, v142, v44
v_mul_f32 v143, v143, v44
v_sub_f32 v192, v160, v42
v_exp_f32 v192, v192
v_sub_f32 v193, v161, v42
v_exp_f32 v193, v193
v_sub_f32 v194, v162, v42
v_exp_f32 v194, v194
v_sub_f32 v195, v163, v42
v_exp_f32 v195, v195
v_cvt_pk_bf16_f32 v184, v192, v193
v_sub_f32 v196, v164, v42
v_exp_f32 v196, v196
v_sub_f32 v197, v165, v42
v_exp_f32 v197, v197
v_cvt_pk_bf16_f32 v185, v194, v195
v_sub_f32 v198, v166, v42
v_exp_f32 v198, v198
v_sub_f32 v199, v167, v42
v_exp_f32 v199, v199
v_cvt_pk_bf16_f32 v186, v196, v197
v_sub_f32 v192, v168, v249
v_exp_f32 v192, v192
v_sub_f32 v193, v169, v249
v_exp_f32 v193, v193
v_cvt_pk_bf16_f32 v187, v198, v199
v_sub_f32 v194, v170, v249
v_exp_f32 v194, v194
v_sub_f32 v195, v171, v249
v_exp_f32 v195, v195
v_cvt_pk_bf16_f32 v188, v192, v193
v_sub_f32 v196, v172, v249
v_exp_f32 v196, v196
v_sub_f32 v197, v173, v249
v_exp_f32 v197, v197
v_cvt_pk_bf16_f32 v189, v194, v195
v_sub_f32 v198, v174, v249
v_exp_f32 v198, v198
v_sub_f32 v199, v175, v249
v_exp_f32 v199, v199
v_cvt_pk_bf16_f32 v190, v196, v197
v_cvt_pk_bf16_f32 v191, v198, v199
v_sub_f32 v144, v144, v42
v_sub_f32 v145, v145, v42
v_sub_f32 v146, v146, v42
v_sub_f32 v147, v147, v42
v_sub_f32 v148, v148, v42
v_sub_f32 v149, v149, v42
v_sub_f32 v150, v150, v42
v_sub_f32 v151, v151, v42
v_sub_f32 v152, v152, v249
v_sub_f32 v153, v153, v249
v_sub_f32 v154, v154, v249
v_sub_f32 v155, v155, v249
v_sub_f32 v156, v156, v249
v_sub_f32 v157, v157, v249
v_sub_f32 v158, v158, v249
v_sub_f32 v159, v159, v249
s_nop 1
s_branch L_back13
L_slow14:
s_nop 15
v_max3_f32 v42, v144, v145, v146
v_max3_f32 v42, v42, v147, v148
v_max3_f32 v42, v42, v149, v150
v_max_f32 v42, v42, v151
v_max3_f32 v249, v152, v153, v154
v_max3_f32 v249, v249, v155, v156
v_max3_f32 v249, v249, v157, v158
v_max_f32 v249, v249, v159
s_nop 1
v_permlane16_swap_b32 v42, v249
v_max_f32 v42, v42, v249
v_mov_b32 v249, v42
s_nop 1
v_permlane32_swap_b32 v42, v249
v_max_f32 v42, v42, v249
v_add_f32 v42, 0x42000000, v42
v_max_f32 v42, 0, v42
v_mov_b32 v249, v42
s_nop 1
v_permlane16_swap_b32 v42, v249
v_sub_f32 v43, 0, v42
v_exp_f32 v43, v43
v_sub_f32 v44, 0, v249
v_exp_f32 v44, v44
v_sub_f32 v240, v240, v42
v_sub_f32 v241, v241, v42
v_sub_f32 v242, v242, v42
v_sub_f32 v243, v243, v42
v_sub_f32 v244, v244, v249
v_sub_f32 v245, v245, v249
v_sub_f32 v246, v246, v249
v_sub_f32 v247, v247, v249
v_mul_f32 v204, v204, v43
v_mul_f32 v252, v252, v44
v_mul_f32 v80, v80, v43
v_mul_f32 v81, v81, v43
v_mul_f32 v82, v82, v43
v_mul_f32 v83, v83, v43
v_mul_f32 v84, v84, v44
v_mul_f32 v85, v85, v44
v_mul_f32 v86, v86, v44
v_mul_f32 v87, v87, v44
v_mul_f32 v88, v88, v43
v_mul_f32 v89, v89, v43
v_mul_f32 v90, v90, v43
v_mul_f32 v91, v91, v43
v_mul_f32 v92, v92, v44
v_mul_f32 v93, v93, v44
v_mul_f32 v94, v94, v44
v_mul_f32 v95, v95, v44
v_mul_f32 v96, v96, v43
v_mul_f32 v97, v97, v43
v_mul_f32 v98, v98, v43
v_mul_f32 v99, v99, v43
v_mul_f32 v100, v100, v44
v_mul_f32 v101, v101, v44
v_mul_f32 v102, v102, v44
v_mul_f32 v103, v103, v44
v_mul_f32 v104, v104, v43
v_mul_f32 v105, v105, v43
v_mul_f32 v106, v106, v43
v_mul_f32 v107, v107, v43
v_mul_f32 v108, v108, v44
v_mul_f32 v109, v109, v44
v_mul_f32 v110, v110, v44
v_mul_f32 v111, v111, v44
v_mul_f32 v112, v112, v43
v_mul_f32 v113, v113, v43
v_mul_f32 v114, v114, v43
v_mul_f32 v115, v115, v43
v_mul_f32 v116, v116, v44
v_mul_f32 v117, v117, v44
v_mul_f32 v118, v118, v44
v_mul_f32 v119, v119, v44
v_mul_f32 v120, v120, v43
v_mul_f32 v121, v121, v43
v_mul_f32 v122, v122, v43
v_mul_f32 v123, v123, v43
v_mul_f32 v124, v124, v44
v_mul_f32 v125, v125, v44
v_mul_f32 v126, v126, v44
v_mul_f32 v127, v127, v44
v_mul_f32 v128, v128, v43
v_mul_f32 v129, v129, v43
v_mul_f32 v130, v130, v43
v_mul_f32 v131, v131, v43
v_mul_f32 v132, v132, v44
v_mul_f32 v133, v133, v44
v_mul_f32 v134, v134, v44
v_mul_f32 v135, v135, v44
v_mul_f32 v136, v136, v43
v_mul_f32 v137, v137, v43
v_mul_f32 v138, v138, v43
v_mul_f32 v139, v139, v43
v_mul_f32 v140, v140, v44
v_mul_f32 v141, v141, v44
v_mul_f32 v142, v142, v44
v_mul_f32 v143, v143, v44
v_sub_f32 v192, v144, v42
v_exp_f32 v192, v192
v_sub_f32 v193, v145, v42
v_exp_f32 v193, v193
v_sub_f32 v194, v146, v42
v_exp_f32 v194, v194
v_sub_f32 v195, v147, v42
v_exp_f32 v195, v195
v_cvt_pk_bf16_f32 v176, v192, v193
v_sub_f32 v196, v148, v42
v_exp_f32 v196, v196
v_sub_f32 v197, v149, v42
v_exp_f32 v197, v197
v_cvt_pk_bf16_f32 v177, v194, v195
v_sub_f32 v198, v150, v42
v_exp_f32 v198, v198
v_sub_f32 v199, v151, v42
v_exp_f32 v199, v199
v_cvt_pk_bf16_f32 v178, v196, v197
v_sub_f32 v192, v152, v249
v_exp_f32 v192, v192
v_sub_f32 v193, v153, v249
v_exp_f32 v193, v193
v_cvt_pk_bf16_f32 v179, v198, v199
v_sub_f32 v194, v154, v249
v_exp_f32 v194, v194
v_sub_f32 v195, v155, v249
v_exp_f32 v195, v195
v_cvt_pk_bf16_f32 v180, v192, v193
v_sub_f32 v196, v156, v249
v_exp_f32 v196, v196
v_sub_f32 v197, v157, v249
v_exp_f32 v197, v197
v_cvt_pk_bf16_f32 v181, v194, v195
v_sub_f32 v198, v158, v249
v_exp_f32 v198, v198
v_sub_f32 v199, v159, v249
v_exp_f32 v199, v199
v_cvt_pk_bf16_f32 v182, v196, v197
v_cvt_pk_bf16_f32 v183, v198, v199
v_sub_f32 v160, v160, v42
v_sub_f32 v161, v161, v42
v_sub_f32 v162, v162, v42
v_sub_f32 v163, v163, v42
v_sub_f32 v164, v164, v42
v_sub_f32 v165, v165, v42
v_sub_f32 v166, v166, v42
v_sub_f32 v167, v167, v42
v_sub_f32 v168, v168, v249
v_sub_f32 v169, v169, v249
v_sub_f32 v170, v170, v249
v_sub_f32 v171, v171, v249
v_sub_f32 v172, v172, v249
v_sub_f32 v173, v173, v249
v_sub_f32 v174, v174, v249
v_sub_f32 v175, v175, v249
s_nop 1
s_branch L_back14
L_slow15:
s_nop 15
v_max3_f32 v42, v160, v161, v162
v_max3_f32 v42, v42, v163, v164
v_max3_f32 v42, v42, v165, v166
v_max_f32 v42, v42, v167
v_max3_f32 v249, v168, v169, v170
v_max3_f32 v249, v249, v171, v172
v_max3_f32 v249, v249, v173, v174
v_max_f32 v249, v249, v175
s_nop 1
v_permlane16_swap_b32 v42, v249
v_max_f32 v42, v42, v249
v_mov_b32 v249, v42
s_nop 1
v_permlane32_swap_b32 v42, v249
v_max_f32 v42, v42, v249
v_add_f32 v42, 0x42000000, v42
v_max_f32 v42, 0, v42
v_mov_b32 v249, v42
s_nop 1
v_permlane16_swap_b32 v42, v249
v_sub_f32 v43, 0, v42
v_exp_f32 v43, v43
v_sub_f32 v44, 0, v249
v_exp_f32 v44, v44
v_sub_f32 v240, v240, v42
v_sub_f32 v241, v241, v42
v_sub_f32 v242, v242, v42
v_sub_f32 v243, v243, v42
v_sub_f32 v244, v244, v249
v_sub_f32 v245, v245, v249
v_sub_f32 v246, v246, v249
v_sub_f32 v247, v247, v249
v_mul_f32 v204, v204, v43
v_mul_f32 v252, v252, v44
v_mul_f32 v80, v80, v43
v_mul_f32 v81, v81, v43
v_mul_f32 v82, v82, v43
v_mul_f32 v83, v83, v43
v_mul_f32 v84, v84, v44
v_mul_f32 v85, v85, v44
v_mul_f32 v86, v86, v44
v_mul_f32 v87, v87, v44
v_mul_f32 v88, v88, v43
v_mul_f32 v89, v89, v43
v_mul_f32 v90, v90, v43
v_mul_f32 v91, v91, v43
v_mul_f32 v92, v92, v44
v_mul_f32 v93, v93, v44
v_mul_f32 v94, v94, v44
v_mul_f32 v95, v95, v44
v_mul_f32 v96, v96, v43
v_mul_f32 v97, v97, v43
v_mul_f32 v98, v98, v43
v_mul_f32 v99, v99, v43
v_mul_f32 v100, v100, v44
v_mul_f32 v101, v101, v44
v_mul_f32 v102, v102, v44
v_mul_f32 v103, v103, v44
v_mul_f32 v104, v104, v43
v_mul_f32 v105, v105, v43
v_mul_f32 v106, v106, v43
v_mul_f32 v107, v107, v43
v_mul_f32 v108, v108, v44
v_mul_f32 v109, v109, v44
v_mul_f32 v110, v110, v44
v_mul_f32 v111, v111, v44
v_mul_f32 v112, v112, v43
v_mul_f32 v113, v113, v43
v_mul_f32 v114, v114, v43
v_mul_f32 v115, v115, v43
v_mul_f32 v116, v116, v44
v_mul_f32 v117, v117, v44
v_mul_f32 v118, v118, v44
v_mul_f32 v119, v119, v44
v_mul_f32 v120, v120, v43
v_mul_f32 v121, v121, v43
v_mul_f32 v122, v122, v43
v_mul_f32 v123, v123, v43
v_mul_f32 v124, v124, v44
v_mul_f32 v125, v125, v44
v_mul_f32 v126, v126, v44
v_mul_f32 v127, v127, v44
v_mul_f32 v128, v128, v43
v_mul_f32 v129, v129, v43
v_mul_f32 v130, v130, v43
v_mul_f32 v131, v131, v43
v_mul_f32 v132, v132, v44
v_mul_f32 v133, v133, v44
v_mul_f32 v134, v134, v44
v_mul_f32 v135, v135, v44
v_mul_f32 v136, v136, v43
v_mul_f32 v137, v137, v43
v_mul_f32 v138, v138, v43
v_mul_f32 v139, v139, v43
v_mul_f32 v140, v140, v44
v_mul_f32 v141, v141, v44
v_mul_f32 v142, v142, v44
v_mul_f32 v143, v143, v44
v_sub_f32 v192, v160, v42
v_exp_f32 v192, v192
v_sub_f32 v193, v161, v42
v_exp_f32 v193, v193
v_sub_f32 v194, v162, v42
v_exp_f32 v194, v194
v_sub_f32 v195, v163, v42
v_exp_f32 v195, v195
v_cvt_pk_bf16_f32 v184, v192, v193
v_sub_f32 v196, v164, v42
v_exp_f32 v196, v196
v_sub_f32 v197, v165, v42
v_exp_f32 v197, v197
v_cvt_pk_bf16_f32 v185, v194, v195
v_sub_f32 v198, v166, v42
v_exp_f32 v198, v198
v_sub_f32 v199, v167, v42
v_exp_f32 v199, v199
v_cvt_pk_bf16_f32 v186, v196, v197
v_sub_f32 v192, v168, v249
v_exp_f32 v192, v192
v_sub_f32 v193, v169, v249
v_exp_f32 v193, v193
v_cvt_pk_bf16_f32 v187, v198, v199
v_sub_f32 v194, v170, v249
v_exp_f32 v194, v194
v_sub_f32 v195, v171, v249
v_exp_f32 v195, v195
v_cvt_pk_bf16_f32 v188, v192, v193
v_sub_f32 v196, v172, v249
v_exp_f32 v196, v196
v_sub_f32 v197, v173, v249
v_exp_f32 v197, v197
v_cvt_pk_bf16_f32 v189, v194, v195
v_sub_f32 v198, v174, v249
v_exp_f32 v198, v198
v_sub_f32 v199, v175, v249
v_exp_f32 v199, v199
v_cvt_pk_bf16_f32 v190, v196, v197
v_cvt_pk_bf16_f32 v191, v198, v199
s_nop 1
s_branch L_back15
L_hs0:
s_mov_b32 s52, 0
L_hsl0:
buffer_load_dword v40, v37, s[96:99], s11 offen sc1
s_add_u32 s52, s52, 1
s_waitcnt vmcnt(0)
v_readfirstlane_b32 s9, v40
s_nop 0
s_cmp_eq_u32 s9, 1
s_cbranch_scc1 L_hsback0
s_sleep 4
s_cmp_lt_u32 s52, 65536
s_cbranch_scc1 L_hsl0
s_branch L_hsback0
L_zv13:
buffer_load_dword v40, v37, s[48:51], s55 offen sc1
s_add_u32 s52, s52, 1
s_waitcnt vmcnt(0)
v_readfirstlane_b32 s9, v40
s_nop 0
s_cmp_eq_u32 s9, 1
s_cbranch_scc1 L_zok13
s_sleep 2
s_cmp_lt_u32 s52, 65536
s_cbranch_scc1 L_zv13
s_branch L_zok13
L_hs24:
s_mov_b32 s52, 0
L_hsl24:
buffer_load_dword v40, v37, s[96:99], s11 offen sc1
s_add_u32 s52, s52, 1
s_waitcnt vmcnt(0)
v_readfirstlane_b32 s9, v40
s_nop 0
s_cmp_eq_u32 s9, 1
s_cbranch_scc1 L_hsback24
s_sleep 4
s_cmp_lt_u32 s52, 65536
s_cbranch_scc1 L_hsl24
s_branch L_hsback24
L_zv37:
buffer_load_dword v40, v37, s[48:51], s55 offen sc1
s_add_u32 s52, s52, 1
s_waitcnt vmcnt(0)
v_readfirstlane_b32 s9, v40
s_nop 0
s_cmp_eq_u32 s9, 1
s_cbranch_scc1 L_zok37
s_sleep 2
s_cmp_lt_u32 s52, 65536
s_cbranch_scc1 L_zv37
s_branch L_zok37
L_hs48:
s_mov_b32 s52, 0
L_hsl48:
buffer_load_dword v40, v37, s[96:99], s11 offen sc1
s_add_u32 s52, s52, 1
s_waitcnt vmcnt(0)
v_readfirstlane_b32 s9, v40
s_nop 0
s_cmp_eq_u32 s9, 1
s_cbranch_scc1 L_hsback48
s_sleep 4
s_cmp_lt_u32 s52, 65536
s_cbranch_scc1 L_hsl48
s_branch L_hsback48
L_zv61:
buffer_load_dword v40, v37, s[48:51], s55 offen sc1
s_add_u32 s52, s52, 1
s_waitcnt vmcnt(0)
v_readfirstlane_b32 s9, v40
s_nop 0
s_cmp_eq_u32 s9, 1
s_cbranch_scc1 L_zok61
s_sleep 2
s_cmp_lt_u32 s52, 65536
s_cbranch_scc1 L_zv61
s_branch L_zok61
L_hs72:
s_mov_b32 s52, 0
L_hsl72:
buffer_load_dword v40, v37, s[96:99], s11 offen sc1
s_add_u32 s52, s52, 1
s_waitcnt vmcnt(0)
v_readfirstlane_b32 s9, v40
s_nop 0
s_cmp_eq_u32 s9, 1
s_cbranch_scc1 L_hsback72
s_sleep 4
s_cmp_lt_u32 s52, 65536
s_cbranch_scc1 L_hsl72
s_branch L_hsback72
L_zv85:
buffer_load_dword v40, v37, s[48:51], s55 offen sc1
s_add_u32 s52, s52, 1
s_waitcnt vmcnt(0)
v_readfirstlane_b32 s9, v40
s_nop 0
s_cmp_eq_u32 s9, 1
s_cbranch_scc1 L_zok85
s_sleep 2
s_cmp_lt_u32 s52, 65536
s_cbranch_scc1 L_zv85
s_branch L_zok85
L_cvec:
s_waitcnt lgkmcnt(0)
v_mov_b32 v217, 0
L_cvl:
buffer_load_dwordx4 v[208:211], v217, s[48:51], s4 offen sc1
buffer_load_dwordx4 v[212:215], v217, s[48:51], s4 offen offset:16 sc1
s_add_u32 s9, s9, 1
s_waitcnt vmcnt(0)
v_readfirstlane_b32 s28, v208
v_readfirstlane_b32 s29, v209
v_readfirstlane_b32 s30, v210
v_readfirstlane_b32 s31, v211
v_readfirstlane_b32 s32, v212
v_readfirstlane_b32 s33, v213
v_readfirstlane_b32 s34, v214
v_readfirstlane_b32 s35, v215
s_or_b64 s[28:29], s[28:29], s[36:37]
s_or_b64 s[30:31], s[30:31], s[38:39]
s_or_b64 s[32:33], s[32:33], s[40:41]
s_or_b64 s[34:35], s[34:35], s[42:43]
s_cmp_lt_u32 s9, 65536
s_cselect_b64 s[28:29], s[28:29], -1
s_cselect_b64 s[30:31], s[30:31], -1
s_cselect_b64 s[32:33], s[32:33], -1
s_cselect_b64 s[34:35], s[34:35], -1
v_mov_b32 v208, s28
v_mov_b32 v209, s29
v_mov_b32 v210, s30
v_mov_b32 v211, s31
v_mov_b32 v212, s32
v_mov_b32 v213, s33
v_mov_b32 v214, s34
v_mov_b32 v215, s35
ds_write_b128 v216, v[208:211]
ds_write_b128 v216, v[212:215] offset:16
s_and_b64 s[52:53], s[28:29], s[30:31]
s_and_b64 s[54:55], s[32:33], s[34:35]
s_and_b64 s[52:53], s[52:53], s[54:55]
s_cmp_eq_u64 s[52:53], -1
s_cbranch_scc1 L_cpdone
s_waitcnt lgkmcnt(0)
s_sleep 2
s_branch L_cvl
.section .rodata,"a"
.p2align 6
.amdhsa_kernel concat_heads__gqa_block_cached__gqa_block_cached__near_ridge_kernel
  .amdhsa_next_free_vgpr 256
  .amdhsa_next_free_sgpr 102
  .amdhsa_accum_offset 256
  .amdhsa_group_segment_fixed_size 0
  .amdhsa_kernarg_size 104
  .amdhsa_user_sgpr_count 2
  .amdhsa_user_sgpr_kernarg_segment_ptr 1
  .amdhsa_system_sgpr_workgroup_id_x 1
.end_amdhsa_kernel
```
